```python
import torch

def _softmax(x, axis=-1):
    return torch.softmax(x, dim=axis)

def _gelu(x):
    return torch.nn.functional.gelu(x, approximate='tanh')

def _silu(x):
    return torch.nn.functional.silu(x)

def _sigmoid(x):
    return torch.sigmoid(x)

def _layernorm(x, axis=-1, eps=1e-05):
    m = x.mean(dim=axis, keepdim=True)
    v = x.var(dim=axis, keepdim=True, unbiased=False)
    return (x - m) / torch.sqrt(v + eps)

def _scatter_add(tgt, idx, src, axis=0):
    return tgt.clone().index_add_(axis, idx, src)

def _segment_sum(src, seg, n):
    out = torch.zeros((n,) + src.shape[1:], dtype=src.dtype)
    return out.index_add_(0, seg, src)

def _pad(x, pw):
    flat = tuple((v for pair in reversed(pw) for v in pair))
    return torch.nn.functional.pad(x, flat)
kernel_name = 'concat_heads__memory_aug_recurrent_mem_tr__ssm_conv_s4__prompt'

def setup_inputs():

    _w = lambda a: (lambda t: t.to(torch.bfloat16) if t.is_floating_point() else t)(torch.as_tensor(a))

    def _A_setup():
        B, S, Dm = (1, 2048, 576)
        H, Dh = (32, 128)
        M, seg = (8, 32)
        seg = min(seg, S)
        S = S // seg * seg
        return {'x': _w((lambda *s: torch.randn(*s, dtype=torch.bfloat16) * 0.05)(B, S, Dm)), 'mem0': _w((lambda *s: torch.randn(*s, dtype=torch.bfloat16) * 0.4)(B, M, Dm)), 'Wq': _w((lambda *s: torch.randn(*s, dtype=torch.bfloat16) * 6.4)(Dm, H, Dh) * Dm ** (-0.5)), 'Wk': _w((lambda *s: torch.randn(*s, dtype=torch.bfloat16) * 6.4)(Dm, H, Dh) * Dm ** (-0.5)), 'Wv': _w((lambda *s: torch.randn(*s, dtype=torch.bfloat16) * 0.4)(Dm, H, Dh) * Dm ** (-0.5)), 'Wo': _w((lambda *s: torch.randn(*s, dtype=torch.bfloat16) * 0.4)(H, Dh, Dm) * (H * Dh) ** (-0.5)), 'seg_len': seg}
    _A_in = _A_setup()

    def _B_setup():
        B, L, D, N = (1, 2048, 576, 128)
        A_re = -(lambda _x: torch.exp(torch.as_tensor(_x)))((lambda *s: torch.randn(*s, dtype=torch.bfloat16) * 3.2)(D, N))
        A_im = torch.pi * (lambda *s: torch.randn(*s, dtype=torch.bfloat16) * 0.05)(D, N)
        B_re = (lambda *s: torch.randn(*s, dtype=torch.bfloat16) * 0.2)(D, N)
        B_im = (lambda *s: torch.randn(*s, dtype=torch.bfloat16) * 0.1)(D, N)
        C_re = (lambda *s: torch.randn(*s, dtype=torch.bfloat16) * 0.2)(D, N)
        C_im = (lambda *s: torch.randn(*s, dtype=torch.bfloat16) * 0.2)(D, N)
        log_dt = (lambda *s: torch.randn(*s, dtype=torch.bfloat16) * 0.05)(D) * 0.5 - 4.0
        Dskip = (lambda *s: torch.randn(*s, dtype=torch.bfloat16) * 0.05)(D)
        return {'u': _w((lambda *s: torch.randn(*s, dtype=torch.bfloat16) * 0.05)(B, L, D)), 'A_re': _w(A_re), 'A_im': _w(A_im), 'B_re': _w(B_re), 'B_im': _w(B_im), 'C_re': _w(C_re), 'C_im': _w(C_im), 'log_dt': _w(log_dt), 'Dskip': _w(Dskip)}
    _B_in = _B_setup()
    return {'A_x': _A_in['x'], 'A_mem0': _A_in['mem0'], 'A_Wq': _A_in['Wq'], 'A_Wk': _A_in['Wk'], 'A_Wv': _A_in['Wv'], 'A_Wo': _A_in['Wo'], 'A_seg_len': _A_in['seg_len'], 'B_u': _B_in['u'], 'B_A_re': _B_in['A_re'], 'B_A_im': _B_in['A_im'], 'B_B_re': _B_in['B_re'], 'B_B_im': _B_in['B_im'], 'B_C_re': _B_in['C_re'], 'B_C_im': _B_in['C_im'], 'B_log_dt': _B_in['log_dt'], 'B_Dskip': _B_in['Dskip']}

def reference(A_x, A_mem0, A_Wq, A_Wk, A_Wv, A_Wo, A_seg_len, B_u, B_A_re, B_A_im, B_B_re, B_B_im, B_C_re, B_C_im, B_log_dt, B_Dskip):

    def _A_ref(x, mem0, Wq, Wk, Wv, Wo, seg_len):
        B, S, Dm = x.shape
        H, Dh = (Wq.shape[1], Wq.shape[2])
        M = mem0.shape[1]
        scale = Dh ** (-0.5)
        n_seg = S // seg_len
        L = M + seg_len
        idx = torch.arange(L)
        mask = (idx[:, None] < M) | (idx[:, None] >= idx[None, :])
        mem = mem0
        outs = []
        for s in range(n_seg):
            xs = x[:, s * seg_len:(s + 1) * seg_len, :].clone()
            h = torch.concatenate([mem, xs], axis=1)
            q = torch.einsum('btd,dhe->bhte', h, Wq)
            k = torch.einsum('btd,dhe->bhte', h, Wk)
            v = torch.einsum('btd,dhe->bhte', h, Wv)
            scores = torch.einsum('bhqe,bhke->bhqk', q, k) * scale
            scores = torch.where(mask[None, None], scores, -1000000000.0)
            p = _softmax(scores, axis=-1)
            o = torch.einsum('bhqk,bhke->bhqe', p, v)
            o = torch.einsum('bhte,hed->btd', o, Wo)
            mem = o[:, :M, :].clone()
            outs.append(o[:, M:, :])
        return torch.concatenate(outs, axis=1)

    def _B_ref(u, A_re, A_im, B_re, B_im, C_re, C_im, log_dt, Dskip):
        Bsz, L, D = u.shape
        dt = torch.exp(log_dt)[:, None]
        A = A_re + 1j * A_im
        Bc = B_re + 1j * B_im
        Cc = C_re + 1j * C_im
        logdA = dt * A
        dB = dt * Bc
        l = (lambda x, dt: x.to(dt))(torch.arange(L), A_re.dtype)
        P = torch.exp(logdA[:, :, None] * l[None, None, :])
        K = torch.einsum('dn,dnl,dn->dl', Cc, P, dB).real
        L2 = 2 * L
        Kp = _pad(K, ((0, 0), (0, L)))
        up = (lambda x, *d: x.permute(*d))(u, 0, 2, 1)
        up = _pad(up, ((0, 0), (0, 0), (0, L)))
        Kf = (lambda x, axes=(-2, -1): torch.fft.rfft2(x.float(), dim=axes))(Kp[:, None, :], axes=(-2, -1))
        Uf = (lambda x, axes=(-2, -1): torch.fft.rfft2(x.float(), dim=axes))(up[:, :, None, :], axes=(-2, -1))
        Yf = Uf * Kf[None, :, :, :]
        y = (lambda x, s, axes=(-2, -1): torch.fft.irfft2(x, s=s, dim=axes).to(torch.bfloat16))(Yf, (1, L2), axes=(-2, -1))[:, :, 0, :L]
        y = (lambda x, *d: x.permute(*d))(y, 0, 2, 1) + u * Dskip[None, None, :]
        return y
    a = _A_ref(A_x, A_mem0, A_Wq, A_Wk, A_Wv, A_Wo, A_seg_len)
    b = _B_ref(B_u, B_A_re, B_A_im, B_B_re, B_B_im, B_C_re, B_C_im, B_log_dt, B_Dskip)
    return torch.concatenate([a, b], axis=-1)
```

```asm
; @launch kernel=c_kernel grid=(256,1,1) block=(256,1,1) lds=163840
.amdgcn_target "amdgcn-amd-amdhsa--gfx950"
.text
.globl c_kernel
.p2align 8
.type c_kernel,@function
c_kernel:
  s_cmp_ge_u32 s2, 256
  s_cbranch_scc1 C_EXIT
  v_lshrrev_b32 v1, 6, v0
  s_nop 0
  v_readfirstlane_b32 s3, v1
  s_load_dwordx2 s[4:5], s[0:1], 136
  s_waitcnt lgkmcnt(0)
  s_mov_b32 s16, s4
  s_mov_b32 s17, s5
  s_mov_b32 s18, 256
  s_mov_b32 s19, 0x00020000
  s_getreg_b32 s10, hwreg(HW_REG_XCC_ID, 0, 4)
  s_cmp_lg_u32 s3, 0
  s_cbranch_scc1 T_WAIT
  s_mov_b64 s[26:27], exec
  s_mov_b64 exec, 1
  s_lshl_b32 s25, s10, 2
  v_mov_b32 v3, s25
  v_mov_b32 v4, 1
  v_mov_b32 v5, 1
  v_mov_b32 v6, 68
  buffer_atomic_add v4, v3, s[16:19], 0 offen sc0
  buffer_atomic_add v5, v6, s[16:19], 0 offen sc0 sc1
  s_waitcnt vmcnt(1)
  v_readfirstlane_b32 s28, v4
  s_waitcnt vmcnt(0)
  v_readfirstlane_b32 s29, v5
  v_mov_b32 v3, 64
  s_cmp_eq_u32 s28, 31
  s_nop 2
  s_cbranch_scc0 T_NL
  s_add_u32 s30, s10, 1
  v_mov_b32 v4, s30
  v_mov_b32 v5, 0
  buffer_atomic_cmpswap v[4:5], v3, s[16:19], 0 offen sc0 sc1
  s_nop 0
  s_waitcnt vmcnt(0)
T_NL:
  s_mov_b32 s30, 0
T_POLL:
  buffer_load_dword v4, v3, s[16:19], 0 offen sc1
  s_waitcnt vmcnt(0)
  v_readfirstlane_b32 s31, v4
  s_cmp_lg_u32 s31, 0
  s_nop 3
  s_cbranch_scc1 T_DONE
  s_add_u32 s30, s30, 1
  s_cmp_lt_u32 s30, 3000
  s_cbranch_scc1 T_POLL
  v_mov_b32 v4, 100
  v_mov_b32 v5, 0
  buffer_atomic_cmpswap v[4:5], v3, s[16:19], 0 offen sc0 sc1
  s_waitcnt vmcnt(0)
  s_mov_b32 s30, 2990
  s_branch T_POLL
T_DONE:
  s_mov_b32 s20, 0xffff
  s_mov_b32 s35, 0
  s_add_u32 s30, s10, 1
  s_cmp_eq_u32 s31, s30
  s_cselect_b32 s20, s28, s20
  s_cmp_eq_u32 s31, 100
  s_cselect_b32 s20, s29, s20
  s_cselect_b32 s35, 1, 0
  v_mov_b32 v4, s20
  v_mov_b32 v5, s35
  v_mov_b32 v3, 0
  ds_write_b64 v3, v[4:5]
  s_waitcnt lgkmcnt(0)
  s_mov_b64 exec, s[26:27]
T_WAIT:
  s_barrier
  v_mov_b32 v3, 0
  ds_read_b64 v[4:5], v3
  s_waitcnt lgkmcnt(0)
  v_readfirstlane_b32 s20, v4
  v_readfirstlane_b32 s35, v5
  s_waitcnt lgkmcnt(0)
  s_barrier
  s_cmp_ge_u32 s20, 32
  s_nop 1
  s_cbranch_scc1 C_WORK
  s_cmp_lg_u32 s35, 0
  s_cbranch_scc1 C_SLOW
  s_load_dwordx2 s[8:9], s[0:1], 144
  s_load_dwordx2 s[36:37], s[0:1], 16
  s_load_dwordx2 s[38:39], s[0:1], 24
  s_load_dwordx2 s[40:41], s[0:1], 32
  s_load_dwordx2 s[42:43], s[0:1], 40
  s_load_dwordx2 s[44:45], s[0:1], 8
  s_waitcnt lgkmcnt(0)
  s_mov_b32 s12, s8
  s_mov_b32 s13, s9
  s_mov_b32 s14, 0x8000000
  s_mov_b32 s15, 0x00020000
  v_and_b32 v20, 63, v0
  v_lshlrev_b32 v1, 4, v20
  v_lshrrev_b32 v21, 4, v20
  v_and_b32 v22, 15, v20
  v_and_b32 v23, 3, v20
  v_lshrrev_b32 v24, 2, v22
  v_mov_b32 v28, -1
  v_mov_b32 v29, -1
  v_mov_b32 v30, -1
  v_mov_b32 v31, -1
  s_mul_i32 s46, s20, 9216
  s_mul_i32 s47, s3, 2304
  s_add_u32 s46, s46, s47
  s_add_u32 s46, s46, 0x4c00000
  s_add_u32 s47, s46, 0
  buffer_store_dwordx4 v[28:31], v1, s[12:15], s47 offen
  s_add_u32 s47, s46, 1024
  buffer_store_dwordx4 v[28:31], v1, s[12:15], s47 offen
  s_mov_b64 exec, 0xffff
  s_add_u32 s47, s46, 2048
  buffer_store_dwordx4 v[28:31], v1, s[12:15], s47 offen
  s_mov_b64 exec, -1
  s_lshl_b32 s34, s20, 2
  s_add_u32 s34, s34, s3
  s_lshl_b32 s34, s34, 7
  s_add_u32 s34, s34, 0x4e00000
  v_mov_b32 v15, 0
  s_mov_b64 exec, 1
  buffer_store_dword v15, off, s[12:15], s34 sc1
  s_mov_b64 exec, -1
  s_lshr_b32 s48, s20, 2
  s_and_b32 s49, s20, 3
  s_mul_i32 s50, s48, 72
  v_lshlrev_b32 v25, 1, v20
  v_add_u32 v25, s50, v25
  v_lshrrev_b32 v26, 3, v25
  v_lshlrev_b32 v26, 7, v26
  v_and_b32 v27, 7, v25
  v_lshlrev_b32 v27, 1, v27
  v_add_u32 v26, v26, v27
  s_and_b32 s50, s49, 1
  s_lshl_b32 s50, s50, 2
  s_lshr_b32 s51, s49, 1
  s_lshl_b32 s51, s51, 1
  s_add_u32 s50, s50, s51
  s_and_b32 s51, s3, 1
  s_add_u32 s50, s50, s51
  s_lshl_b32 s51, s50, 4
  v_add_u32 v16, s51, v26
  s_mov_b32 s4, s44
  s_mov_b32 s5, s45
  s_mov_b32 s6, 9216
  s_mov_b32 s7, 0x00020000
  s_mul_i32 s51, s50, 1152
  v_lshlrev_b32 v27, 1, v25
  v_add_u32 v27, s51, v27
  s_mov_b32 s52, -1
  s_mov_b32 s53, 15
  s_cmp_lt_u32 s3, 2
  s_cselect_b64 s[52:53], s[52:53], 0
  s_mov_b64 exec, s[52:53]
  s_waitcnt vmcnt(0)
  s_cbranch_execz C_NOINIT_f
  buffer_load_dword v32, v27, s[4:7], 0 offen
  v_mov_b32 v33, -1
  s_mov_b32 s47, 0x4d80000
  s_waitcnt vmcnt(0)
  buffer_store_dword v32, v16, s[12:15], s47 offen
  s_mov_b32 s47, 0x4d82400
  buffer_store_dword v33, v16, s[12:15], s47 offen
  s_mov_b32 s47, 0x4d84800
  buffer_store_dword v33, v16, s[12:15], s47 offen
  s_nop 1
  s_waitcnt vmcnt(0)
C_NOINIT_f:
  s_mov_b64 exec, -1
  s_waitcnt vmcnt(0)
  s_barrier
  s_cmp_lg_u32 s3, 0
  s_cbranch_scc1 C_NOSIG_f
  s_mov_b64 exec, 1
  v_mov_b32 v32, 1
  v_mov_b32 v33, 72
  buffer_atomic_add v32, v33, s[16:19], 0 offen sc1
  s_mov_b64 exec, -1
  s_waitcnt vmcnt(0)
C_NOSIG_f:
  v_and_b32 v34, 1, v21
  s_and_b32 s50, s3, 1
  s_lshl_b32 s50, s50, 1
  s_lshr_b32 s51, s3, 1
  s_lshl_b32 s51, s51, 2
  s_add_u32 s50, s50, s51
  v_add_u32 v34, s50, v34
  v_lshlrev_b32 v34, 1, v34
  v_xor_b32 v34, v34, v22
  v_lshlrev_b32 v34, 4, v34
  v_lshlrev_b32 v35, 13, v21
  v_add_u32 v32, v34, v35
  v_lshrrev_b32 v34, 5, v20
  s_and_b32 s50, s3, 1
  s_lshl_b32 s50, s50, 1
  v_add_u32 v34, s50, v34
  v_lshlrev_b32 v34, 1, v34
  v_and_b32 v35, 7, v20
  v_xor_b32 v34, v34, v35
  v_lshlrev_b32 v34, 4, v34
  v_lshrrev_b32 v35, 3, v20
  v_mul_u32_u24 v35, 1152, v35
  v_add_u32 v33, v34, v35
  s_mov_b32 s56, s36
  s_mov_b32 s57, s37
  s_mov_b32 s58, 4718592
  s_mov_b32 s59, 0x00020000
  s_mov_b32 s60, s38
  s_mov_b32 s61, s39
  s_mov_b32 s62, 4718592
  s_mov_b32 s63, 0x00020000
  s_mov_b32 s64, s40
  s_mov_b32 s65, s41
  s_mov_b32 s66, 4718592
  s_mov_b32 s67, 0x00020000
  s_mov_b32 s68, s42
  s_mov_b32 s69, s43
  s_mov_b32 s70, 4718592
  s_mov_b32 s71, 0x00020000
  s_lshl_b32 s50, s20, 8
  s_lshl_b32 s51, s3, 15
  s_add_u32 s50, s50, s51
  s_lshl_b32 s51, s3, 10
  s_mul_i32 s72, s20, 147456
  s_mul_i32 s73, s3, 18432
  s_add_u32 s72, s72, s73
  s_lshl_b32 s73, s3, 11
  v_lshrrev_b32 v34, 1, v21
  v_lshlrev_b32 v34, 4, v34
  v_and_b32 v35, 1, v21
  v_lshlrev_b32 v36, 2, v35
  v_add_u32 v34, v34, v36
  v_lshrrev_b32 v36, 1, v24
  v_lshlrev_b32 v37, 3, v36
  v_add_u32 v34, v34, v37
  v_and_b32 v37, 1, v24
  v_add_u32 v34, v34, v37
  v_lshlrev_b32 v34, 8, v34
  v_lshlrev_b32 v35, 1, v35
  v_add_u32 v35, v35, v37
  v_lshlrev_b32 v36, 2, v36
  v_add_u32 v35, v35, v36
  v_lshlrev_b32 v35, 1, v35
  v_and_b32 v36, 1, v23
  v_lshlrev_b32 v36, 3, v36
  v_add_u32 v34, v34, v36
  v_lshrrev_b32 v36, 1, v23
  s_lshl_b32 s74, s3, 2
  s_add_u32 s74, s74, 0
  v_add_u32 v37, s74, v36
  v_xor_b32 v37, v37, v35
  v_lshlrev_b32 v37, 4, v37
  v_add_u32 v10, v34, v37
  s_lshl_b32 s74, s3, 2
  s_add_u32 s74, s74, 2
  v_add_u32 v37, s74, v36
  v_xor_b32 v37, v37, v35
  v_lshlrev_b32 v37, 4, v37
  v_add_u32 v11, v34, v37
  v_and_b32 v34, 1, v21
  v_lshlrev_b32 v35, 4, v34
  v_lshrrev_b32 v37, 1, v21
  v_lshlrev_b32 v37, 3, v37
  v_add_u32 v35, v35, v37
  v_lshrrev_b32 v37, 1, v24
  v_lshlrev_b32 v39, 2, v37
  v_add_u32 v35, v35, v39
  v_and_b32 v39, 1, v24
  v_add_u32 v35, v35, v39
  v_lshlrev_b32 v38, 7, v35
  v_lshlrev_b32 v34, 1, v34
  v_add_u32 v39, v34, v37
  v_and_b32 v34, 1, v23
  v_lshlrev_b32 v34, 3, v34
  v_add_u32 v38, v38, v34
  v_lshlrev_b32 v34, 4, v36
  v_add_u32 v38, v38, v34
  s_add_u32 s74, s50, 0
  s_add_u32 m0, s51, 0
  s_nop 0
  buffer_load_dwordx4 v32, s[56:59], s74 offen lds
  s_add_u32 s74, s50, 131072
  s_add_u32 m0, s51, 4096
  s_nop 0
  buffer_load_dwordx4 v32, s[56:59], s74 offen lds
  s_add_u32 s74, s50, 262144
  s_add_u32 m0, s51, 8192
  s_nop 0
  buffer_load_dwordx4 v32, s[56:59], s74 offen lds
  s_add_u32 s74, s50, 393216
  s_add_u32 m0, s51, 12288
  s_nop 0
  buffer_load_dwordx4 v32, s[56:59], s74 offen lds
  s_add_u32 s74, s50, 524288
  s_add_u32 m0, s51, 16384
  s_nop 0
  buffer_load_dwordx4 v32, s[56:59], s74 offen lds
  s_add_u32 s74, s50, 655360
  s_add_u32 m0, s51, 20480
  s_nop 0
  buffer_load_dwordx4 v32, s[56:59], s74 offen lds
  s_add_u32 s74, s50, 786432
  s_add_u32 m0, s51, 24576
  s_nop 0
  buffer_load_dwordx4 v32, s[56:59], s74 offen lds
  s_add_u32 s74, s50, 917504
  s_add_u32 m0, s51, 28672
  s_nop 0
  buffer_load_dwordx4 v32, s[56:59], s74 offen lds
  s_add_u32 s74, s50, 1048576
  s_add_u32 m0, s51, 32768
  s_nop 0
  buffer_load_dwordx4 v32, s[56:59], s74 offen lds
  s_add_u32 s74, s50, 1179648
  s_add_u32 m0, s51, 36864
  s_nop 0
  buffer_load_dwordx4 v32, s[56:59], s74 offen lds
  s_add_u32 s74, s50, 1310720
  s_add_u32 m0, s51, 40960
  s_nop 0
  buffer_load_dwordx4 v32, s[56:59], s74 offen lds
  s_add_u32 s74, s50, 1441792
  s_add_u32 m0, s51, 45056
  s_nop 0
  buffer_load_dwordx4 v32, s[56:59], s74 offen lds
  s_add_u32 s74, s50, 1572864
  s_add_u32 m0, s51, 49152
  s_nop 0
  buffer_load_dwordx4 v32, s[56:59], s74 offen lds
  s_add_u32 s74, s50, 1703936
  s_add_u32 m0, s51, 53248
  s_nop 0
  buffer_load_dwordx4 v32, s[56:59], s74 offen lds
  s_add_u32 s74, s50, 1835008
  s_add_u32 m0, s51, 57344
  s_nop 0
  buffer_load_dwordx4 v32, s[56:59], s74 offen lds
  s_add_u32 s74, s50, 1966080
  s_add_u32 m0, s51, 61440
  s_nop 0
  buffer_load_dwordx4 v32, s[56:59], s74 offen lds
  s_add_u32 s74, s50, 2097152
  s_add_u32 m0, s51, 65536
  s_nop 0
  buffer_load_dwordx4 v32, s[56:59], s74 offen lds
  s_add_u32 s74, s50, 2228224
  s_add_u32 m0, s51, 69632
  s_nop 0
  buffer_load_dwordx4 v32, s[56:59], s74 offen lds
  s_add_u32 s74, s50, 2359296
  s_add_u32 m0, s51, 73728
  s_nop 0
  buffer_load_dwordx4 v32, s[56:59], s74 offen lds
  s_add_u32 s74, s50, 2490368
  s_add_u32 m0, s51, 77824
  s_nop 0
  buffer_load_dwordx4 v32, s[56:59], s74 offen lds
  s_add_u32 s74, s50, 2621440
  s_add_u32 m0, s51, 81920
  s_nop 0
  buffer_load_dwordx4 v32, s[56:59], s74 offen lds
  s_add_u32 s74, s50, 2752512
  s_add_u32 m0, s51, 86016
  s_nop 0
  buffer_load_dwordx4 v32, s[56:59], s74 offen lds
  s_add_u32 s74, s50, 2883584
  s_add_u32 m0, s51, 90112
  s_nop 0
  buffer_load_dwordx4 v32, s[56:59], s74 offen lds
  s_add_u32 s74, s50, 3014656
  s_add_u32 m0, s51, 94208
  s_nop 0
  buffer_load_dwordx4 v32, s[56:59], s74 offen lds
  s_add_u32 s74, s50, 3145728
  s_add_u32 m0, s51, 98304
  s_nop 0
  buffer_load_dwordx4 v32, s[56:59], s74 offen lds
  s_add_u32 s74, s50, 3276800
  s_add_u32 m0, s51, 102400
  s_nop 0
  buffer_load_dwordx4 v32, s[56:59], s74 offen lds
  s_add_u32 s74, s50, 3407872
  s_add_u32 m0, s51, 106496
  s_nop 0
  buffer_load_dwordx4 v32, s[56:59], s74 offen lds
  s_add_u32 s74, s50, 3538944
  s_add_u32 m0, s51, 110592
  s_nop 0
  buffer_load_dwordx4 v32, s[56:59], s74 offen lds
  s_add_u32 s74, s50, 3670016
  s_add_u32 m0, s51, 114688
  s_nop 0
  buffer_load_dwordx4 v32, s[56:59], s74 offen lds
  s_add_u32 s74, s50, 3801088
  s_add_u32 m0, s51, 118784
  s_nop 0
  buffer_load_dwordx4 v32, s[56:59], s74 offen lds
  s_add_u32 s74, s50, 3932160
  s_add_u32 m0, s51, 122880
  s_nop 0
  buffer_load_dwordx4 v32, s[56:59], s74 offen lds
  s_add_u32 s74, s50, 4063232
  s_add_u32 m0, s51, 126976
  s_nop 0
  buffer_load_dwordx4 v32, s[56:59], s74 offen lds
  s_add_u32 s74, s50, 4194304
  s_add_u32 m0, s51, 131072
  s_nop 0
  buffer_load_dwordx4 v32, s[56:59], s74 offen lds
  s_add_u32 s74, s50, 4325376
  s_add_u32 m0, s51, 135168
  s_nop 0
  buffer_load_dwordx4 v32, s[56:59], s74 offen lds
  s_add_u32 s74, s50, 4456448
  s_add_u32 m0, s51, 139264
  s_nop 0
  buffer_load_dwordx4 v32, s[56:59], s74 offen lds
  s_add_u32 s74, s50, 4587520
  s_add_u32 m0, s51, 143360
  s_nop 0
  buffer_load_dwordx4 v32, s[56:59], s74 offen lds
  s_waitcnt vmcnt(18)
  s_barrier
  ds_read_b64_tr_b16 a[0:1], v10 offset:0
  ds_read_b64_tr_b16 a[2:3], v10 offset:512
  ds_read_b64_tr_b16 a[72:73], v11 offset:0
  ds_read_b64_tr_b16 a[74:75], v11 offset:512
  ds_read_b64_tr_b16 a[4:5], v10 offset:8192
  ds_read_b64_tr_b16 a[6:7], v10 offset:8704
  ds_read_b64_tr_b16 a[76:77], v11 offset:8192
  ds_read_b64_tr_b16 a[78:79], v11 offset:8704
  ds_read_b64_tr_b16 a[8:9], v10 offset:16384
  ds_read_b64_tr_b16 a[10:11], v10 offset:16896
  ds_read_b64_tr_b16 a[80:81], v11 offset:16384
  ds_read_b64_tr_b16 a[82:83], v11 offset:16896
  ds_read_b64_tr_b16 a[12:13], v10 offset:24576
  ds_read_b64_tr_b16 a[14:15], v10 offset:25088
  ds_read_b64_tr_b16 a[84:85], v11 offset:24576
  ds_read_b64_tr_b16 a[86:87], v11 offset:25088
  ds_read_b64_tr_b16 a[16:17], v10 offset:32768
  ds_read_b64_tr_b16 a[18:19], v10 offset:33280
  ds_read_b64_tr_b16 a[88:89], v11 offset:32768
  ds_read_b64_tr_b16 a[90:91], v11 offset:33280
  ds_read_b64_tr_b16 a[20:21], v10 offset:40960
  ds_read_b64_tr_b16 a[22:23], v10 offset:41472
  ds_read_b64_tr_b16 a[92:93], v11 offset:40960
  ds_read_b64_tr_b16 a[94:95], v11 offset:41472
  ds_read_b64_tr_b16 a[24:25], v10 offset:49152
  ds_read_b64_tr_b16 a[26:27], v10 offset:49664
  ds_read_b64_tr_b16 a[96:97], v11 offset:49152
  ds_read_b64_tr_b16 a[98:99], v11 offset:49664
  ds_read_b64_tr_b16 a[28:29], v10 offset:57344
  ds_read_b64_tr_b16 a[30:31], v10 offset:57856
  ds_read_b64_tr_b16 a[100:101], v11 offset:57344
  ds_read_b64_tr_b16 a[102:103], v11 offset:57856
  v_add_u32 v40, 65536, v10
  ds_read_b64_tr_b16 a[32:33], v40 offset:0
  v_add_u32 v40, 65536, v10
  ds_read_b64_tr_b16 a[34:35], v40 offset:512
  v_add_u32 v40, 65536, v11
  ds_read_b64_tr_b16 a[104:105], v40 offset:0
  v_add_u32 v40, 65536, v11
  ds_read_b64_tr_b16 a[106:107], v40 offset:512
  s_waitcnt lgkmcnt(0)
  s_barrier
  s_add_u32 s74, s50, 0
  s_add_u32 m0, s51, 0
  s_nop 0
  buffer_load_dwordx4 v32, s[60:63], s74 offen lds
  s_add_u32 s74, s50, 131072
  s_add_u32 m0, s51, 4096
  s_nop 0
  buffer_load_dwordx4 v32, s[60:63], s74 offen lds
  s_add_u32 s74, s50, 262144
  s_add_u32 m0, s51, 8192
  s_nop 0
  buffer_load_dwordx4 v32, s[60:63], s74 offen lds
  s_add_u32 s74, s50, 393216
  s_add_u32 m0, s51, 12288
  s_nop 0
  buffer_load_dwordx4 v32, s[60:63], s74 offen lds
  s_add_u32 s74, s50, 524288
  s_add_u32 m0, s51, 16384
  s_nop 0
  buffer_load_dwordx4 v32, s[60:63], s74 offen lds
  s_add_u32 s74, s50, 655360
  s_add_u32 m0, s51, 20480
  s_nop 0
  buffer_load_dwordx4 v32, s[60:63], s74 offen lds
  s_add_u32 s74, s50, 786432
  s_add_u32 m0, s51, 24576
  s_nop 0
  buffer_load_dwordx4 v32, s[60:63], s74 offen lds
  s_add_u32 s74, s50, 917504
  s_add_u32 m0, s51, 28672
  s_nop 0
  buffer_load_dwordx4 v32, s[60:63], s74 offen lds
  s_add_u32 s74, s50, 1048576
  s_add_u32 m0, s51, 32768
  s_nop 0
  buffer_load_dwordx4 v32, s[60:63], s74 offen lds
  s_add_u32 s74, s50, 1179648
  s_add_u32 m0, s51, 36864
  s_nop 0
  buffer_load_dwordx4 v32, s[60:63], s74 offen lds
  s_add_u32 s74, s50, 1310720
  s_add_u32 m0, s51, 40960
  s_nop 0
  buffer_load_dwordx4 v32, s[60:63], s74 offen lds
  s_add_u32 s74, s50, 1441792
  s_add_u32 m0, s51, 45056
  s_nop 0
  buffer_load_dwordx4 v32, s[60:63], s74 offen lds
  s_add_u32 s74, s50, 1572864
  s_add_u32 m0, s51, 49152
  s_nop 0
  buffer_load_dwordx4 v32, s[60:63], s74 offen lds
  s_add_u32 s74, s50, 1703936
  s_add_u32 m0, s51, 53248
  s_nop 0
  buffer_load_dwordx4 v32, s[60:63], s74 offen lds
  s_add_u32 s74, s50, 1835008
  s_add_u32 m0, s51, 57344
  s_nop 0
  buffer_load_dwordx4 v32, s[60:63], s74 offen lds
  s_add_u32 s74, s50, 1966080
  s_add_u32 m0, s51, 61440
  s_nop 0
  buffer_load_dwordx4 v32, s[60:63], s74 offen lds
  s_add_u32 s74, s50, 2097152
  s_add_u32 m0, s51, 65536
  s_nop 0
  buffer_load_dwordx4 v32, s[60:63], s74 offen lds
  s_add_u32 s74, s50, 2228224
  s_add_u32 m0, s51, 69632
  s_nop 0
  buffer_load_dwordx4 v32, s[60:63], s74 offen lds
  s_waitcnt vmcnt(18)
  s_barrier
  v_add_u32 v40, 65536, v10
  ds_read_b64_tr_b16 a[36:37], v40 offset:8192
  v_add_u32 v40, 65536, v10
  ds_read_b64_tr_b16 a[38:39], v40 offset:8704
  v_add_u32 v40, 65536, v11
  ds_read_b64_tr_b16 a[108:109], v40 offset:8192
  v_add_u32 v40, 65536, v11
  ds_read_b64_tr_b16 a[110:111], v40 offset:8704
  v_add_u32 v40, 65536, v10
  ds_read_b64_tr_b16 a[40:41], v40 offset:16384
  v_add_u32 v40, 65536, v10
  ds_read_b64_tr_b16 a[42:43], v40 offset:16896
  v_add_u32 v40, 65536, v11
  ds_read_b64_tr_b16 a[112:113], v40 offset:16384
  v_add_u32 v40, 65536, v11
  ds_read_b64_tr_b16 a[114:115], v40 offset:16896
  v_add_u32 v40, 65536, v10
  ds_read_b64_tr_b16 a[44:45], v40 offset:24576
  v_add_u32 v40, 65536, v10
  ds_read_b64_tr_b16 a[46:47], v40 offset:25088
  v_add_u32 v40, 65536, v11
  ds_read_b64_tr_b16 a[116:117], v40 offset:24576
  v_add_u32 v40, 65536, v11
  ds_read_b64_tr_b16 a[118:119], v40 offset:25088
  v_add_u32 v40, 65536, v10
  ds_read_b64_tr_b16 a[48:49], v40 offset:32768
  v_add_u32 v40, 65536, v10
  ds_read_b64_tr_b16 a[50:51], v40 offset:33280
  v_add_u32 v40, 65536, v11
  ds_read_b64_tr_b16 a[120:121], v40 offset:32768
  v_add_u32 v40, 65536, v11
  ds_read_b64_tr_b16 a[122:123], v40 offset:33280
  v_add_u32 v40, 65536, v10
  ds_read_b64_tr_b16 a[52:53], v40 offset:40960
  v_add_u32 v40, 65536, v10
  ds_read_b64_tr_b16 a[54:55], v40 offset:41472
  v_add_u32 v40, 65536, v11
  ds_read_b64_tr_b16 a[124:125], v40 offset:40960
  v_add_u32 v40, 65536, v11
  ds_read_b64_tr_b16 a[126:127], v40 offset:41472
  v_add_u32 v40, 65536, v10
  ds_read_b64_tr_b16 a[56:57], v40 offset:49152
  v_add_u32 v40, 65536, v10
  ds_read_b64_tr_b16 a[58:59], v40 offset:49664
  v_add_u32 v40, 65536, v11
  ds_read_b64_tr_b16 a[128:129], v40 offset:49152
  v_add_u32 v40, 65536, v11
  ds_read_b64_tr_b16 a[130:131], v40 offset:49664
  v_add_u32 v40, 65536, v10
  ds_read_b64_tr_b16 a[60:61], v40 offset:57344
  v_add_u32 v40, 65536, v10
  ds_read_b64_tr_b16 a[62:63], v40 offset:57856
  v_add_u32 v40, 65536, v11
  ds_read_b64_tr_b16 a[132:133], v40 offset:57344
  v_add_u32 v40, 65536, v11
  ds_read_b64_tr_b16 a[134:135], v40 offset:57856
  v_add_u32 v40, 131072, v10
  ds_read_b64_tr_b16 a[64:65], v40 offset:0
  v_add_u32 v40, 131072, v10
  ds_read_b64_tr_b16 a[66:67], v40 offset:512
  v_add_u32 v40, 131072, v11
  ds_read_b64_tr_b16 a[136:137], v40 offset:0
  v_add_u32 v40, 131072, v11
  ds_read_b64_tr_b16 a[138:139], v40 offset:512
  v_add_u32 v40, 131072, v10
  ds_read_b64_tr_b16 a[68:69], v40 offset:8192
  v_add_u32 v40, 131072, v10
  ds_read_b64_tr_b16 a[70:71], v40 offset:8704
  v_add_u32 v40, 131072, v11
  ds_read_b64_tr_b16 a[140:141], v40 offset:8192
  v_add_u32 v40, 131072, v11
  ds_read_b64_tr_b16 a[142:143], v40 offset:8704
  s_waitcnt lgkmcnt(0)
  s_barrier
  s_add_u32 s74, s50, 2359296
  s_add_u32 m0, s51, 73728
  s_nop 0
  buffer_load_dwordx4 v32, s[60:63], s74 offen lds
  s_add_u32 s74, s50, 2490368
  s_add_u32 m0, s51, 77824
  s_nop 0
  buffer_load_dwordx4 v32, s[60:63], s74 offen lds
  s_add_u32 s74, s50, 2621440
  s_add_u32 m0, s51, 81920
  s_nop 0
  buffer_load_dwordx4 v32, s[60:63], s74 offen lds
  s_add_u32 s74, s50, 2752512
  s_add_u32 m0, s51, 86016
  s_nop 0
  buffer_load_dwordx4 v32, s[60:63], s74 offen lds
  s_add_u32 s74, s50, 2883584
  s_add_u32 m0, s51, 90112
  s_nop 0
  buffer_load_dwordx4 v32, s[60:63], s74 offen lds
  s_add_u32 s74, s50, 3014656
  s_add_u32 m0, s51, 94208
  s_nop 0
  buffer_load_dwordx4 v32, s[60:63], s74 offen lds
  s_add_u32 s74, s50, 3145728
  s_add_u32 m0, s51, 98304
  s_nop 0
  buffer_load_dwordx4 v32, s[60:63], s74 offen lds
  s_add_u32 s74, s50, 3276800
  s_add_u32 m0, s51, 102400
  s_nop 0
  buffer_load_dwordx4 v32, s[60:63], s74 offen lds
  s_add_u32 s74, s50, 3407872
  s_add_u32 m0, s51, 106496
  s_nop 0
  buffer_load_dwordx4 v32, s[60:63], s74 offen lds
  s_add_u32 s74, s50, 3538944
  s_add_u32 m0, s51, 110592
  s_nop 0
  buffer_load_dwordx4 v32, s[60:63], s74 offen lds
  s_add_u32 s74, s50, 3670016
  s_add_u32 m0, s51, 114688
  s_nop 0
  buffer_load_dwordx4 v32, s[60:63], s74 offen lds
  s_add_u32 s74, s50, 3801088
  s_add_u32 m0, s51, 118784
  s_nop 0
  buffer_load_dwordx4 v32, s[60:63], s74 offen lds
  s_add_u32 s74, s50, 3932160
  s_add_u32 m0, s51, 122880
  s_nop 0
  buffer_load_dwordx4 v32, s[60:63], s74 offen lds
  s_add_u32 s74, s50, 4063232
  s_add_u32 m0, s51, 126976
  s_nop 0
  buffer_load_dwordx4 v32, s[60:63], s74 offen lds
  s_add_u32 s74, s50, 4194304
  s_add_u32 m0, s51, 131072
  s_nop 0
  buffer_load_dwordx4 v32, s[60:63], s74 offen lds
  s_add_u32 s74, s50, 4325376
  s_add_u32 m0, s51, 135168
  s_nop 0
  buffer_load_dwordx4 v32, s[60:63], s74 offen lds
  s_add_u32 s74, s50, 4456448
  s_add_u32 m0, s51, 139264
  s_nop 0
  buffer_load_dwordx4 v32, s[60:63], s74 offen lds
  s_add_u32 s74, s50, 4587520
  s_add_u32 m0, s51, 143360
  s_nop 0
  buffer_load_dwordx4 v32, s[60:63], s74 offen lds
  s_waitcnt vmcnt(18)
  s_barrier
  ds_read_b64_tr_b16 a[144:145], v10 offset:0
  ds_read_b64_tr_b16 a[146:147], v10 offset:512
  ds_read_b64_tr_b16 a[216:217], v11 offset:0
  ds_read_b64_tr_b16 a[218:219], v11 offset:512
  ds_read_b64_tr_b16 a[148:149], v10 offset:8192
  ds_read_b64_tr_b16 a[150:151], v10 offset:8704
  ds_read_b64_tr_b16 a[220:221], v11 offset:8192
  ds_read_b64_tr_b16 a[222:223], v11 offset:8704
  ds_read_b64_tr_b16 a[152:153], v10 offset:16384
  ds_read_b64_tr_b16 a[154:155], v10 offset:16896
  ds_read_b64_tr_b16 a[224:225], v11 offset:16384
  ds_read_b64_tr_b16 a[226:227], v11 offset:16896
  ds_read_b64_tr_b16 a[156:157], v10 offset:24576
  ds_read_b64_tr_b16 a[158:159], v10 offset:25088
  ds_read_b64_tr_b16 a[228:229], v11 offset:24576
  ds_read_b64_tr_b16 a[230:231], v11 offset:25088
  ds_read_b64_tr_b16 a[160:161], v10 offset:32768
  ds_read_b64_tr_b16 a[162:163], v10 offset:33280
  ds_read_b64_tr_b16 a[232:233], v11 offset:32768
  ds_read_b64_tr_b16 a[234:235], v11 offset:33280
  ds_read_b64_tr_b16 a[164:165], v10 offset:40960
  ds_read_b64_tr_b16 a[166:167], v10 offset:41472
  ds_read_b64_tr_b16 a[236:237], v11 offset:40960
  ds_read_b64_tr_b16 a[238:239], v11 offset:41472
  ds_read_b64_tr_b16 a[168:169], v10 offset:49152
  ds_read_b64_tr_b16 a[170:171], v10 offset:49664
  ds_read_b64_tr_b16 a[240:241], v11 offset:49152
  ds_read_b64_tr_b16 a[242:243], v11 offset:49664
  ds_read_b64_tr_b16 a[172:173], v10 offset:57344
  ds_read_b64_tr_b16 a[174:175], v10 offset:57856
  ds_read_b64_tr_b16 a[244:245], v11 offset:57344
  ds_read_b64_tr_b16 a[246:247], v11 offset:57856
  v_add_u32 v40, 65536, v10
  ds_read_b64_tr_b16 a[176:177], v40 offset:0
  v_add_u32 v40, 65536, v10
  ds_read_b64_tr_b16 a[178:179], v40 offset:512
  v_add_u32 v40, 65536, v11
  ds_read_b64_tr_b16 a[248:249], v40 offset:0
  v_add_u32 v40, 65536, v11
  ds_read_b64_tr_b16 a[250:251], v40 offset:512
  s_waitcnt lgkmcnt(0)
  s_barrier
  s_add_u32 s74, s72, 0
  s_add_u32 m0, s73, 0
  s_nop 0
  buffer_load_dwordx4 v33, s[68:71], s74 offen lds
  s_add_u32 s74, s72, 9216
  s_add_u32 m0, s73, 1024
  s_nop 0
  buffer_load_dwordx4 v33, s[68:71], s74 offen lds
  s_add_u32 s74, s72, 128
  s_add_u32 m0, s73, 8192
  s_nop 0
  buffer_load_dwordx4 v33, s[68:71], s74 offen lds
  s_add_u32 s74, s72, 9344
  s_add_u32 m0, s73, 9216
  s_nop 0
  buffer_load_dwordx4 v33, s[68:71], s74 offen lds
  s_add_u32 s74, s72, 256
  s_add_u32 m0, s73, 16384
  s_nop 0
  buffer_load_dwordx4 v33, s[68:71], s74 offen lds
  s_add_u32 s74, s72, 9472
  s_add_u32 m0, s73, 17408
  s_nop 0
  buffer_load_dwordx4 v33, s[68:71], s74 offen lds
  s_add_u32 s74, s72, 384
  s_add_u32 m0, s73, 24576
  s_nop 0
  buffer_load_dwordx4 v33, s[68:71], s74 offen lds
  s_add_u32 s74, s72, 9600
  s_add_u32 m0, s73, 25600
  s_nop 0
  buffer_load_dwordx4 v33, s[68:71], s74 offen lds
  s_add_u32 s74, s72, 512
  s_add_u32 m0, s73, 32768
  s_nop 0
  buffer_load_dwordx4 v33, s[68:71], s74 offen lds
  s_add_u32 s74, s72, 9728
  s_add_u32 m0, s73, 33792
  s_nop 0
  buffer_load_dwordx4 v33, s[68:71], s74 offen lds
  s_add_u32 s74, s72, 640
  s_add_u32 m0, s73, 40960
  s_nop 0
  buffer_load_dwordx4 v33, s[68:71], s74 offen lds
  s_add_u32 s74, s72, 9856
  s_add_u32 m0, s73, 41984
  s_nop 0
  buffer_load_dwordx4 v33, s[68:71], s74 offen lds
  s_add_u32 s74, s72, 768
  s_add_u32 m0, s73, 49152
  s_nop 0
  buffer_load_dwordx4 v33, s[68:71], s74 offen lds
  s_add_u32 s74, s72, 9984
  s_add_u32 m0, s73, 50176
  s_nop 0
  buffer_load_dwordx4 v33, s[68:71], s74 offen lds
  s_add_u32 s74, s72, 896
  s_add_u32 m0, s73, 57344
  s_nop 0
  buffer_load_dwordx4 v33, s[68:71], s74 offen lds
  s_add_u32 s74, s72, 10112
  s_add_u32 m0, s73, 58368
  s_nop 0
  buffer_load_dwordx4 v33, s[68:71], s74 offen lds
  s_add_u32 s74, s72, 1024
  s_add_u32 m0, s73, 65536
  s_nop 0
  buffer_load_dwordx4 v33, s[68:71], s74 offen lds
  s_add_u32 s74, s72, 10240
  s_add_u32 m0, s73, 66560
  s_nop 0
  buffer_load_dwordx4 v33, s[68:71], s74 offen lds
  s_waitcnt vmcnt(18)
  s_barrier
  v_add_u32 v40, 65536, v10
  ds_read_b64_tr_b16 a[180:181], v40 offset:8192
  v_add_u32 v40, 65536, v10
  ds_read_b64_tr_b16 a[182:183], v40 offset:8704
  v_add_u32 v40, 65536, v11
  ds_read_b64_tr_b16 a[252:253], v40 offset:8192
  v_add_u32 v40, 65536, v11
  ds_read_b64_tr_b16 a[254:255], v40 offset:8704
  v_add_u32 v40, 65536, v10
  ds_read_b64_tr_b16 a[184:185], v40 offset:16384
  v_add_u32 v40, 65536, v10
  ds_read_b64_tr_b16 a[186:187], v40 offset:16896
  v_add_u32 v40, 65536, v11
  ds_read_b64_tr_b16 v[80:81], v40 offset:16384
  v_add_u32 v40, 65536, v11
  ds_read_b64_tr_b16 v[82:83], v40 offset:16896
  v_add_u32 v40, 65536, v10
  ds_read_b64_tr_b16 a[188:189], v40 offset:24576
  v_add_u32 v40, 65536, v10
  ds_read_b64_tr_b16 a[190:191], v40 offset:25088
  v_add_u32 v40, 65536, v11
  ds_read_b64_tr_b16 v[84:85], v40 offset:24576
  v_add_u32 v40, 65536, v11
  ds_read_b64_tr_b16 v[86:87], v40 offset:25088
  v_add_u32 v40, 65536, v10
  ds_read_b64_tr_b16 a[192:193], v40 offset:32768
  v_add_u32 v40, 65536, v10
  ds_read_b64_tr_b16 a[194:195], v40 offset:33280
  v_add_u32 v40, 65536, v11
  ds_read_b64_tr_b16 v[88:89], v40 offset:32768
  v_add_u32 v40, 65536, v11
  ds_read_b64_tr_b16 v[90:91], v40 offset:33280
  v_add_u32 v40, 65536, v10
  ds_read_b64_tr_b16 a[196:197], v40 offset:40960
  v_add_u32 v40, 65536, v10
  ds_read_b64_tr_b16 a[198:199], v40 offset:41472
  v_add_u32 v40, 65536, v11
  ds_read_b64_tr_b16 v[92:93], v40 offset:40960
  v_add_u32 v40, 65536, v11
  ds_read_b64_tr_b16 v[94:95], v40 offset:41472
  v_add_u32 v40, 65536, v10
  ds_read_b64_tr_b16 a[200:201], v40 offset:49152
  v_add_u32 v40, 65536, v10
  ds_read_b64_tr_b16 a[202:203], v40 offset:49664
  v_add_u32 v40, 65536, v11
  ds_read_b64_tr_b16 v[96:97], v40 offset:49152
  v_add_u32 v40, 65536, v11
  ds_read_b64_tr_b16 v[98:99], v40 offset:49664
  v_add_u32 v40, 65536, v10
  ds_read_b64_tr_b16 a[204:205], v40 offset:57344
  v_add_u32 v40, 65536, v10
  ds_read_b64_tr_b16 a[206:207], v40 offset:57856
  v_add_u32 v40, 65536, v11
  ds_read_b64_tr_b16 v[100:101], v40 offset:57344
  v_add_u32 v40, 65536, v11
  ds_read_b64_tr_b16 v[102:103], v40 offset:57856
  v_add_u32 v40, 131072, v10
  ds_read_b64_tr_b16 a[208:209], v40 offset:0
  v_add_u32 v40, 131072, v10
  ds_read_b64_tr_b16 a[210:211], v40 offset:512
  v_add_u32 v40, 131072, v11
  ds_read_b64_tr_b16 v[104:105], v40 offset:0
  v_add_u32 v40, 131072, v11
  ds_read_b64_tr_b16 v[106:107], v40 offset:512
  v_add_u32 v40, 131072, v10
  ds_read_b64_tr_b16 a[212:213], v40 offset:8192
  v_add_u32 v40, 131072, v10
  ds_read_b64_tr_b16 a[214:215], v40 offset:8704
  v_add_u32 v40, 131072, v11
  ds_read_b64_tr_b16 v[108:109], v40 offset:8192
  v_add_u32 v40, 131072, v11
  ds_read_b64_tr_b16 v[110:111], v40 offset:8704
  s_waitcnt lgkmcnt(0)
  s_barrier
  s_add_u32 s74, s72, 73728
  s_add_u32 m0, s73, 73728
  s_nop 0
  buffer_load_dwordx4 v33, s[68:71], s74 offen lds
  s_add_u32 s74, s72, 82944
  s_add_u32 m0, s73, 74752
  s_nop 0
  buffer_load_dwordx4 v33, s[68:71], s74 offen lds
  s_add_u32 s74, s72, 73856
  s_add_u32 m0, s73, 81920
  s_nop 0
  buffer_load_dwordx4 v33, s[68:71], s74 offen lds
  s_add_u32 s74, s72, 83072
  s_add_u32 m0, s73, 82944
  s_nop 0
  buffer_load_dwordx4 v33, s[68:71], s74 offen lds
  s_add_u32 s74, s72, 73984
  s_add_u32 m0, s73, 90112
  s_nop 0
  buffer_load_dwordx4 v33, s[68:71], s74 offen lds
  s_add_u32 s74, s72, 83200
  s_add_u32 m0, s73, 91136
  s_nop 0
  buffer_load_dwordx4 v33, s[68:71], s74 offen lds
  s_add_u32 s74, s72, 74112
  s_add_u32 m0, s73, 98304
  s_nop 0
  buffer_load_dwordx4 v33, s[68:71], s74 offen lds
  s_add_u32 s74, s72, 83328
  s_add_u32 m0, s73, 99328
  s_nop 0
  buffer_load_dwordx4 v33, s[68:71], s74 offen lds
  s_add_u32 s74, s72, 74240
  s_add_u32 m0, s73, 106496
  s_nop 0
  buffer_load_dwordx4 v33, s[68:71], s74 offen lds
  s_add_u32 s74, s72, 83456
  s_add_u32 m0, s73, 107520
  s_nop 0
  buffer_load_dwordx4 v33, s[68:71], s74 offen lds
  s_add_u32 s74, s72, 74368
  s_add_u32 m0, s73, 114688
  s_nop 0
  buffer_load_dwordx4 v33, s[68:71], s74 offen lds
  s_add_u32 s74, s72, 83584
  s_add_u32 m0, s73, 115712
  s_nop 0
  buffer_load_dwordx4 v33, s[68:71], s74 offen lds
  s_add_u32 s74, s72, 74496
  s_add_u32 m0, s73, 122880
  s_nop 0
  buffer_load_dwordx4 v33, s[68:71], s74 offen lds
  s_add_u32 s74, s72, 83712
  s_add_u32 m0, s73, 123904
  s_nop 0
  buffer_load_dwordx4 v33, s[68:71], s74 offen lds
  s_add_u32 s74, s72, 74624
  s_add_u32 m0, s73, 131072
  s_nop 0
  buffer_load_dwordx4 v33, s[68:71], s74 offen lds
  s_add_u32 s74, s72, 83840
  s_add_u32 m0, s73, 132096
  s_nop 0
  buffer_load_dwordx4 v33, s[68:71], s74 offen lds
  s_add_u32 s74, s72, 74752
  s_add_u32 m0, s73, 139264
  s_nop 0
  buffer_load_dwordx4 v33, s[68:71], s74 offen lds
  s_add_u32 s74, s72, 83968
  s_add_u32 m0, s73, 140288
  s_nop 0
  buffer_load_dwordx4 v33, s[68:71], s74 offen lds
  s_waitcnt vmcnt(18)
  s_barrier
  s_mul_i32 s74, s3, 9
  s_add_u32 s74, s74, 0
  s_and_b32 s75, s74, 3
  s_lshr_b32 s74, s74, 2
  s_lshl_b32 s74, s74, 13
  s_add_u32 s74, s74, 0
  v_xor_b32 v41, s75, v39
  v_lshlrev_b32 v41, 5, v41
  v_add_u32 v41, v41, v38
  v_add_u32 v41, s74, v41
  ds_read_b64_tr_b16 v[112:113], v41 offset:0
  ds_read_b64_tr_b16 v[114:115], v41 offset:256
  ds_read_b64_tr_b16 v[116:117], v41 offset:4096
  ds_read_b64_tr_b16 v[118:119], v41 offset:4352
  s_mul_i32 s74, s3, 9
  s_add_u32 s74, s74, 1
  s_and_b32 s75, s74, 3
  s_lshr_b32 s74, s74, 2
  s_lshl_b32 s74, s74, 13
  s_add_u32 s74, s74, 0
  v_xor_b32 v41, s75, v39
  v_lshlrev_b32 v41, 5, v41
  v_add_u32 v41, v41, v38
  v_add_u32 v41, s74, v41
  ds_read_b64_tr_b16 v[128:129], v41 offset:0
  ds_read_b64_tr_b16 v[130:131], v41 offset:256
  ds_read_b64_tr_b16 v[132:133], v41 offset:4096
  ds_read_b64_tr_b16 v[134:135], v41 offset:4352
  s_mul_i32 s74, s3, 9
  s_add_u32 s74, s74, 2
  s_and_b32 s75, s74, 3
  s_lshr_b32 s74, s74, 2
  s_lshl_b32 s74, s74, 13
  s_add_u32 s74, s74, 0
  v_xor_b32 v41, s75, v39
  v_lshlrev_b32 v41, 5, v41
  v_add_u32 v41, v41, v38
  v_add_u32 v41, s74, v41
  ds_read_b64_tr_b16 v[144:145], v41 offset:0
  ds_read_b64_tr_b16 v[146:147], v41 offset:256
  ds_read_b64_tr_b16 v[148:149], v41 offset:4096
  ds_read_b64_tr_b16 v[150:151], v41 offset:4352
  s_mul_i32 s74, s3, 9
  s_add_u32 s74, s74, 3
  s_and_b32 s75, s74, 3
  s_lshr_b32 s74, s74, 2
  s_lshl_b32 s74, s74, 13
  s_add_u32 s74, s74, 0
  v_xor_b32 v41, s75, v39
  v_lshlrev_b32 v41, 5, v41
  v_add_u32 v41, v41, v38
  v_add_u32 v41, s74, v41
  ds_read_b64_tr_b16 v[160:161], v41 offset:0
  ds_read_b64_tr_b16 v[162:163], v41 offset:256
  ds_read_b64_tr_b16 v[164:165], v41 offset:4096
  ds_read_b64_tr_b16 v[166:167], v41 offset:4352
  s_mul_i32 s74, s3, 9
  s_add_u32 s74, s74, 4
  s_and_b32 s75, s74, 3
  s_lshr_b32 s74, s74, 2
  s_lshl_b32 s74, s74, 13
  s_add_u32 s74, s74, 0
  v_xor_b32 v41, s75, v39
  v_lshlrev_b32 v41, 5, v41
  v_add_u32 v41, v41, v38
  v_add_u32 v41, s74, v41
  ds_read_b64_tr_b16 v[176:177], v41 offset:0
  ds_read_b64_tr_b16 v[178:179], v41 offset:256
  ds_read_b64_tr_b16 v[180:181], v41 offset:4096
  ds_read_b64_tr_b16 v[182:183], v41 offset:4352
  s_mul_i32 s74, s3, 9
  s_add_u32 s74, s74, 5
  s_and_b32 s75, s74, 3
  s_lshr_b32 s74, s74, 2
  s_lshl_b32 s74, s74, 13
  s_add_u32 s74, s74, 0
  v_xor_b32 v41, s75, v39
  v_lshlrev_b32 v41, 5, v41
  v_add_u32 v41, v41, v38
  v_add_u32 v41, s74, v41
  ds_read_b64_tr_b16 v[192:193], v41 offset:0
  ds_read_b64_tr_b16 v[194:195], v41 offset:256
  ds_read_b64_tr_b16 v[196:197], v41 offset:4096
  ds_read_b64_tr_b16 v[198:199], v41 offset:4352
  s_mul_i32 s74, s3, 9
  s_add_u32 s74, s74, 6
  s_and_b32 s75, s74, 3
  s_lshr_b32 s74, s74, 2
  s_lshl_b32 s74, s74, 13
  s_add_u32 s74, s74, 0
  v_xor_b32 v41, s75, v39
  v_lshlrev_b32 v41, 5, v41
  v_add_u32 v41, v41, v38
  v_add_u32 v41, s74, v41
  ds_read_b64_tr_b16 v[208:209], v41 offset:0
  ds_read_b64_tr_b16 v[210:211], v41 offset:256
  ds_read_b64_tr_b16 v[212:213], v41 offset:4096
  ds_read_b64_tr_b16 v[214:215], v41 offset:4352
  s_mul_i32 s74, s3, 9
  s_add_u32 s74, s74, 7
  s_and_b32 s75, s74, 3
  s_lshr_b32 s74, s74, 2
  s_lshl_b32 s74, s74, 13
  s_add_u32 s74, s74, 0
  v_xor_b32 v41, s75, v39
  v_lshlrev_b32 v41, 5, v41
  v_add_u32 v41, v41, v38
  v_add_u32 v41, s74, v41
  ds_read_b64_tr_b16 v[224:225], v41 offset:0
  ds_read_b64_tr_b16 v[226:227], v41 offset:256
  ds_read_b64_tr_b16 v[228:229], v41 offset:4096
  ds_read_b64_tr_b16 v[230:231], v41 offset:4352
  s_mul_i32 s74, s3, 9
  s_add_u32 s74, s74, 8
  s_and_b32 s75, s74, 3
  s_lshr_b32 s74, s74, 2
  s_lshl_b32 s74, s74, 13
  s_add_u32 s74, s74, 0
  v_xor_b32 v41, s75, v39
  v_lshlrev_b32 v41, 5, v41
  v_add_u32 v41, v41, v38
  v_add_u32 v41, s74, v41
  ds_read_b64_tr_b16 v[240:241], v41 offset:0
  ds_read_b64_tr_b16 v[242:243], v41 offset:256
  ds_read_b64_tr_b16 v[244:245], v41 offset:4096
  ds_read_b64_tr_b16 v[246:247], v41 offset:4352
  s_waitcnt lgkmcnt(0)
  s_barrier
  s_add_u32 s74, s50, 0
  s_add_u32 m0, s51, 0
  s_nop 0
  buffer_load_dwordx4 v32, s[64:67], s74 offen lds
  s_add_u32 s74, s50, 131072
  s_add_u32 m0, s51, 4096
  s_nop 0
  buffer_load_dwordx4 v32, s[64:67], s74 offen lds
  s_add_u32 s74, s50, 262144
  s_add_u32 m0, s51, 8192
  s_nop 0
  buffer_load_dwordx4 v32, s[64:67], s74 offen lds
  s_add_u32 s74, s50, 393216
  s_add_u32 m0, s51, 12288
  s_nop 0
  buffer_load_dwordx4 v32, s[64:67], s74 offen lds
  s_add_u32 s74, s50, 524288
  s_add_u32 m0, s51, 16384
  s_nop 0
  buffer_load_dwordx4 v32, s[64:67], s74 offen lds
  s_add_u32 s74, s50, 655360
  s_add_u32 m0, s51, 20480
  s_nop 0
  buffer_load_dwordx4 v32, s[64:67], s74 offen lds
  s_add_u32 s74, s50, 786432
  s_add_u32 m0, s51, 24576
  s_nop 0
  buffer_load_dwordx4 v32, s[64:67], s74 offen lds
  s_add_u32 s74, s50, 917504
  s_add_u32 m0, s51, 28672
  s_nop 0
  buffer_load_dwordx4 v32, s[64:67], s74 offen lds
  s_add_u32 s74, s50, 1048576
  s_add_u32 m0, s51, 32768
  s_nop 0
  buffer_load_dwordx4 v32, s[64:67], s74 offen lds
  s_add_u32 s74, s50, 1179648
  s_add_u32 m0, s51, 36864
  s_nop 0
  buffer_load_dwordx4 v32, s[64:67], s74 offen lds
  s_add_u32 s74, s50, 1310720
  s_add_u32 m0, s51, 40960
  s_nop 0
  buffer_load_dwordx4 v32, s[64:67], s74 offen lds
  s_add_u32 s74, s50, 1441792
  s_add_u32 m0, s51, 45056
  s_nop 0
  buffer_load_dwordx4 v32, s[64:67], s74 offen lds
  s_add_u32 s74, s50, 1572864
  s_add_u32 m0, s51, 49152
  s_nop 0
  buffer_load_dwordx4 v32, s[64:67], s74 offen lds
  s_add_u32 s74, s50, 1703936
  s_add_u32 m0, s51, 53248
  s_nop 0
  buffer_load_dwordx4 v32, s[64:67], s74 offen lds
  s_add_u32 s74, s50, 1835008
  s_add_u32 m0, s51, 57344
  s_nop 0
  buffer_load_dwordx4 v32, s[64:67], s74 offen lds
  s_add_u32 s74, s50, 1966080
  s_add_u32 m0, s51, 61440
  s_nop 0
  buffer_load_dwordx4 v32, s[64:67], s74 offen lds
  s_add_u32 s74, s50, 2097152
  s_add_u32 m0, s51, 65536
  s_nop 0
  buffer_load_dwordx4 v32, s[64:67], s74 offen lds
  s_add_u32 s74, s50, 2228224
  s_add_u32 m0, s51, 69632
  s_nop 0
  buffer_load_dwordx4 v32, s[64:67], s74 offen lds
  s_waitcnt vmcnt(18)
  s_barrier
  s_mul_i32 s74, s3, 9
  s_add_u32 s74, s74, 0
  s_and_b32 s75, s74, 3
  s_lshr_b32 s74, s74, 2
  s_lshl_b32 s74, s74, 13
  s_add_u32 s74, s74, 73728
  v_xor_b32 v41, s75, v39
  v_lshlrev_b32 v41, 5, v41
  v_add_u32 v41, v41, v38
  v_add_u32 v41, s74, v41
  ds_read_b64_tr_b16 v[120:121], v41 offset:0
  ds_read_b64_tr_b16 v[122:123], v41 offset:256
  ds_read_b64_tr_b16 v[124:125], v41 offset:4096
  ds_read_b64_tr_b16 v[126:127], v41 offset:4352
  s_mul_i32 s74, s3, 9
  s_add_u32 s74, s74, 1
  s_and_b32 s75, s74, 3
  s_lshr_b32 s74, s74, 2
  s_lshl_b32 s74, s74, 13
  s_add_u32 s74, s74, 73728
  v_xor_b32 v41, s75, v39
  v_lshlrev_b32 v41, 5, v41
  v_add_u32 v41, v41, v38
  v_add_u32 v41, s74, v41
  ds_read_b64_tr_b16 v[136:137], v41 offset:0
  ds_read_b64_tr_b16 v[138:139], v41 offset:256
  ds_read_b64_tr_b16 v[140:141], v41 offset:4096
  ds_read_b64_tr_b16 v[142:143], v41 offset:4352
  s_mul_i32 s74, s3, 9
  s_add_u32 s74, s74, 2
  s_and_b32 s75, s74, 3
  s_lshr_b32 s74, s74, 2
  s_lshl_b32 s74, s74, 13
  s_add_u32 s74, s74, 73728
  v_xor_b32 v41, s75, v39
  v_lshlrev_b32 v41, 5, v41
  v_add_u32 v41, v41, v38
  v_add_u32 v41, s74, v41
  ds_read_b64_tr_b16 v[152:153], v41 offset:0
  ds_read_b64_tr_b16 v[154:155], v41 offset:256
  ds_read_b64_tr_b16 v[156:157], v41 offset:4096
  ds_read_b64_tr_b16 v[158:159], v41 offset:4352
  s_mul_i32 s74, s3, 9
  s_add_u32 s74, s74, 3
  s_and_b32 s75, s74, 3
  s_lshr_b32 s74, s74, 2
  s_lshl_b32 s74, s74, 13
  s_add_u32 s74, s74, 73728
  v_xor_b32 v41, s75, v39
  v_lshlrev_b32 v41, 5, v41
  v_add_u32 v41, v41, v38
  v_add_u32 v41, s74, v41
  ds_read_b64_tr_b16 v[168:169], v41 offset:0
  ds_read_b64_tr_b16 v[170:171], v41 offset:256
  ds_read_b64_tr_b16 v[172:173], v41 offset:4096
  ds_read_b64_tr_b16 v[174:175], v41 offset:4352
  s_mul_i32 s74, s3, 9
  s_add_u32 s74, s74, 4
  s_and_b32 s75, s74, 3
  s_lshr_b32 s74, s74, 2
  s_lshl_b32 s74, s74, 13
  s_add_u32 s74, s74, 73728
  v_xor_b32 v41, s75, v39
  v_lshlrev_b32 v41, 5, v41
  v_add_u32 v41, v41, v38
  v_add_u32 v41, s74, v41
  ds_read_b64_tr_b16 v[184:185], v41 offset:0
  ds_read_b64_tr_b16 v[186:187], v41 offset:256
  ds_read_b64_tr_b16 v[188:189], v41 offset:4096
  ds_read_b64_tr_b16 v[190:191], v41 offset:4352
  s_mul_i32 s74, s3, 9
  s_add_u32 s74, s74, 5
  s_and_b32 s75, s74, 3
  s_lshr_b32 s74, s74, 2
  s_lshl_b32 s74, s74, 13
  s_add_u32 s74, s74, 73728
  v_xor_b32 v41, s75, v39
  v_lshlrev_b32 v41, 5, v41
  v_add_u32 v41, v41, v38
  v_add_u32 v41, s74, v41
  ds_read_b64_tr_b16 v[200:201], v41 offset:0
  ds_read_b64_tr_b16 v[202:203], v41 offset:256
  ds_read_b64_tr_b16 v[204:205], v41 offset:4096
  ds_read_b64_tr_b16 v[206:207], v41 offset:4352
  s_mul_i32 s74, s3, 9
  s_add_u32 s74, s74, 6
  s_and_b32 s75, s74, 3
  s_lshr_b32 s74, s74, 2
  s_lshl_b32 s74, s74, 13
  s_add_u32 s74, s74, 73728
  v_xor_b32 v41, s75, v39
  v_lshlrev_b32 v41, 5, v41
  v_add_u32 v41, v41, v38
  v_add_u32 v41, s74, v41
  ds_read_b64_tr_b16 v[216:217], v41 offset:0
  ds_read_b64_tr_b16 v[218:219], v41 offset:256
  ds_read_b64_tr_b16 v[220:221], v41 offset:4096
  ds_read_b64_tr_b16 v[222:223], v41 offset:4352
  s_mul_i32 s74, s3, 9
  s_add_u32 s74, s74, 7
  s_and_b32 s75, s74, 3
  s_lshr_b32 s74, s74, 2
  s_lshl_b32 s74, s74, 13
  s_add_u32 s74, s74, 73728
  v_xor_b32 v41, s75, v39
  v_lshlrev_b32 v41, 5, v41
  v_add_u32 v41, v41, v38
  v_add_u32 v41, s74, v41
  ds_read_b64_tr_b16 v[232:233], v41 offset:0
  ds_read_b64_tr_b16 v[234:235], v41 offset:256
  ds_read_b64_tr_b16 v[236:237], v41 offset:4096
  ds_read_b64_tr_b16 v[238:239], v41 offset:4352
  s_mul_i32 s74, s3, 9
  s_add_u32 s74, s74, 8
  s_and_b32 s75, s74, 3
  s_lshr_b32 s74, s74, 2
  s_lshl_b32 s74, s74, 13
  s_add_u32 s74, s74, 73728
  v_xor_b32 v41, s75, v39
  v_lshlrev_b32 v41, 5, v41
  v_add_u32 v41, v41, v38
  v_add_u32 v41, s74, v41
  ds_read_b64_tr_b16 v[248:249], v41 offset:0
  ds_read_b64_tr_b16 v[250:251], v41 offset:256
  ds_read_b64_tr_b16 v[252:253], v41 offset:4096
  ds_read_b64_tr_b16 v[254:255], v41 offset:4352
  s_waitcnt lgkmcnt(0)
  s_barrier
  s_add_u32 s74, s50, 2359296
  s_add_u32 m0, s51, 73728
  s_nop 0
  buffer_load_dwordx4 v32, s[64:67], s74 offen lds
  s_add_u32 s74, s50, 2490368
  s_add_u32 m0, s51, 77824
  s_nop 0
  buffer_load_dwordx4 v32, s[64:67], s74 offen lds
  s_add_u32 s74, s50, 2621440
  s_add_u32 m0, s51, 81920
  s_nop 0
  buffer_load_dwordx4 v32, s[64:67], s74 offen lds
  s_add_u32 s74, s50, 2752512
  s_add_u32 m0, s51, 86016
  s_nop 0
  buffer_load_dwordx4 v32, s[64:67], s74 offen lds
  s_add_u32 s74, s50, 2883584
  s_add_u32 m0, s51, 90112
  s_nop 0
  buffer_load_dwordx4 v32, s[64:67], s74 offen lds
  s_add_u32 s74, s50, 3014656
  s_add_u32 m0, s51, 94208
  s_nop 0
  buffer_load_dwordx4 v32, s[64:67], s74 offen lds
  s_add_u32 s74, s50, 3145728
  s_add_u32 m0, s51, 98304
  s_nop 0
  buffer_load_dwordx4 v32, s[64:67], s74 offen lds
  s_add_u32 s74, s50, 3276800
  s_add_u32 m0, s51, 102400
  s_nop 0
  buffer_load_dwordx4 v32, s[64:67], s74 offen lds
  s_add_u32 s74, s50, 3407872
  s_add_u32 m0, s51, 106496
  s_nop 0
  buffer_load_dwordx4 v32, s[64:67], s74 offen lds
  s_add_u32 s74, s50, 3538944
  s_add_u32 m0, s51, 110592
  s_nop 0
  buffer_load_dwordx4 v32, s[64:67], s74 offen lds
  s_add_u32 s74, s50, 3670016
  s_add_u32 m0, s51, 114688
  s_nop 0
  buffer_load_dwordx4 v32, s[64:67], s74 offen lds
  s_add_u32 s74, s50, 3801088
  s_add_u32 m0, s51, 118784
  s_nop 0
  buffer_load_dwordx4 v32, s[64:67], s74 offen lds
  s_add_u32 s74, s50, 3932160
  s_add_u32 m0, s51, 122880
  s_nop 0
  buffer_load_dwordx4 v32, s[64:67], s74 offen lds
  s_add_u32 s74, s50, 4063232
  s_add_u32 m0, s51, 126976
  s_nop 0
  buffer_load_dwordx4 v32, s[64:67], s74 offen lds
  s_add_u32 s74, s50, 4194304
  s_add_u32 m0, s51, 131072
  s_nop 0
  buffer_load_dwordx4 v32, s[64:67], s74 offen lds
  s_add_u32 s74, s50, 4325376
  s_add_u32 m0, s51, 135168
  s_nop 0
  buffer_load_dwordx4 v32, s[64:67], s74 offen lds
  s_add_u32 s74, s50, 4456448
  s_add_u32 m0, s51, 139264
  s_nop 0
  buffer_load_dwordx4 v32, s[64:67], s74 offen lds
  s_add_u32 s74, s50, 4587520
  s_add_u32 m0, s51, 143360
  s_nop 0
  buffer_load_dwordx4 v32, s[64:67], s74 offen lds
  s_waitcnt vmcnt(0)
  s_barrier
  s_lshl_b32 s74, s3, 12
  v_add_u32 v42, s74, v1
  ds_read_b64_tr_b16 v[44:45], v10 offset:0
  ds_read_b64_tr_b16 v[46:47], v10 offset:512
  ds_read_b64_tr_b16 v[48:49], v10 offset:8192
  ds_read_b64_tr_b16 v[50:51], v10 offset:8704
  ds_read_b64_tr_b16 v[52:53], v11 offset:0
  ds_read_b64_tr_b16 v[54:55], v11 offset:512
  ds_read_b64_tr_b16 v[56:57], v11 offset:8192
  ds_read_b64_tr_b16 v[58:59], v11 offset:8704
  ds_read_b64_tr_b16 v[60:61], v10 offset:16384
  ds_read_b64_tr_b16 v[62:63], v10 offset:16896
  ds_read_b64_tr_b16 v[64:65], v10 offset:24576
  ds_read_b64_tr_b16 v[66:67], v10 offset:25088
  ds_read_b64_tr_b16 v[68:69], v11 offset:16384
  ds_read_b64_tr_b16 v[70:71], v11 offset:16896
  ds_read_b64_tr_b16 v[72:73], v11 offset:24576
  ds_read_b64_tr_b16 v[74:75], v11 offset:25088
  s_waitcnt lgkmcnt(0)
  s_barrier
  v_add_u32 v43, 0, v42
  ds_write_b128 v43, v[44:47] offset:0
  ds_write_b128 v43, v[48:51] offset:1024
  ds_write_b128 v43, v[52:55] offset:2048
  ds_write_b128 v43, v[56:59] offset:3072
  v_add_u32 v43, 16384, v42
  ds_write_b128 v43, v[60:63] offset:0
  ds_write_b128 v43, v[64:67] offset:1024
  ds_write_b128 v43, v[68:71] offset:2048
  ds_write_b128 v43, v[72:75] offset:3072
  s_waitcnt lgkmcnt(0)
  ds_read_b64_tr_b16 v[44:45], v10 offset:32768
  ds_read_b64_tr_b16 v[46:47], v10 offset:33280
  ds_read_b64_tr_b16 v[48:49], v10 offset:40960
  ds_read_b64_tr_b16 v[50:51], v10 offset:41472
  ds_read_b64_tr_b16 v[52:53], v11 offset:32768
  ds_read_b64_tr_b16 v[54:55], v11 offset:33280
  ds_read_b64_tr_b16 v[56:57], v11 offset:40960
  ds_read_b64_tr_b16 v[58:59], v11 offset:41472
  ds_read_b64_tr_b16 v[60:61], v10 offset:49152
  ds_read_b64_tr_b16 v[62:63], v10 offset:49664
  ds_read_b64_tr_b16 v[64:65], v10 offset:57344
  ds_read_b64_tr_b16 v[66:67], v10 offset:57856
  ds_read_b64_tr_b16 v[68:69], v11 offset:49152
  ds_read_b64_tr_b16 v[70:71], v11 offset:49664
  ds_read_b64_tr_b16 v[72:73], v11 offset:57344
  ds_read_b64_tr_b16 v[74:75], v11 offset:57856
  s_waitcnt lgkmcnt(0)
  s_barrier
  v_add_u32 v43, 32768, v42
  ds_write_b128 v43, v[44:47] offset:0
  ds_write_b128 v43, v[48:51] offset:1024
  ds_write_b128 v43, v[52:55] offset:2048
  ds_write_b128 v43, v[56:59] offset:3072
  v_add_u32 v43, 49152, v42
  ds_write_b128 v43, v[60:63] offset:0
  ds_write_b128 v43, v[64:67] offset:1024
  ds_write_b128 v43, v[68:71] offset:2048
  ds_write_b128 v43, v[72:75] offset:3072
  s_waitcnt lgkmcnt(0)
  v_add_u32 v40, 65536, v10
  ds_read_b64_tr_b16 v[44:45], v40 offset:0
  v_add_u32 v40, 65536, v10
  ds_read_b64_tr_b16 v[46:47], v40 offset:512
  v_add_u32 v40, 65536, v10
  ds_read_b64_tr_b16 v[48:49], v40 offset:8192
  v_add_u32 v40, 65536, v10
  ds_read_b64_tr_b16 v[50:51], v40 offset:8704
  v_add_u32 v40, 65536, v11
  ds_read_b64_tr_b16 v[52:53], v40 offset:0
  v_add_u32 v40, 65536, v11
  ds_read_b64_tr_b16 v[54:55], v40 offset:512
  v_add_u32 v40, 65536, v11
  ds_read_b64_tr_b16 v[56:57], v40 offset:8192
  v_add_u32 v40, 65536, v11
  ds_read_b64_tr_b16 v[58:59], v40 offset:8704
  v_add_u32 v40, 65536, v10
  ds_read_b64_tr_b16 v[60:61], v40 offset:16384
  v_add_u32 v40, 65536, v10
  ds_read_b64_tr_b16 v[62:63], v40 offset:16896
  v_add_u32 v40, 65536, v10
  ds_read_b64_tr_b16 v[64:65], v40 offset:24576
  v_add_u32 v40, 65536, v10
  ds_read_b64_tr_b16 v[66:67], v40 offset:25088
  v_add_u32 v40, 65536, v11
  ds_read_b64_tr_b16 v[68:69], v40 offset:16384
  v_add_u32 v40, 65536, v11
  ds_read_b64_tr_b16 v[70:71], v40 offset:16896
  v_add_u32 v40, 65536, v11
  ds_read_b64_tr_b16 v[72:73], v40 offset:24576
  v_add_u32 v40, 65536, v11
  ds_read_b64_tr_b16 v[74:75], v40 offset:25088
  s_waitcnt lgkmcnt(0)
  s_barrier
  v_add_u32 v43, 65536, v42
  ds_write_b128 v43, v[44:47] offset:0
  ds_write_b128 v43, v[48:51] offset:1024
  ds_write_b128 v43, v[52:55] offset:2048
  ds_write_b128 v43, v[56:59] offset:3072
  v_add_u32 v43, 81920, v42
  ds_write_b128 v43, v[60:63] offset:0
  ds_write_b128 v43, v[64:67] offset:1024
  ds_write_b128 v43, v[68:71] offset:2048
  ds_write_b128 v43, v[72:75] offset:3072
  s_waitcnt lgkmcnt(0)
  v_add_u32 v40, 65536, v10
  ds_read_b64_tr_b16 v[44:45], v40 offset:32768
  v_add_u32 v40, 65536, v10
  ds_read_b64_tr_b16 v[46:47], v40 offset:33280
  v_add_u32 v40, 65536, v10
  ds_read_b64_tr_b16 v[48:49], v40 offset:40960
  v_add_u32 v40, 65536, v10
  ds_read_b64_tr_b16 v[50:51], v40 offset:41472
  v_add_u32 v40, 65536, v11
  ds_read_b64_tr_b16 v[52:53], v40 offset:32768
  v_add_u32 v40, 65536, v11
  ds_read_b64_tr_b16 v[54:55], v40 offset:33280
  v_add_u32 v40, 65536, v11
  ds_read_b64_tr_b16 v[56:57], v40 offset:40960
  v_add_u32 v40, 65536, v11
  ds_read_b64_tr_b16 v[58:59], v40 offset:41472
  v_add_u32 v40, 65536, v10
  ds_read_b64_tr_b16 v[60:61], v40 offset:49152
  v_add_u32 v40, 65536, v10
  ds_read_b64_tr_b16 v[62:63], v40 offset:49664
  v_add_u32 v40, 65536, v10
  ds_read_b64_tr_b16 v[64:65], v40 offset:57344
  v_add_u32 v40, 65536, v10
  ds_read_b64_tr_b16 v[66:67], v40 offset:57856
  v_add_u32 v40, 65536, v11
  ds_read_b64_tr_b16 v[68:69], v40 offset:49152
  v_add_u32 v40, 65536, v11
  ds_read_b64_tr_b16 v[70:71], v40 offset:49664
  v_add_u32 v40, 65536, v11
  ds_read_b64_tr_b16 v[72:73], v40 offset:57344
  v_add_u32 v40, 65536, v11
  ds_read_b64_tr_b16 v[74:75], v40 offset:57856
  s_waitcnt lgkmcnt(0)
  s_barrier
  v_add_u32 v43, 98304, v42
  ds_write_b128 v43, v[44:47] offset:0
  ds_write_b128 v43, v[48:51] offset:1024
  ds_write_b128 v43, v[52:55] offset:2048
  ds_write_b128 v43, v[56:59] offset:3072
  v_add_u32 v43, 114688, v42
  ds_write_b128 v43, v[60:63] offset:0
  ds_write_b128 v43, v[64:67] offset:1024
  ds_write_b128 v43, v[68:71] offset:2048
  ds_write_b128 v43, v[72:75] offset:3072
  s_waitcnt lgkmcnt(0)
  v_add_u32 v40, 131072, v10
  ds_read_b64_tr_b16 v[44:45], v40 offset:0
  v_add_u32 v40, 131072, v10
  ds_read_b64_tr_b16 v[46:47], v40 offset:512
  v_add_u32 v40, 131072, v10
  ds_read_b64_tr_b16 v[48:49], v40 offset:8192
  v_add_u32 v40, 131072, v10
  ds_read_b64_tr_b16 v[50:51], v40 offset:8704
  v_add_u32 v40, 131072, v11
  ds_read_b64_tr_b16 v[52:53], v40 offset:0
  v_add_u32 v40, 131072, v11
  ds_read_b64_tr_b16 v[54:55], v40 offset:512
  v_add_u32 v40, 131072, v11
  ds_read_b64_tr_b16 v[56:57], v40 offset:8192
  v_add_u32 v40, 131072, v11
  ds_read_b64_tr_b16 v[58:59], v40 offset:8704
  s_waitcnt lgkmcnt(0)
  s_barrier
  v_add_u32 v43, 131072, v42
  ds_write_b128 v43, v[44:47] offset:0
  ds_write_b128 v43, v[48:51] offset:1024
  ds_write_b128 v43, v[52:55] offset:2048
  ds_write_b128 v43, v[56:59] offset:3072
  s_waitcnt lgkmcnt(0)
  v_mov_b32 v10, v42
  v_mov_b32 v11, v42
  s_barrier
  v_mov_b32 v2, 0x44444444
  v_mov_b32 v34, 0xeeeeeeee
  v_cmp_gt_u32 vcc, 8, v22
  s_nop 1
  v_cndmask_b32 v2, v34, v2, vcc
  s_mul_i32 s74, s3, 1280
  s_add_u32 s74, s74, 156672
  v_and_b32 v34, 1, v21
  v_lshlrev_b32 v34, 2, v34
  v_lshrrev_b32 v35, 1, v21
  v_lshlrev_b32 v35, 1, v35
  v_add_u32 v34, v34, v35
  v_mul_u32_u24 v34, 80, v34
  v_lshlrev_b32 v35, 2, v22
  v_add_u32 v34, v34, v35
  v_add_u32 v3, s74, v34
  v_and_b32 v34, 7, v20
  v_mul_u32_u24 v34, 80, v34
  v_lshlrev_b32 v35, 4, v21
  v_add_u32 v34, v34, v35
  v_add_u32 v4, s74, v34
  v_and_b32 v34, 1, v24
  v_lshlrev_b32 v34, 2, v34
  v_lshrrev_b32 v36, 1, v24
  v_lshlrev_b32 v36, 1, v36
  v_add_u32 v34, v34, v36
  v_and_b32 v36, 1, v22
  v_add_u32 v34, v34, v36
  v_mul_u32_u24 v34, 80, v34
  v_add_u32 v34, v34, v35
  v_add_u32 v5, s74, v34
  v_add_u32 v5, 640, v5
  v_add_u32 v6, s74, v1
  v_add_u32 v7, 147456, v1
  v_lshlrev_b32 v35, 2, v20
  v_add_u32 v18, 157696, v35
  s_mul_i32 s75, s3, 1280
  v_add_u32 v19, s75, v18
  v_lshlrev_b32 v34, 3, v21
  v_and_b32 v35, 7, v20
  v_add_u32 v34, v34, v35
  v_lshlrev_b32 v35, 4, v34
  s_lshl_b32 s75, s3, 9
  s_add_u32 s75, s75, 161792
  v_add_u32 v8, s75, v35
  v_mul_u32_u24 v34, 2304, v21
  v_lshlrev_b32 v35, 2, v22
  v_add_u32 v34, v34, v35
  s_mul_i32 s75, s3, 576
  v_add_u32 v12, s75, v34
  v_mul_u32_u24 v35, 12, v22
  v_add_u32 v9, v12, v35
  v_and_b32 v34, 31, v20
  v_lshrrev_b32 v35, 2, v34
  v_lshlrev_b32 v35, 1, v35
  v_and_b32 v36, 1, v34
  v_add_u32 v17, v35, v36
  v_mov_b32 v36, 99
  v_cmp_gt_u32 vcc, 8, v34
  s_nop 1
  v_cndmask_b32 v17, v36, v17, vcc
  v_and_b32 v36, 2, v34
  v_mov_b32 v14, 0x3f80
  v_mov_b32 v35, 0x3f800000
  v_cmp_eq_u32 vcc, 2, v36
  s_nop 1
  v_cndmask_b32 v14, v14, v35, vcc
  s_mov_b32 s21, 0
  s_mov_b32 s22, 0x4d80000
  s_mov_b32 s23, 0x4d82400
  s_mov_b32 s24, 0x4d84800
  s_mul_i32 s80, s20, 9216
  s_add_u32 s80, s80, 0x4c00000
  s_mul_i32 s81, s49, 2304
  s_mul_i32 s74, s48, 288
  s_add_u32 s81, s81, s74
  s_mul_i32 s74, s3, 73728
  s_add_u32 s81, s81, s74
  s_add_u32 s81, s81, 0x4c00000
  s_mul_i32 s70, s3, 2304
  s_add_u32 s70, s70, s80
  s_mov_b32 s25, s80
  s_mov_b32 s26, s81
  s_mov_b32 s27, 0
  s_mov_b32 s70, 0
  s_lshl_b32 s28, s20, 13
  s_lshl_b32 s74, s3, 11
  s_add_u32 s28, s28, s74
  s_lshl_b32 s29, s20, 12
  s_lshl_b32 s74, s3, 10
  s_add_u32 s29, s29, s74
  s_add_u32 s29, s29, 0x4000000
  s_lshl_b32 s30, s20, 11
  s_lshl_b32 s74, s3, 9
  s_add_u32 s30, s30, s74
  s_add_u32 s30, s30, 0x4800000
  s_mov_b32 s31, 0x20000
  s_mov_b32 s68, 0x3db504f3
  s_mov_b32 s69, 0x3fb8aa3b
  s_mov_b32 s76, 0x00ff00ff
  s_mov_b32 s77, s76
  s_mov_b32 s78, 0x3ffff
  s_mov_b32 s79, 0x3ffff
  s_lshl_b32 s64, s3, 11
  s_lshl_b32 s74, s3, 4
  s_mov_b64 s[66:67], 0xffff
  s_lshl_b64 s[66:67], s[66:67], s74
  s_mul_i32 s65, s3, 1280
  s_add_u32 s65, s65, 157312
  s_and_b32 s63, s3, 1
  s_lshl_b32 s63, s63, 3
  s_mov_b32 s44, -1
  s_mov_b32 s45, 15
  s_mov_b32 s71, 0x0c0c0703
  v_mov_b32 v33, 72
  s_mov_b32 s74, 0
  s_nop 0
C_RDY_f:
  buffer_load_dword v32, v33, s[16:19], 0 offen sc1
  s_waitcnt vmcnt(0)
  v_readfirstlane_b32 s75, v32
  s_add_u32 s74, s74, 1
  s_cmp_ge_u32 s75, 32
  s_nop 2
  s_cbranch_scc1 C_GO_f
  s_cmp_lt_u32 s74, 20000
  s_cbranch_scc1 C_RDY_f
C_GO_f:
  s_waitcnt vmcnt(0)
  s_barrier
  s_mov_b32 s33, 0
  s_add_u32 s74, s21, 0
  s_lshr_b32 s74, s74, 2
  s_min_u32 s74, s74, 15
  s_cmp_lt_u32 s74, s33
  s_cbranch_scc1 pw_1
  v_lshrrev_b32 v28, 2, v1
  v_add_u32 v28, 128, v28
  s_mov_b32 s75, 0
pl_2:
  s_mov_b64 exec, 0xffff
  buffer_load_dword v29, v28, s[16:19], 0 offen sc1
  s_waitcnt vmcnt(0)
  v_cmp_eq_u32 vcc, 0xc0, v29
  s_mov_b64 exec, -1
  s_nop 4
  s_not_b32 s33, vcc_lo
  s_ff1_i32_b32 s33, s33
  s_add_u32 s75, s75, 1
  s_cmp_lt_u32 s74, s33
  s_cbranch_scc1 pw_1
  s_cmp_lt_u32 s75, 100000
  s_cbranch_scc1 pl_2
pw_1:
  buffer_load_dwordx4 v[32:35], v1, s[12:15], s28 offen
  buffer_load_dwordx4 v[76:79], v1, s[12:15], s28 offen offset:1024
  s_waitcnt vmcnt(0)
C_STEP_f:
  s_add_u32 s72, s22, s64
  s_add_u32 s73, s22, 8192
  v_mov_b64 v[28:29], 0
  v_mov_b64 v[30:31], 0
  ds_read_b128 v[60:63], v10 offset:0
  ds_read_b128 v[64:67], v10 offset:1024
  ds_read_b128 v[68:71], v10 offset:16384
  ds_read_b128 v[72:75], v10 offset:17408
  v_mov_b64 v[36:37], 0
  v_mov_b64 v[38:39], 0
  v_mov_b64 v[40:41], 0
  v_mov_b64 v[42:43], 0
  v_mov_b64 v[44:45], 0
  v_mov_b64 v[46:47], 0
  v_mov_b64 v[48:49], 0
  v_mov_b64 v[50:51], 0
  v_mov_b64 v[52:53], 0
  v_mov_b64 v[54:55], 0
  v_mov_b64 v[56:57], 0
  v_mov_b64 v[58:59], 0
  buffer_load_dwordx4 v[20:23], v1, s[12:15], s72 offen sc1
  buffer_load_dwordx4 v[24:27], v1, s[12:15], s72 offen offset:1024 sc1
  s_mov_b64 exec, s[66:67]
  buffer_load_dwordx4 v[28:31], v1, s[12:15], s73 offen sc1
  s_mov_b64 exec, -1
  v_add_u32 v13, s64, v7
  s_waitcnt vmcnt(2)
  v_max3_u32 v15, v20, v21, v22
  s_waitcnt vmcnt(1)
  v_max3_u32 v15, v15, v23, v24
  v_max3_u32 v15, v15, v25, v26
  s_waitcnt vmcnt(0)
  v_max3_u32 v15, v15, v27, v28
  v_max3_u32 v15, v15, v29, v30
  v_max_u32 v15, v15, v31
  v_cmp_eq_u32 vcc, -1, v15
  s_nop 4
  s_cbranch_vccz mok_3
mrt_4:
  s_sub_u32 s31, s31, 1
  s_cbranch_scc1 mok_3_x
  buffer_load_dwordx4 v[20:23], v1, s[12:15], s72 offen sc1
  buffer_load_dwordx4 v[24:27], v1, s[12:15], s72 offen offset:1024 sc1
  s_mov_b64 exec, s[66:67]
  buffer_load_dwordx4 v[28:31], v1, s[12:15], s73 offen sc1
  s_mov_b64 exec, -1
  s_waitcnt vmcnt(0)
  v_max3_u32 v15, v20, v21, v22
  v_max3_u32 v15, v15, v23, v24
  v_max3_u32 v15, v15, v25, v26
  v_max3_u32 v15, v15, v27, v28
  v_max3_u32 v15, v15, v29, v30
  v_max_u32 v15, v15, v31
  v_cmp_eq_u32 vcc, -1, v15
  s_nop 4
  s_cbranch_vccnz mrt_4
  s_branch mok_3
mok_3_x:
  s_mov_b32 s31, 0
mok_3:
  ds_write_b128 v13, v[20:23]
  ds_write_b128 v13, v[24:27] offset:1024
  s_mov_b64 exec, s[66:67]
  ds_write_b128 v7, v[28:31] offset:8192
  s_mov_b64 exec, -1
  s_cmp_eq_u32 s21, 0
  s_cbranch_scc1 sk_5
  v_lshrrev_b32 v15, 2, v1
  s_sub_u32 s74, s30, 65536
  buffer_store_dword v9, v15, s[12:15], s74 offen sc1
  buffer_store_dword v0, v15, s[12:15], s74 offen offset:256 sc1
  s_sub_u32 s74, s21, 1
  v_mov_b32 v15, s74
  s_mov_b64 exec, 1
  s_nop 0
  buffer_store_dword v15, off, s[12:15], s34 sc1
  s_mov_b64 exec, -1
sk_5:
  v_lshlrev_b32 v15, 2, v1
  s_add_u32 s75, s28, 0x1040000
  s_mov_b32 exec_hi, 0
  buffer_load_dword v0, v15, s[12:15], s75 offen
  s_add_u32 s74, s28, 524288
  s_min_u32 s74, s74, 0xfff800
  buffer_load_dword v0, v15, s[12:15], s74 offen
  s_mov_b64 exec, -1
  s_waitcnt lgkmcnt(0)
  s_barrier
  ds_read_b128 v[20:23], v7 offset:0
  ds_read_b128 v[24:27], v7 offset:1024
  ds_read_b128 v[28:31], v7 offset:2048
  s_waitcnt lgkmcnt(2)
  v_smfmac_f32_16x16x64_bf16 v[36:39], v[20:23], a[0:7], v2
  v_smfmac_f32_16x16x64_bf16 v[44:47], v[20:23], a[144:151], v2
  v_smfmac_f32_16x16x64_bf16 v[40:43], v[20:23], a[72:79], v2
  v_smfmac_f32_16x16x64_bf16 v[48:51], v[20:23], a[216:223], v2
  v_smfmac_f32_16x16x64_bf16 v[52:55], v[20:23], v[60:67], v2
  ds_read_b128 v[20:23], v7 offset:3072
  ds_read_b128 v[60:63], v10 offset:32768
  ds_read_b128 v[64:67], v10 offset:33792
  s_waitcnt lgkmcnt(4)
  v_smfmac_f32_16x16x64_bf16 v[36:39], v[24:27], a[8:15], v2
  v_smfmac_f32_16x16x64_bf16 v[44:47], v[24:27], a[152:159], v2
  v_smfmac_f32_16x16x64_bf16 v[40:43], v[24:27], a[80:87], v2
  v_smfmac_f32_16x16x64_bf16 v[48:51], v[24:27], a[224:231], v2
  v_smfmac_f32_16x16x64_bf16 v[52:55], v[24:27], v[68:75], v2
  ds_read_b128 v[24:27], v7 offset:4096
  ds_read_b128 v[68:71], v10 offset:49152
  ds_read_b128 v[72:75], v10 offset:50176
  s_waitcnt lgkmcnt(6)
  v_smfmac_f32_16x16x64_bf16 v[36:39], v[28:31], a[16:23], v2
  v_smfmac_f32_16x16x64_bf16 v[44:47], v[28:31], a[160:167], v2
  v_smfmac_f32_16x16x64_bf16 v[40:43], v[28:31], a[88:95], v2
  v_smfmac_f32_16x16x64_bf16 v[48:51], v[28:31], a[232:239], v2
  s_waitcnt lgkmcnt(3)
  v_smfmac_f32_16x16x64_bf16 v[52:55], v[28:31], v[60:67], v2
  ds_read_b128 v[28:31], v7 offset:5120
  v_add_u32 v10, 0x10000, v10
  ds_read_b128 v[60:63], v10 offset:0
  ds_read_b128 v[64:67], v10 offset:1024
  v_smfmac_f32_16x16x64_bf16 v[36:39], v[20:23], a[24:31], v2
  v_smfmac_f32_16x16x64_bf16 v[44:47], v[20:23], a[168:175], v2
  v_smfmac_f32_16x16x64_bf16 v[40:43], v[20:23], a[96:103], v2
  v_smfmac_f32_16x16x64_bf16 v[48:51], v[20:23], a[240:247], v2
  s_waitcnt lgkmcnt(3)
  v_smfmac_f32_16x16x64_bf16 v[52:55], v[20:23], v[68:75], v2
  ds_read_b128 v[20:23], v7 offset:6144
  ds_read_b128 v[68:71], v10 offset:16384
  ds_read_b128 v[72:75], v10 offset:17408
  v_smfmac_f32_16x16x64_bf16 v[36:39], v[24:27], a[32:39], v2
  v_smfmac_f32_16x16x64_bf16 v[44:47], v[24:27], a[176:183], v2
  v_smfmac_f32_16x16x64_bf16 v[40:43], v[24:27], a[104:111], v2
  v_smfmac_f32_16x16x64_bf16 v[48:51], v[24:27], a[248:255], v2
  s_waitcnt lgkmcnt(3)
  v_smfmac_f32_16x16x64_bf16 v[52:55], v[24:27], v[60:67], v2
  ds_read_b128 v[24:27], v7 offset:7168
  ds_read_b128 v[60:63], v10 offset:32768
  ds_read_b128 v[64:67], v10 offset:33792
  v_smfmac_f32_16x16x64_bf16 v[36:39], v[28:31], a[40:47], v2
  v_smfmac_f32_16x16x64_bf16 v[44:47], v[28:31], a[184:191], v2
  v_smfmac_f32_16x16x64_bf16 v[40:43], v[28:31], a[112:119], v2
  v_smfmac_f32_16x16x64_bf16 v[48:51], v[28:31], v[80:87], v2
  s_waitcnt lgkmcnt(3)
  v_smfmac_f32_16x16x64_bf16 v[52:55], v[28:31], v[68:75], v2
  ds_read_b128 v[28:31], v7 offset:8192
  ds_read_b128 v[68:71], v10 offset:49152
  ds_read_b128 v[72:75], v10 offset:50176
  v_smfmac_f32_16x16x64_bf16 v[36:39], v[20:23], a[48:55], v2
  v_smfmac_f32_16x16x64_bf16 v[44:47], v[20:23], a[192:199], v2
  v_smfmac_f32_16x16x64_bf16 v[40:43], v[20:23], a[120:127], v2
  v_smfmac_f32_16x16x64_bf16 v[48:51], v[20:23], v[88:95], v2
  s_waitcnt lgkmcnt(3)
  v_smfmac_f32_16x16x64_bf16 v[52:55], v[20:23], v[60:67], v2
  v_add_u32 v10, 0x10000, v10
  ds_read_b128 v[60:63], v10 offset:0
  ds_read_b128 v[64:67], v10 offset:1024
  v_smfmac_f32_16x16x64_bf16 v[36:39], v[24:27], a[56:63], v2
  v_smfmac_f32_16x16x64_bf16 v[44:47], v[24:27], a[200:207], v2
  v_smfmac_f32_16x16x64_bf16 v[40:43], v[24:27], a[128:135], v2
  v_smfmac_f32_16x16x64_bf16 v[48:51], v[24:27], v[96:103], v2
  s_waitcnt lgkmcnt(2)
  v_smfmac_f32_16x16x64_bf16 v[52:55], v[24:27], v[68:75], v2
  ds_read_b128 v[68:71], v11 offset:2048
  ds_read_b128 v[72:75], v11 offset:3072
  v_smfmac_f32_16x16x64_bf16 v[36:39], v[28:31], a[64:71], v2
  v_smfmac_f32_16x16x64_bf16 v[44:47], v[28:31], a[208:215], v2
  v_smfmac_f32_16x16x64_bf16 v[40:43], v[28:31], a[136:143], v2
  v_smfmac_f32_16x16x64_bf16 v[48:51], v[28:31], v[104:111], v2
  s_waitcnt lgkmcnt(2)
  v_smfmac_f32_16x16x64_bf16 v[52:55], v[28:31], v[60:67], v2
  v_subrev_u32 v10, 0x20000, v10
  ds_read_b128 v[20:23], v7 offset:0
  ds_read_b128 v[24:27], v7 offset:1024
  ds_read_b128 v[60:63], v11 offset:18432
  ds_read_b128 v[64:67], v11 offset:19456
  v_permlane32_swap_b32 v36, v38
  v_permlane32_swap_b32 v37, v39
  v_permlane32_swap_b32 v40, v42
  v_permlane32_swap_b32 v41, v43
  v_permlane32_swap_b32 v44, v46
  v_permlane32_swap_b32 v45, v47
  v_permlane32_swap_b32 v48, v50
  v_permlane32_swap_b32 v49, v51
  v_add_f32 v36, v36, v38
  v_add_f32 v37, v37, v39
  v_add_f32 v40, v40, v42
  v_add_f32 v41, v41, v43
  v_add_f32 v44, v44, v46
  v_add_f32 v45, v45, v47
  v_add_f32 v48, v48, v50
  v_add_f32 v49, v49, v51
  v_cvt_pk_bf16_f32 v36, v36, v40
  v_cvt_pk_bf16_f32 v37, v37, v41
  v_cvt_pk_bf16_f32 v38, v44, v48
  v_cvt_pk_bf16_f32 v39, v45, v49
  ds_write_b32 v3, v36
  ds_write_b32 v3, v37 offset:80
  ds_write_b32 v3, v38 offset:640
  ds_write_b32 v3, v39 offset:720
  ds_read_b128 v[40:43], v4
  ds_read_b128 v[44:47], v5
  s_waitcnt lgkmcnt(9)
  v_smfmac_f32_16x16x64_bf16 v[56:59], v[20:23], v[68:75], v2
  ds_read_b128 v[20:23], v7 offset:2048
  ds_read_b128 v[68:71], v11 offset:34816
  ds_read_b128 v[72:75], v11 offset:35840
  v_permlane32_swap_b32 v52, v54
  v_permlane32_swap_b32 v53, v55
  v_add_f32 v52, v52, v54
  v_add_f32 v53, v53, v55
  v_cvt_pk_bf16_f32 v52, v52, v53
  v_mov_b32 v53, 0
  v_mov_b32 v9, v52
  s_waitcnt lgkmcnt(9)
  v_smfmac_f32_16x16x64_bf16 v[56:59], v[24:27], v[60:67], v2
  ds_read_b128 v[24:27], v7 offset:3072
  ds_read_b128 v[60:63], v11 offset:51200
  ds_read_b128 v[64:67], v11 offset:52224
  s_waitcnt lgkmcnt(7)
  v_mfma_f32_16x16x32_bf16 v[48:51], v[32:35], v[40:43], 0
  v_mfma_f32_16x16x32_bf16 v[28:31], v[76:79], v[40:43], 0
  s_waitcnt lgkmcnt(6)
  v_mfma_f32_16x16x32_bf16 v[36:39], v[44:47], v[40:43], 0
  s_add_u32 s74, s28, 0x1000000
  buffer_load_dwordx4 v[76:79], v1, s[12:15], s74 offen
  buffer_load_dwordx4 v[32:35], v1, s[12:15], s74 offen offset:1024
  buffer_store_dwordx4 v[44:47], v1, s[12:15], s29 offen sc1
  s_nop 1
  v_cndmask_b32 v40, v28, v48, s[76:77]
  v_cndmask_b32 v41, v29, v49, s[76:77]
  v_cndmask_b32 v42, v30, v50, s[76:77]
  v_cndmask_b32 v43, v31, v51, s[76:77]
  v_cndmask_b32 v44, v37, v36, s[76:77]
  ds_write_b128 v6, v[40:43]
  ds_write_b32 v19, v44
  s_waitcnt lgkmcnt(0)
  s_barrier
  ds_read_b128 v[28:31], v7 offset:9216
  ds_read_b32 v44, v18 offset:0
  ds_read_b128 v[36:39], v7 offset:10496
  ds_read_b32 v45, v18 offset:1280
  ds_read_b128 v[48:51], v7 offset:11776
  ds_read_b32 v46, v18 offset:2560
  ds_read_b128 v[40:43], v7 offset:13056
  ds_read_b32 v47, v18 offset:3840
  v_smfmac_f32_16x16x64_bf16 v[56:59], v[20:23], v[68:75], v2
  ds_read_b128 v[20:23], v7 offset:4096
  v_add_u32 v11, 0x10000, v11
  ds_read_b128 v[68:71], v11 offset:2048
  ds_read_b128 v[72:75], v11 offset:3072
  s_waitcnt lgkmcnt(8)
  v_pk_add_f32 v[28:29], v[28:29], v[36:37]
  v_pk_add_f32 v[30:31], v[30:31], v[38:39]
  s_waitcnt lgkmcnt(4)
  v_pk_add_f32 v[48:49], v[48:49], v[40:41]
  v_pk_add_f32 v[50:51], v[50:51], v[42:43]
  s_waitcnt lgkmcnt(3)
  v_pk_add_f32 v[44:45], v[44:45], v[46:47]
  v_pk_add_f32 v[28:29], v[28:29], v[48:49]
  v_pk_add_f32 v[30:31], v[30:31], v[50:51]
  v_add_f32 v44, v44, v45
  v_cvt_pk_bf16_f32 v36, v28, v29
  v_cvt_pk_bf16_f32 v37, v30, v31
  v_cvt_pk_bf16_f32 v38, v44, v44
  v_lshlrev_b32 v28, 16, v36
  v_and_b32 v29, 0xffff0000, v36
  v_lshlrev_b32 v30, 16, v37
  v_and_b32 v31, 0xffff0000, v37
  v_lshlrev_b32 v44, 16, v38
  v_smfmac_f32_16x16x64_bf16 v[56:59], v[24:27], v[60:67], v2
  ds_read_b128 v[24:27], v7 offset:5120
  ds_read_b128 v[60:63], v11 offset:18432
  ds_read_b128 v[64:67], v11 offset:19456
  v_mul_f32 v28, s68, v28
  v_mul_f32 v29, s68, v29
  v_mul_f32 v30, s68, v30
  v_mul_f32 v31, s68, v31
  v_mul_f32 v44, s68, v44
  v_cvt_pk_bf16_f32 v36, v28, v29
  v_cvt_pk_bf16_f32 v37, v30, v31
  v_cvt_pk_bf16_f32 v38, v44, v44
  v_lshlrev_b32 v28, 16, v36
  v_and_b32 v29, 0xffff0000, v36
  v_lshlrev_b32 v30, 16, v37
  v_and_b32 v31, 0xffff0000, v37
  v_lshlrev_b32 v44, 16, v38
  s_waitcnt lgkmcnt(3)
  v_smfmac_f32_16x16x64_bf16 v[56:59], v[20:23], v[68:75], v2
  ds_read_b128 v[20:23], v7 offset:6144
  ds_read_b128 v[68:71], v11 offset:34816
  ds_read_b128 v[72:75], v11 offset:35840
  v_max3_f32 v36, v28, v29, v30
  v_max3_f32 v36, v36, v31, v44
  v_mov_b32 v37, v36
  s_nop 1
  v_permlane32_swap_b32 v36, v37
  v_max_f32 v36, v36, v37
  v_mov_b32 v37, v36
  s_nop 1
  v_permlane16_swap_b32 v36, v37
  v_max_f32 v36, v36, v37
  s_nop 1
  v_max_f32_dpp v36, v36, v36 row_ror:8 row_mask:0xf bank_mask:0xf
  s_waitcnt lgkmcnt(3)
  v_smfmac_f32_16x16x64_bf16 v[56:59], v[24:27], v[60:67], v2
  ds_read_b128 v[24:27], v7 offset:7168
  ds_read_b128 v[60:63], v11 offset:51200
  ds_read_b128 v[64:67], v11 offset:52224
  v_mul_f32 v36, s69, v36
  v_fma_f32 v28, v28, s69, -v36
  v_fma_f32 v29, v29, s69, -v36
  v_fma_f32 v30, v30, s69, -v36
  v_fma_f32 v31, v31, s69, -v36
  v_fma_f32 v44, v44, s69, -v36
  v_exp_f32 v28, v28
  v_exp_f32 v29, v29
  v_exp_f32 v30, v30
  v_exp_f32 v31, v31
  v_exp_f32 v44, v44
  s_waitcnt lgkmcnt(3)
  v_smfmac_f32_16x16x64_bf16 v[56:59], v[20:23], v[68:75], v2
  ds_read_b128 v[20:23], v7 offset:8192
  v_add_u32 v11, 0x10000, v11
  ds_read_b128 v[68:71], v11 offset:2048
  ds_read_b128 v[72:75], v11 offset:3072
  v_add_f32 v36, v28, v29
  v_add_f32 v37, v30, v31
  v_add_f32 v36, v36, v44
  v_add_f32 v36, v36, v37
  v_mov_b32 v37, v36
  s_nop 1
  v_permlane32_swap_b32 v36, v37
  v_add_f32 v36, v36, v37
  v_mov_b32 v37, v36
  s_nop 1
  v_permlane16_swap_b32 v36, v37
  v_add_f32 v36, v36, v37
  s_nop 1
  v_add_f32_dpp v36, v36, v36 row_ror:8 row_mask:0xf bank_mask:0xf
  s_waitcnt lgkmcnt(3)
  v_smfmac_f32_16x16x64_bf16 v[56:59], v[24:27], v[60:67], v2
  v_rcp_f32 v36, v36
  s_nop 0
  v_mul_f32 v28, v28, v36
  v_mul_f32 v29, v29, v36
  v_mul_f32 v30, v30, v36
  v_mul_f32 v31, v31, v36
  v_mul_f32 v44, v44, v36
  v_cvt_pk_bf16_f32 v40, v28, v29
  v_cvt_pk_bf16_f32 v41, v30, v31
  v_mov_b32_dpp v45, v44 row_ror:8 row_mask:0xf bank_mask:0xf
  v_mov_b32_dpp v42, v40 row_ror:8 row_mask:0xf bank_mask:0xf
  v_mov_b32_dpp v43, v41 row_ror:8 row_mask:0xf bank_mask:0xf
  v_cvt_pk_bf16_f32 v44, v44, v45
  v_mov_b32 v45, 0
  s_waitcnt lgkmcnt(0)
  v_smfmac_f32_16x16x64_bf16 v[56:59], v[20:23], v[68:75], v2
  s_waitcnt vmcnt(2)
  v_mfma_f32_16x16x32_bf16 v[28:31], v[76:79], v[40:43], 0
  s_waitcnt vmcnt(1)
  v_mfma_f32_16x16x32_bf16 v[48:51], v[32:35], v[40:43], 0
  s_nop 3
  v_permlane32_swap_b32 v56, v58
  v_permlane32_swap_b32 v57, v59
  v_add_f32 v56, v56, v58
  v_add_f32 v57, v57, v59
  v_cvt_pk_bf16_f32 v56, v56, v57
  v_mov_b32 v57, 0
  v_subrev_u32 v11, 0x20000, v11
  v_mfma_f32_16x16x16_bf16 v[28:31], v[52:53], v[44:45], v[28:31]
  v_mfma_f32_16x16x16_bf16 v[48:51], v[56:57], v[44:45], v[48:51]
  v_mov_b32 v0, v56
  s_cmp_eq_u32 s21, 63
  s_nop 5
  s_cbranch_scc1 C_END_f
  v_mov_b64 v[60:61], 0
  v_mov_b64 v[62:63], 0
  v_mov_b64 v[64:65], 0
  v_mov_b64 v[66:67], 0
  v_mov_b64 v[68:69], 0
  v_mov_b64 v[70:71], 0
  v_mov_b64 v[72:73], 0
  v_mov_b64 v[74:75], 0
  v_mov_b64 v[40:41], 0
  v_mov_b64 v[42:43], 0
  v_cvt_pk_bf16_f32 v36, v28, v29
  v_cvt_pk_bf16_f32 v37, v30, v31
  v_cvt_pk_bf16_f32 v38, v48, v49
  v_cvt_pk_bf16_f32 v39, v50, v51
  s_mov_b64 exec, s[76:77]
  ds_write_b128 v8, v[36:39]
  s_mov_b64 exec, -1
  s_add_u32 s74, s21, 3
  s_lshr_b32 s74, s74, 2
  s_min_u32 s74, s74, 15
  s_cmp_lt_u32 s74, s33
  s_cbranch_scc1 pw_6
  v_lshrrev_b32 v28, 2, v1
  v_add_u32 v28, 128, v28
  s_mov_b32 s75, 0
pl_7:
  s_mov_b64 exec, 0xffff
  buffer_load_dword v29, v28, s[16:19], 0 offen sc1
  s_waitcnt vmcnt(0)
  v_cmp_eq_u32 vcc, 0xc0, v29
  s_mov_b64 exec, -1
  s_nop 4
  s_not_b32 s33, vcc_lo
  s_ff1_i32_b32 s33, s33
  s_add_u32 s75, s75, 1
  s_cmp_lt_u32 s74, s33
  s_cbranch_scc1 pw_6
  s_cmp_lt_u32 s75, 100000
  s_cbranch_scc1 pl_7
pw_6:
  s_add_u32 s74, s28, 262144
  buffer_load_dwordx4 v[32:35], v1, s[12:15], s74 offen
  buffer_load_dwordx4 v[76:79], v1, s[12:15], s74 offen offset:1024
  v_mov_b64 v[44:45], 0
  v_mov_b64 v[46:47], 0
  v_mov_b64 v[48:49], 0
  v_mov_b64 v[50:51], 0
  v_mov_b64 v[52:53], 0
  v_mov_b64 v[54:55], 0
  v_mov_b64 v[56:57], 0
  v_mov_b64 v[58:59], 0
  s_waitcnt lgkmcnt(0)
  s_barrier
  ds_read_b128 v[20:23], v7 offset:14336
  ds_read_b128 v[24:27], v7 offset:15360
  s_waitcnt lgkmcnt(1)
  v_smfmac_f32_16x16x64_bf16 v[40:43], v[20:23], v[112:119], v2
  v_smfmac_f32_16x16x64_bf16 v[44:47], v[20:23], v[128:135], v2
  v_smfmac_f32_16x16x64_bf16 v[48:51], v[20:23], v[144:151], v2
  v_smfmac_f32_16x16x64_bf16 v[52:55], v[20:23], v[160:167], v2
  v_smfmac_f32_16x16x64_bf16 v[56:59], v[20:23], v[176:183], v2
  v_smfmac_f32_16x16x64_bf16 v[60:63], v[20:23], v[192:199], v2
  v_smfmac_f32_16x16x64_bf16 v[64:67], v[20:23], v[208:215], v2
  v_smfmac_f32_16x16x64_bf16 v[68:71], v[20:23], v[224:231], v2
  v_smfmac_f32_16x16x64_bf16 v[72:75], v[20:23], v[240:247], v2
  s_waitcnt lgkmcnt(0)
  v_smfmac_f32_16x16x64_bf16 v[40:43], v[24:27], v[120:127], v2
  v_smfmac_f32_16x16x64_bf16 v[44:47], v[24:27], v[136:143], v2
  v_smfmac_f32_16x16x64_bf16 v[48:51], v[24:27], v[152:159], v2
  s_nop 5
  v_permlane32_swap_b32 v40, v42
  v_permlane32_swap_b32 v41, v43
  v_pk_add_f32 v[40:41], v[40:41], v[42:43]
  v_cvt_pk_bf16_f32 v40, v40, v41
  v_and_or_b32 v40, v40, -2, s27
  buffer_store_dword v40, v12, s[12:15], s25 offen offset:0
  v_smfmac_f32_16x16x64_bf16 v[52:55], v[24:27], v[168:175], v2
  v_permlane32_swap_b32 v44, v46
  v_permlane32_swap_b32 v45, v47
  v_pk_add_f32 v[44:45], v[44:45], v[46:47]
  v_cvt_pk_bf16_f32 v44, v44, v45
  v_and_or_b32 v44, v44, -2, s27
  buffer_store_dword v44, v12, s[12:15], s25 offen offset:64
  v_smfmac_f32_16x16x64_bf16 v[56:59], v[24:27], v[184:191], v2
  v_permlane32_swap_b32 v48, v50
  v_permlane32_swap_b32 v49, v51
  v_pk_add_f32 v[48:49], v[48:49], v[50:51]
  v_cvt_pk_bf16_f32 v48, v48, v49
  v_and_or_b32 v48, v48, -2, s27
  buffer_store_dword v48, v12, s[12:15], s25 offen offset:128
  v_smfmac_f32_16x16x64_bf16 v[60:63], v[24:27], v[200:207], v2
  v_permlane32_swap_b32 v52, v54
  v_permlane32_swap_b32 v53, v55
  v_pk_add_f32 v[52:53], v[52:53], v[54:55]
  v_cvt_pk_bf16_f32 v52, v52, v53
  v_and_or_b32 v52, v52, -2, s27
  buffer_store_dword v52, v12, s[12:15], s25 offen offset:192
  v_smfmac_f32_16x16x64_bf16 v[64:67], v[24:27], v[216:223], v2
  v_permlane32_swap_b32 v56, v58
  v_permlane32_swap_b32 v57, v59
  v_pk_add_f32 v[56:57], v[56:57], v[58:59]
  v_cvt_pk_bf16_f32 v56, v56, v57
  v_and_or_b32 v56, v56, -2, s27
  buffer_store_dword v56, v12, s[12:15], s25 offen offset:256
  v_smfmac_f32_16x16x64_bf16 v[68:71], v[24:27], v[232:239], v2
  v_permlane32_swap_b32 v60, v62
  v_permlane32_swap_b32 v61, v63
  v_pk_add_f32 v[60:61], v[60:61], v[62:63]
  v_cvt_pk_bf16_f32 v60, v60, v61
  v_and_or_b32 v60, v60, -2, s27
  buffer_store_dword v60, v12, s[12:15], s25 offen offset:320
  v_smfmac_f32_16x16x64_bf16 v[72:75], v[24:27], v[248:255], v2
  v_permlane32_swap_b32 v64, v66
  v_permlane32_swap_b32 v65, v67
  v_pk_add_f32 v[64:65], v[64:65], v[66:67]
  v_cvt_pk_bf16_f32 v64, v64, v65
  v_and_or_b32 v64, v64, -2, s27
  buffer_store_dword v64, v12, s[12:15], s25 offen offset:384
  v_permlane32_swap_b32 v68, v70
  v_permlane32_swap_b32 v69, v71
  v_pk_add_f32 v[68:69], v[68:69], v[70:71]
  v_cvt_pk_bf16_f32 v68, v68, v69
  v_and_or_b32 v68, v68, -2, s27
  buffer_store_dword v68, v12, s[12:15], s25 offen offset:448
  v_permlane32_swap_b32 v72, v74
  v_permlane32_swap_b32 v73, v75
  v_pk_add_f32 v[72:73], v[72:73], v[74:75]
  v_cvt_pk_bf16_f32 v72, v72, v73
  v_and_or_b32 v72, v72, -2, s27
  buffer_store_dword v72, v12, s[12:15], s25 offen offset:512
  v_and_b32 v13, 0x1ff, v1
  v_lshrrev_b32 v15, 9, v1
  v_mul_u32_u24 v20, 9216, v15
  v_add_u32 v20, v20, v13
  v_lshlrev_b32 v13, 1, v13
  v_lshlrev_b32 v15, 4, v15
  v_add_u32 v13, v13, v15
  v_add_u32 v13, s65, v13
  v_cmp_eq_u32 vcc, 0, v17
  s_nop 1
  v_cndmask_b32 v40, 0, v14, vcc
  v_cmp_eq_u32 vcc, 1, v17
  s_nop 1
  v_cndmask_b32 v41, 0, v14, vcc
  v_cmp_eq_u32 vcc, 2, v17
  s_nop 1
  v_cndmask_b32 v42, 0, v14, vcc
  v_cmp_eq_u32 vcc, 3, v17
  s_nop 1
  v_cndmask_b32 v43, 0, v14, vcc
  s_mov_b64 exec, s[78:79]
  s_add_u32 s74, s26, 0
  buffer_load_dwordx4 v[60:63], v20, s[12:15], s74 offen sc1
  s_add_u32 s74, s26, 18432
  buffer_load_dwordx4 v[64:67], v20, s[12:15], s74 offen sc1
  s_add_u32 s74, s26, 36864
  buffer_load_dwordx4 v[68:71], v20, s[12:15], s74 offen sc1
  s_add_u32 s74, s26, 55296
  buffer_load_dwordx4 v[72:75], v20, s[12:15], s74 offen sc1
  s_mov_b64 exec, -1
  s_waitcnt vmcnt(3)
  v_alignbit_b32 v21, v60, v60, 1
  v_alignbit_b32 v22, v61, v61, 1
  v_alignbit_b32 v21, v62, v21, 1
  v_alignbit_b32 v22, v63, v22, 1
  s_waitcnt vmcnt(2)
  v_alignbit_b32 v21, v64, v21, 1
  v_alignbit_b32 v22, v65, v22, 1
  v_alignbit_b32 v21, v66, v21, 1
  v_alignbit_b32 v22, v67, v22, 1
  s_waitcnt vmcnt(1)
  v_alignbit_b32 v21, v68, v21, 1
  v_alignbit_b32 v22, v69, v22, 1
  v_alignbit_b32 v21, v70, v21, 1
  v_alignbit_b32 v22, v71, v22, 1
  s_waitcnt vmcnt(0)
  v_alignbit_b32 v21, v72, v21, 1
  v_alignbit_b32 v22, v73, v22, 1
  v_alignbit_b32 v21, v74, v21, 1
  v_alignbit_b32 v22, v75, v22, 1
  v_perm_b32 v21, v21, v22, s71
  v_cmp_ne_u32 vcc, s70, v21
  s_and_b64 vcc, vcc, s[78:79]
  s_nop 3
  s_cbranch_vccz ro_9
rr_8:
  s_sub_u32 s31, s31, 1
  s_cbranch_scc1 ro_9_x
  s_mov_b64 exec, s[78:79]
  s_add_u32 s74, s26, 0
  buffer_load_dwordx4 v[60:63], v20, s[12:15], s74 offen sc1
  s_add_u32 s74, s26, 18432
  buffer_load_dwordx4 v[64:67], v20, s[12:15], s74 offen sc1
  s_add_u32 s74, s26, 36864
  buffer_load_dwordx4 v[68:71], v20, s[12:15], s74 offen sc1
  s_add_u32 s74, s26, 55296
  buffer_load_dwordx4 v[72:75], v20, s[12:15], s74 offen sc1
  s_mov_b64 exec, -1
  s_waitcnt vmcnt(0)
  v_alignbit_b32 v21, v60, v60, 1
  v_alignbit_b32 v22, v61, v61, 1
  v_alignbit_b32 v21, v62, v21, 1
  v_alignbit_b32 v22, v63, v22, 1
  v_alignbit_b32 v21, v64, v21, 1
  v_alignbit_b32 v22, v65, v22, 1
  v_alignbit_b32 v21, v66, v21, 1
  v_alignbit_b32 v22, v67, v22, 1
  v_alignbit_b32 v21, v68, v21, 1
  v_alignbit_b32 v22, v69, v22, 1
  v_alignbit_b32 v21, v70, v21, 1
  v_alignbit_b32 v22, v71, v22, 1
  v_alignbit_b32 v21, v72, v21, 1
  v_alignbit_b32 v22, v73, v22, 1
  v_alignbit_b32 v21, v74, v21, 1
  v_alignbit_b32 v22, v75, v22, 1
  v_perm_b32 v21, v21, v22, s71
  v_cmp_ne_u32 vcc, s70, v21
  s_and_b64 vcc, vcc, s[78:79]
  s_nop 3
  s_cbranch_vccnz rr_8
  s_branch ro_9
ro_9_x:
  s_mov_b32 s31, 0
ro_9:
  v_mfma_f32_32x32x16_bf16 v[44:59], v[40:43], v[60:63], 0
  v_mfma_f32_32x32x16_bf16 v[44:59], v[40:43], v[64:67], v[44:59]
  v_mfma_f32_32x32x16_bf16 v[44:59], v[40:43], v[68:71], v[44:59]
  v_mfma_f32_32x32x16_bf16 v[44:59], v[40:43], v[72:75], v[44:59]
  s_mov_b64 exec, s[78:79]
  s_nop 10
  ds_write_b128 v13, v[44:47]
  s_mov_b64 exec, -1
  s_waitcnt lgkmcnt(0)
  s_barrier
  s_cmp_ge_u32 s3, 2
  s_cbranch_scc1 nf_10
  v_add_u32 v13, s63, v7
  ds_read_b64 v[20:21], v13 offset:9856
  ds_read_b64 v[22:23], v13 offset:11136
  ds_read_b64 v[24:25], v13 offset:12416
  ds_read_b64 v[26:27], v13 offset:13696
  s_waitcnt lgkmcnt(2)
  v_add_f32 v20, v20, v22
  v_add_f32 v21, v21, v23
  s_waitcnt lgkmcnt(0)
  v_add_f32 v24, v24, v26
  v_add_f32 v25, v25, v27
  v_add_f32 v20, v20, v24
  v_add_f32 v21, v21, v25
  v_cvt_pk_bf16_f32 v20, v20, v21
  v_mov_b32 v21, -1
  s_mov_b64 exec, s[44:45]
  buffer_store_dword v20, v16, s[12:15], s23 offen
  buffer_store_dword v21, v16, s[12:15], s24 offen
  s_mov_b64 exec, -1
nf_10:
  s_barrier
  s_mov_b32 s74, s22
  s_mov_b32 s22, s23
  s_mov_b32 s23, s24
  s_mov_b32 s24, s74
  s_xor_b32 s27, s27, 1
  s_xor_b32 s70, s70, 0xffff
  s_add_u32 s28, s28, 262144
  s_add_u32 s29, s29, 131072
  s_add_u32 s30, s30, 65536
  s_add_u32 s21, s21, 1
  s_branch C_STEP_f
C_END_f:
  v_lshrrev_b32 v15, 2, v1
  s_sub_u32 s74, s30, 0
  buffer_store_dword v9, v15, s[12:15], s74 offen sc1
  buffer_store_dword v0, v15, s[12:15], s74 offen offset:256 sc1
  s_waitcnt vmcnt(0)
  v_mov_b32 v15, 64
  s_mov_b64 exec, 1
  s_nop 0
  buffer_store_dword v15, off, s[12:15], s34 sc1
  s_mov_b64 exec, -1
  s_waitcnt vmcnt(0)
  s_branch C_FIN
C_SLOW:
  s_load_dwordx2 s[8:9], s[0:1], 144
  s_load_dwordx2 s[36:37], s[0:1], 16
  s_load_dwordx2 s[38:39], s[0:1], 24
  s_load_dwordx2 s[40:41], s[0:1], 32
  s_load_dwordx2 s[42:43], s[0:1], 40
  s_load_dwordx2 s[44:45], s[0:1], 8
  s_waitcnt lgkmcnt(0)
  s_mov_b32 s12, s8
  s_mov_b32 s13, s9
  s_mov_b32 s14, 0x8000000
  s_mov_b32 s15, 0x00020000
  v_and_b32 v20, 63, v0
  v_lshlrev_b32 v1, 4, v20
  v_lshrrev_b32 v21, 4, v20
  v_and_b32 v22, 15, v20
  v_and_b32 v23, 3, v20
  v_lshrrev_b32 v24, 2, v22
  v_mov_b32 v28, -1
  v_mov_b32 v29, -1
  v_mov_b32 v30, -1
  v_mov_b32 v31, -1
  s_mul_i32 s46, s20, 9216
  s_mul_i32 s47, s3, 2304
  s_add_u32 s46, s46, s47
  s_add_u32 s46, s46, 0x4c00000
  s_add_u32 s47, s46, 0
  buffer_store_dwordx4 v[28:31], v1, s[12:15], s47 offen sc1
  s_add_u32 s47, s46, 1024
  buffer_store_dwordx4 v[28:31], v1, s[12:15], s47 offen sc1
  s_mov_b64 exec, 0xffff
  s_add_u32 s47, s46, 2048
  buffer_store_dwordx4 v[28:31], v1, s[12:15], s47 offen sc1
  s_mov_b64 exec, -1
  s_lshl_b32 s34, s20, 2
  s_add_u32 s34, s34, s3
  s_lshl_b32 s34, s34, 7
  s_add_u32 s34, s34, 0x4e00000
  v_mov_b32 v15, 0
  s_mov_b64 exec, 1
  buffer_store_dword v15, off, s[12:15], s34 sc1
  s_mov_b64 exec, -1
  s_lshr_b32 s48, s20, 2
  s_and_b32 s49, s20, 3
  s_mul_i32 s50, s48, 72
  v_lshlrev_b32 v25, 1, v20
  v_add_u32 v25, s50, v25
  v_lshrrev_b32 v26, 3, v25
  v_lshlrev_b32 v26, 7, v26
  v_and_b32 v27, 7, v25
  v_lshlrev_b32 v27, 1, v27
  v_add_u32 v26, v26, v27
  s_and_b32 s50, s49, 1
  s_lshl_b32 s50, s50, 2
  s_lshr_b32 s51, s49, 1
  s_lshl_b32 s51, s51, 1
  s_add_u32 s50, s50, s51
  s_and_b32 s51, s3, 1
  s_add_u32 s50, s50, s51
  s_lshl_b32 s51, s50, 4
  v_add_u32 v16, s51, v26
  s_mov_b32 s4, s44
  s_mov_b32 s5, s45
  s_mov_b32 s6, 9216
  s_mov_b32 s7, 0x00020000
  s_mul_i32 s51, s50, 1152
  v_lshlrev_b32 v27, 1, v25
  v_add_u32 v27, s51, v27
  s_mov_b32 s52, -1
  s_mov_b32 s53, 15
  s_cmp_lt_u32 s3, 2
  s_cselect_b64 s[52:53], s[52:53], 0
  s_mov_b64 exec, s[52:53]
  s_waitcnt vmcnt(0)
  s_cbranch_execz C_NOINIT_s
  buffer_load_dword v32, v27, s[4:7], 0 offen
  v_mov_b32 v33, -1
  s_mov_b32 s47, 0x4d80000
  s_waitcnt vmcnt(0)
  buffer_store_dword v32, v16, s[12:15], s47 offen sc1
  s_mov_b32 s47, 0x4d82400
  buffer_store_dword v33, v16, s[12:15], s47 offen sc1
  s_mov_b32 s47, 0x4d84800
  buffer_store_dword v33, v16, s[12:15], s47 offen sc1
  s_nop 1
  s_waitcnt vmcnt(0)
C_NOINIT_s:
  s_mov_b64 exec, -1
  s_waitcnt vmcnt(0)
  s_barrier
  s_cmp_lg_u32 s3, 0
  s_cbranch_scc1 C_NOSIG_s
  s_mov_b64 exec, 1
  v_mov_b32 v32, 1
  v_mov_b32 v33, 72
  buffer_atomic_add v32, v33, s[16:19], 0 offen sc1
  s_mov_b64 exec, -1
  s_waitcnt vmcnt(0)
C_NOSIG_s:
  v_and_b32 v34, 1, v21
  s_and_b32 s50, s3, 1
  s_lshl_b32 s50, s50, 1
  s_lshr_b32 s51, s3, 1
  s_lshl_b32 s51, s51, 2
  s_add_u32 s50, s50, s51
  v_add_u32 v34, s50, v34
  v_lshlrev_b32 v34, 1, v34
  v_xor_b32 v34, v34, v22
  v_lshlrev_b32 v34, 4, v34
  v_lshlrev_b32 v35, 13, v21
  v_add_u32 v32, v34, v35
  v_lshrrev_b32 v34, 5, v20
  s_and_b32 s50, s3, 1
  s_lshl_b32 s50, s50, 1
  v_add_u32 v34, s50, v34
  v_lshlrev_b32 v34, 1, v34
  v_and_b32 v35, 7, v20
  v_xor_b32 v34, v34, v35
  v_lshlrev_b32 v34, 4, v34
  v_lshrrev_b32 v35, 3, v20
  v_mul_u32_u24 v35, 1152, v35
  v_add_u32 v33, v34, v35
  s_mov_b32 s56, s36
  s_mov_b32 s57, s37
  s_mov_b32 s58, 4718592
  s_mov_b32 s59, 0x00020000
  s_mov_b32 s60, s38
  s_mov_b32 s61, s39
  s_mov_b32 s62, 4718592
  s_mov_b32 s63, 0x00020000
  s_mov_b32 s64, s40
  s_mov_b32 s65, s41
  s_mov_b32 s66, 4718592
  s_mov_b32 s67, 0x00020000
  s_mov_b32 s68, s42
  s_mov_b32 s69, s43
  s_mov_b32 s70, 4718592
  s_mov_b32 s71, 0x00020000
  s_lshl_b32 s50, s20, 8
  s_lshl_b32 s51, s3, 15
  s_add_u32 s50, s50, s51
  s_lshl_b32 s51, s3, 10
  s_mul_i32 s72, s20, 147456
  s_mul_i32 s73, s3, 18432
  s_add_u32 s72, s72, s73
  s_lshl_b32 s73, s3, 11
  v_lshrrev_b32 v34, 1, v21
  v_lshlrev_b32 v34, 4, v34
  v_and_b32 v35, 1, v21
  v_lshlrev_b32 v36, 2, v35
  v_add_u32 v34, v34, v36
  v_lshrrev_b32 v36, 1, v24
  v_lshlrev_b32 v37, 3, v36
  v_add_u32 v34, v34, v37
  v_and_b32 v37, 1, v24
  v_add_u32 v34, v34, v37
  v_lshlrev_b32 v34, 8, v34
  v_lshlrev_b32 v35, 1, v35
  v_add_u32 v35, v35, v37
  v_lshlrev_b32 v36, 2, v36
  v_add_u32 v35, v35, v36
  v_lshlrev_b32 v35, 1, v35
  v_and_b32 v36, 1, v23
  v_lshlrev_b32 v36, 3, v36
  v_add_u32 v34, v34, v36
  v_lshrrev_b32 v36, 1, v23
  s_lshl_b32 s74, s3, 2
  s_add_u32 s74, s74, 0
  v_add_u32 v37, s74, v36
  v_xor_b32 v37, v37, v35
  v_lshlrev_b32 v37, 4, v37
  v_add_u32 v10, v34, v37
  s_lshl_b32 s74, s3, 2
  s_add_u32 s74, s74, 2
  v_add_u32 v37, s74, v36
  v_xor_b32 v37, v37, v35
  v_lshlrev_b32 v37, 4, v37
  v_add_u32 v11, v34, v37
  v_and_b32 v34, 1, v21
  v_lshlrev_b32 v35, 4, v34
  v_lshrrev_b32 v37, 1, v21
  v_lshlrev_b32 v37, 3, v37
  v_add_u32 v35, v35, v37
  v_lshrrev_b32 v37, 1, v24
  v_lshlrev_b32 v39, 2, v37
  v_add_u32 v35, v35, v39
  v_and_b32 v39, 1, v24
  v_add_u32 v35, v35, v39
  v_lshlrev_b32 v38, 7, v35
  v_lshlrev_b32 v34, 1, v34
  v_add_u32 v39, v34, v37
  v_and_b32 v34, 1, v23
  v_lshlrev_b32 v34, 3, v34
  v_add_u32 v38, v38, v34
  v_lshlrev_b32 v34, 4, v36
  v_add_u32 v38, v38, v34
  s_add_u32 s74, s50, 0
  s_add_u32 m0, s51, 0
  s_nop 0
  buffer_load_dwordx4 v32, s[56:59], s74 offen lds
  s_add_u32 s74, s50, 131072
  s_add_u32 m0, s51, 4096
  s_nop 0
  buffer_load_dwordx4 v32, s[56:59], s74 offen lds
  s_add_u32 s74, s50, 262144
  s_add_u32 m0, s51, 8192
  s_nop 0
  buffer_load_dwordx4 v32, s[56:59], s74 offen lds
  s_add_u32 s74, s50, 393216
  s_add_u32 m0, s51, 12288
  s_nop 0
  buffer_load_dwordx4 v32, s[56:59], s74 offen lds
  s_add_u32 s74, s50, 524288
  s_add_u32 m0, s51, 16384
  s_nop 0
  buffer_load_dwordx4 v32, s[56:59], s74 offen lds
  s_add_u32 s74, s50, 655360
  s_add_u32 m0, s51, 20480
  s_nop 0
  buffer_load_dwordx4 v32, s[56:59], s74 offen lds
  s_add_u32 s74, s50, 786432
  s_add_u32 m0, s51, 24576
  s_nop 0
  buffer_load_dwordx4 v32, s[56:59], s74 offen lds
  s_add_u32 s74, s50, 917504
  s_add_u32 m0, s51, 28672
  s_nop 0
  buffer_load_dwordx4 v32, s[56:59], s74 offen lds
  s_add_u32 s74, s50, 1048576
  s_add_u32 m0, s51, 32768
  s_nop 0
  buffer_load_dwordx4 v32, s[56:59], s74 offen lds
  s_add_u32 s74, s50, 1179648
  s_add_u32 m0, s51, 36864
  s_nop 0
  buffer_load_dwordx4 v32, s[56:59], s74 offen lds
  s_add_u32 s74, s50, 1310720
  s_add_u32 m0, s51, 40960
  s_nop 0
  buffer_load_dwordx4 v32, s[56:59], s74 offen lds
  s_add_u32 s74, s50, 1441792
  s_add_u32 m0, s51, 45056
  s_nop 0
  buffer_load_dwordx4 v32, s[56:59], s74 offen lds
  s_add_u32 s74, s50, 1572864
  s_add_u32 m0, s51, 49152
  s_nop 0
  buffer_load_dwordx4 v32, s[56:59], s74 offen lds
  s_add_u32 s74, s50, 1703936
  s_add_u32 m0, s51, 53248
  s_nop 0
  buffer_load_dwordx4 v32, s[56:59], s74 offen lds
  s_add_u32 s74, s50, 1835008
  s_add_u32 m0, s51, 57344
  s_nop 0
  buffer_load_dwordx4 v32, s[56:59], s74 offen lds
  s_add_u32 s74, s50, 1966080
  s_add_u32 m0, s51, 61440
  s_nop 0
  buffer_load_dwordx4 v32, s[56:59], s74 offen lds
  s_add_u32 s74, s50, 2097152
  s_add_u32 m0, s51, 65536
  s_nop 0
  buffer_load_dwordx4 v32, s[56:59], s74 offen lds
  s_add_u32 s74, s50, 2228224
  s_add_u32 m0, s51, 69632
  s_nop 0
  buffer_load_dwordx4 v32, s[56:59], s74 offen lds
  s_add_u32 s74, s50, 2359296
  s_add_u32 m0, s51, 73728
  s_nop 0
  buffer_load_dwordx4 v32, s[56:59], s74 offen lds
  s_add_u32 s74, s50, 2490368
  s_add_u32 m0, s51, 77824
  s_nop 0
  buffer_load_dwordx4 v32, s[56:59], s74 offen lds
  s_add_u32 s74, s50, 2621440
  s_add_u32 m0, s51, 81920
  s_nop 0
  buffer_load_dwordx4 v32, s[56:59], s74 offen lds
  s_add_u32 s74, s50, 2752512
  s_add_u32 m0, s51, 86016
  s_nop 0
  buffer_load_dwordx4 v32, s[56:59], s74 offen lds
  s_add_u32 s74, s50, 2883584
  s_add_u32 m0, s51, 90112
  s_nop 0
  buffer_load_dwordx4 v32, s[56:59], s74 offen lds
  s_add_u32 s74, s50, 3014656
  s_add_u32 m0, s51, 94208
  s_nop 0
  buffer_load_dwordx4 v32, s[56:59], s74 offen lds
  s_add_u32 s74, s50, 3145728
  s_add_u32 m0, s51, 98304
  s_nop 0
  buffer_load_dwordx4 v32, s[56:59], s74 offen lds
  s_add_u32 s74, s50, 3276800
  s_add_u32 m0, s51, 102400
  s_nop 0
  buffer_load_dwordx4 v32, s[56:59], s74 offen lds
  s_add_u32 s74, s50, 3407872
  s_add_u32 m0, s51, 106496
  s_nop 0
  buffer_load_dwordx4 v32, s[56:59], s74 offen lds
  s_add_u32 s74, s50, 3538944
  s_add_u32 m0, s51, 110592
  s_nop 0
  buffer_load_dwordx4 v32, s[56:59], s74 offen lds
  s_add_u32 s74, s50, 3670016
  s_add_u32 m0, s51, 114688
  s_nop 0
  buffer_load_dwordx4 v32, s[56:59], s74 offen lds
  s_add_u32 s74, s50, 3801088
  s_add_u32 m0, s51, 118784
  s_nop 0
  buffer_load_dwordx4 v32, s[56:59], s74 offen lds
  s_add_u32 s74, s50, 3932160
  s_add_u32 m0, s51, 122880
  s_nop 0
  buffer_load_dwordx4 v32, s[56:59], s74 offen lds
  s_add_u32 s74, s50, 4063232
  s_add_u32 m0, s51, 126976
  s_nop 0
  buffer_load_dwordx4 v32, s[56:59], s74 offen lds
  s_add_u32 s74, s50, 4194304
  s_add_u32 m0, s51, 131072
  s_nop 0
  buffer_load_dwordx4 v32, s[56:59], s74 offen lds
  s_add_u32 s74, s50, 4325376
  s_add_u32 m0, s51, 135168
  s_nop 0
  buffer_load_dwordx4 v32, s[56:59], s74 offen lds
  s_add_u32 s74, s50, 4456448
  s_add_u32 m0, s51, 139264
  s_nop 0
  buffer_load_dwordx4 v32, s[56:59], s74 offen lds
  s_add_u32 s74, s50, 4587520
  s_add_u32 m0, s51, 143360
  s_nop 0
  buffer_load_dwordx4 v32, s[56:59], s74 offen lds
  s_waitcnt vmcnt(18)
  s_barrier
  ds_read_b64_tr_b16 a[0:1], v10 offset:0
  ds_read_b64_tr_b16 a[2:3], v10 offset:512
  ds_read_b64_tr_b16 a[72:73], v11 offset:0
  ds_read_b64_tr_b16 a[74:75], v11 offset:512
  ds_read_b64_tr_b16 a[4:5], v10 offset:8192
  ds_read_b64_tr_b16 a[6:7], v10 offset:8704
  ds_read_b64_tr_b16 a[76:77], v11 offset:8192
  ds_read_b64_tr_b16 a[78:79], v11 offset:8704
  ds_read_b64_tr_b16 a[8:9], v10 offset:16384
  ds_read_b64_tr_b16 a[10:11], v10 offset:16896
  ds_read_b64_tr_b16 a[80:81], v11 offset:16384
  ds_read_b64_tr_b16 a[82:83], v11 offset:16896
  ds_read_b64_tr_b16 a[12:13], v10 offset:24576
  ds_read_b64_tr_b16 a[14:15], v10 offset:25088
  ds_read_b64_tr_b16 a[84:85], v11 offset:24576
  ds_read_b64_tr_b16 a[86:87], v11 offset:25088
  ds_read_b64_tr_b16 a[16:17], v10 offset:32768
  ds_read_b64_tr_b16 a[18:19], v10 offset:33280
  ds_read_b64_tr_b16 a[88:89], v11 offset:32768
  ds_read_b64_tr_b16 a[90:91], v11 offset:33280
  ds_read_b64_tr_b16 a[20:21], v10 offset:40960
  ds_read_b64_tr_b16 a[22:23], v10 offset:41472
  ds_read_b64_tr_b16 a[92:93], v11 offset:40960
  ds_read_b64_tr_b16 a[94:95], v11 offset:41472
  ds_read_b64_tr_b16 a[24:25], v10 offset:49152
  ds_read_b64_tr_b16 a[26:27], v10 offset:49664
  ds_read_b64_tr_b16 a[96:97], v11 offset:49152
  ds_read_b64_tr_b16 a[98:99], v11 offset:49664
  ds_read_b64_tr_b16 a[28:29], v10 offset:57344
  ds_read_b64_tr_b16 a[30:31], v10 offset:57856
  ds_read_b64_tr_b16 a[100:101], v11 offset:57344
  ds_read_b64_tr_b16 a[102:103], v11 offset:57856
  v_add_u32 v40, 65536, v10
  ds_read_b64_tr_b16 a[32:33], v40 offset:0
  v_add_u32 v40, 65536, v10
  ds_read_b64_tr_b16 a[34:35], v40 offset:512
  v_add_u32 v40, 65536, v11
  ds_read_b64_tr_b16 a[104:105], v40 offset:0
  v_add_u32 v40, 65536, v11
  ds_read_b64_tr_b16 a[106:107], v40 offset:512
  s_waitcnt lgkmcnt(0)
  s_barrier
  s_add_u32 s74, s50, 0
  s_add_u32 m0, s51, 0
  s_nop 0
  buffer_load_dwordx4 v32, s[60:63], s74 offen lds
  s_add_u32 s74, s50, 131072
  s_add_u32 m0, s51, 4096
  s_nop 0
  buffer_load_dwordx4 v32, s[60:63], s74 offen lds
  s_add_u32 s74, s50, 262144
  s_add_u32 m0, s51, 8192
  s_nop 0
  buffer_load_dwordx4 v32, s[60:63], s74 offen lds
  s_add_u32 s74, s50, 393216
  s_add_u32 m0, s51, 12288
  s_nop 0
  buffer_load_dwordx4 v32, s[60:63], s74 offen lds
  s_add_u32 s74, s50, 524288
  s_add_u32 m0, s51, 16384
  s_nop 0
  buffer_load_dwordx4 v32, s[60:63], s74 offen lds
  s_add_u32 s74, s50, 655360
  s_add_u32 m0, s51, 20480
  s_nop 0
  buffer_load_dwordx4 v32, s[60:63], s74 offen lds
  s_add_u32 s74, s50, 786432
  s_add_u32 m0, s51, 24576
  s_nop 0
  buffer_load_dwordx4 v32, s[60:63], s74 offen lds
  s_add_u32 s74, s50, 917504
  s_add_u32 m0, s51, 28672
  s_nop 0
  buffer_load_dwordx4 v32, s[60:63], s74 offen lds
  s_add_u32 s74, s50, 1048576
  s_add_u32 m0, s51, 32768
  s_nop 0
  buffer_load_dwordx4 v32, s[60:63], s74 offen lds
  s_add_u32 s74, s50, 1179648
  s_add_u32 m0, s51, 36864
  s_nop 0
  buffer_load_dwordx4 v32, s[60:63], s74 offen lds
  s_add_u32 s74, s50, 1310720
  s_add_u32 m0, s51, 40960
  s_nop 0
  buffer_load_dwordx4 v32, s[60:63], s74 offen lds
  s_add_u32 s74, s50, 1441792
  s_add_u32 m0, s51, 45056
  s_nop 0
  buffer_load_dwordx4 v32, s[60:63], s74 offen lds
  s_add_u32 s74, s50, 1572864
  s_add_u32 m0, s51, 49152
  s_nop 0
  buffer_load_dwordx4 v32, s[60:63], s74 offen lds
  s_add_u32 s74, s50, 1703936
  s_add_u32 m0, s51, 53248
  s_nop 0
  buffer_load_dwordx4 v32, s[60:63], s74 offen lds
  s_add_u32 s74, s50, 1835008
  s_add_u32 m0, s51, 57344
  s_nop 0
  buffer_load_dwordx4 v32, s[60:63], s74 offen lds
  s_add_u32 s74, s50, 1966080
  s_add_u32 m0, s51, 61440
  s_nop 0
  buffer_load_dwordx4 v32, s[60:63], s74 offen lds
  s_add_u32 s74, s50, 2097152
  s_add_u32 m0, s51, 65536
  s_nop 0
  buffer_load_dwordx4 v32, s[60:63], s74 offen lds
  s_add_u32 s74, s50, 2228224
  s_add_u32 m0, s51, 69632
  s_nop 0
  buffer_load_dwordx4 v32, s[60:63], s74 offen lds
  s_waitcnt vmcnt(18)
  s_barrier
  v_add_u32 v40, 65536, v10
  ds_read_b64_tr_b16 a[36:37], v40 offset:8192
  v_add_u32 v40, 65536, v10
  ds_read_b64_tr_b16 a[38:39], v40 offset:8704
  v_add_u32 v40, 65536, v11
  ds_read_b64_tr_b16 a[108:109], v40 offset:8192
  v_add_u32 v40, 65536, v11
  ds_read_b64_tr_b16 a[110:111], v40 offset:8704
  v_add_u32 v40, 65536, v10
  ds_read_b64_tr_b16 a[40:41], v40 offset:16384
  v_add_u32 v40, 65536, v10
  ds_read_b64_tr_b16 a[42:43], v40 offset:16896
  v_add_u32 v40, 65536, v11
  ds_read_b64_tr_b16 a[112:113], v40 offset:16384
  v_add_u32 v40, 65536, v11
  ds_read_b64_tr_b16 a[114:115], v40 offset:16896
  v_add_u32 v40, 65536, v10
  ds_read_b64_tr_b16 a[44:45], v40 offset:24576
  v_add_u32 v40, 65536, v10
  ds_read_b64_tr_b16 a[46:47], v40 offset:25088
  v_add_u32 v40, 65536, v11
  ds_read_b64_tr_b16 a[116:117], v40 offset:24576
  v_add_u32 v40, 65536, v11
  ds_read_b64_tr_b16 a[118:119], v40 offset:25088
  v_add_u32 v40, 65536, v10
  ds_read_b64_tr_b16 a[48:49], v40 offset:32768
  v_add_u32 v40, 65536, v10
  ds_read_b64_tr_b16 a[50:51], v40 offset:33280
  v_add_u32 v40, 65536, v11
  ds_read_b64_tr_b16 a[120:121], v40 offset:32768
  v_add_u32 v40, 65536, v11
  ds_read_b64_tr_b16 a[122:123], v40 offset:33280
  v_add_u32 v40, 65536, v10
  ds_read_b64_tr_b16 a[52:53], v40 offset:40960
  v_add_u32 v40, 65536, v10
  ds_read_b64_tr_b16 a[54:55], v40 offset:41472
  v_add_u32 v40, 65536, v11
  ds_read_b64_tr_b16 a[124:125], v40 offset:40960
  v_add_u32 v40, 65536, v11
  ds_read_b64_tr_b16 a[126:127], v40 offset:41472
  v_add_u32 v40, 65536, v10
  ds_read_b64_tr_b16 a[56:57], v40 offset:49152
  v_add_u32 v40, 65536, v10
  ds_read_b64_tr_b16 a[58:59], v40 offset:49664
  v_add_u32 v40, 65536, v11
  ds_read_b64_tr_b16 a[128:129], v40 offset:49152
  v_add_u32 v40, 65536, v11
  ds_read_b64_tr_b16 a[130:131], v40 offset:49664
  v_add_u32 v40, 65536, v10
  ds_read_b64_tr_b16 a[60:61], v40 offset:57344
  v_add_u32 v40, 65536, v10
  ds_read_b64_tr_b16 a[62:63], v40 offset:57856
  v_add_u32 v40, 65536, v11
  ds_read_b64_tr_b16 a[132:133], v40 offset:57344
  v_add_u32 v40, 65536, v11
  ds_read_b64_tr_b16 a[134:135], v40 offset:57856
  v_add_u32 v40, 131072, v10
  ds_read_b64_tr_b16 a[64:65], v40 offset:0
  v_add_u32 v40, 131072, v10
  ds_read_b64_tr_b16 a[66:67], v40 offset:512
  v_add_u32 v40, 131072, v11
  ds_read_b64_tr_b16 a[136:137], v40 offset:0
  v_add_u32 v40, 131072, v11
  ds_read_b64_tr_b16 a[138:139], v40 offset:512
  v_add_u32 v40, 131072, v10
  ds_read_b64_tr_b16 a[68:69], v40 offset:8192
  v_add_u32 v40, 131072, v10
  ds_read_b64_tr_b16 a[70:71], v40 offset:8704
  v_add_u32 v40, 131072, v11
  ds_read_b64_tr_b16 a[140:141], v40 offset:8192
  v_add_u32 v40, 131072, v11
  ds_read_b64_tr_b16 a[142:143], v40 offset:8704
  s_waitcnt lgkmcnt(0)
  s_barrier
  s_add_u32 s74, s50, 2359296
  s_add_u32 m0, s51, 73728
  s_nop 0
  buffer_load_dwordx4 v32, s[60:63], s74 offen lds
  s_add_u32 s74, s50, 2490368
  s_add_u32 m0, s51, 77824
  s_nop 0
  buffer_load_dwordx4 v32, s[60:63], s74 offen lds
  s_add_u32 s74, s50, 2621440
  s_add_u32 m0, s51, 81920
  s_nop 0
  buffer_load_dwordx4 v32, s[60:63], s74 offen lds
  s_add_u32 s74, s50, 2752512
  s_add_u32 m0, s51, 86016
  s_nop 0
  buffer_load_dwordx4 v32, s[60:63], s74 offen lds
  s_add_u32 s74, s50, 2883584
  s_add_u32 m0, s51, 90112
  s_nop 0
  buffer_load_dwordx4 v32, s[60:63], s74 offen lds
  s_add_u32 s74, s50, 3014656
  s_add_u32 m0, s51, 94208
  s_nop 0
  buffer_load_dwordx4 v32, s[60:63], s74 offen lds
  s_add_u32 s74, s50, 3145728
  s_add_u32 m0, s51, 98304
  s_nop 0
  buffer_load_dwordx4 v32, s[60:63], s74 offen lds
  s_add_u32 s74, s50, 3276800
  s_add_u32 m0, s51, 102400
  s_nop 0
  buffer_load_dwordx4 v32, s[60:63], s74 offen lds
  s_add_u32 s74, s50, 3407872
  s_add_u32 m0, s51, 106496
  s_nop 0
  buffer_load_dwordx4 v32, s[60:63], s74 offen lds
  s_add_u32 s74, s50, 3538944
  s_add_u32 m0, s51, 110592
  s_nop 0
  buffer_load_dwordx4 v32, s[60:63], s74 offen lds
  s_add_u32 s74, s50, 3670016
  s_add_u32 m0, s51, 114688
  s_nop 0
  buffer_load_dwordx4 v32, s[60:63], s74 offen lds
  s_add_u32 s74, s50, 3801088
  s_add_u32 m0, s51, 118784
  s_nop 0
  buffer_load_dwordx4 v32, s[60:63], s74 offen lds
  s_add_u32 s74, s50, 3932160
  s_add_u32 m0, s51, 122880
  s_nop 0
  buffer_load_dwordx4 v32, s[60:63], s74 offen lds
  s_add_u32 s74, s50, 4063232
  s_add_u32 m0, s51, 126976
  s_nop 0
  buffer_load_dwordx4 v32, s[60:63], s74 offen lds
  s_add_u32 s74, s50, 4194304
  s_add_u32 m0, s51, 131072
  s_nop 0
  buffer_load_dwordx4 v32, s[60:63], s74 offen lds
  s_add_u32 s74, s50, 4325376
  s_add_u32 m0, s51, 135168
  s_nop 0
  buffer_load_dwordx4 v32, s[60:63], s74 offen lds
  s_add_u32 s74, s50, 4456448
  s_add_u32 m0, s51, 139264
  s_nop 0
  buffer_load_dwordx4 v32, s[60:63], s74 offen lds
  s_add_u32 s74, s50, 4587520
  s_add_u32 m0, s51, 143360
  s_nop 0
  buffer_load_dwordx4 v32, s[60:63], s74 offen lds
  s_waitcnt vmcnt(18)
  s_barrier
  ds_read_b64_tr_b16 a[144:145], v10 offset:0
  ds_read_b64_tr_b16 a[146:147], v10 offset:512
  ds_read_b64_tr_b16 a[216:217], v11 offset:0
  ds_read_b64_tr_b16 a[218:219], v11 offset:512
  ds_read_b64_tr_b16 a[148:149], v10 offset:8192
  ds_read_b64_tr_b16 a[150:151], v10 offset:8704
  ds_read_b64_tr_b16 a[220:221], v11 offset:8192
  ds_read_b64_tr_b16 a[222:223], v11 offset:8704
  ds_read_b64_tr_b16 a[152:153], v10 offset:16384
  ds_read_b64_tr_b16 a[154:155], v10 offset:16896
  ds_read_b64_tr_b16 a[224:225], v11 offset:16384
  ds_read_b64_tr_b16 a[226:227], v11 offset:16896
  ds_read_b64_tr_b16 a[156:157], v10 offset:24576
  ds_read_b64_tr_b16 a[158:159], v10 offset:25088
  ds_read_b64_tr_b16 a[228:229], v11 offset:24576
  ds_read_b64_tr_b16 a[230:231], v11 offset:25088
  ds_read_b64_tr_b16 a[160:161], v10 offset:32768
  ds_read_b64_tr_b16 a[162:163], v10 offset:33280
  ds_read_b64_tr_b16 a[232:233], v11 offset:32768
  ds_read_b64_tr_b16 a[234:235], v11 offset:33280
  ds_read_b64_tr_b16 a[164:165], v10 offset:40960
  ds_read_b64_tr_b16 a[166:167], v10 offset:41472
  ds_read_b64_tr_b16 a[236:237], v11 offset:40960
  ds_read_b64_tr_b16 a[238:239], v11 offset:41472
  ds_read_b64_tr_b16 a[168:169], v10 offset:49152
  ds_read_b64_tr_b16 a[170:171], v10 offset:49664
  ds_read_b64_tr_b16 a[240:241], v11 offset:49152
  ds_read_b64_tr_b16 a[242:243], v11 offset:49664
  ds_read_b64_tr_b16 a[172:173], v10 offset:57344
  ds_read_b64_tr_b16 a[174:175], v10 offset:57856
  ds_read_b64_tr_b16 a[244:245], v11 offset:57344
  ds_read_b64_tr_b16 a[246:247], v11 offset:57856
  v_add_u32 v40, 65536, v10
  ds_read_b64_tr_b16 a[176:177], v40 offset:0
  v_add_u32 v40, 65536, v10
  ds_read_b64_tr_b16 a[178:179], v40 offset:512
  v_add_u32 v40, 65536, v11
  ds_read_b64_tr_b16 a[248:249], v40 offset:0
  v_add_u32 v40, 65536, v11
  ds_read_b64_tr_b16 a[250:251], v40 offset:512
  s_waitcnt lgkmcnt(0)
  s_barrier
  s_add_u32 s74, s72, 0
  s_add_u32 m0, s73, 0
  s_nop 0
  buffer_load_dwordx4 v33, s[68:71], s74 offen lds
  s_add_u32 s74, s72, 9216
  s_add_u32 m0, s73, 1024
  s_nop 0
  buffer_load_dwordx4 v33, s[68:71], s74 offen lds
  s_add_u32 s74, s72, 128
  s_add_u32 m0, s73, 8192
  s_nop 0
  buffer_load_dwordx4 v33, s[68:71], s74 offen lds
  s_add_u32 s74, s72, 9344
  s_add_u32 m0, s73, 9216
  s_nop 0
  buffer_load_dwordx4 v33, s[68:71], s74 offen lds
  s_add_u32 s74, s72, 256
  s_add_u32 m0, s73, 16384
  s_nop 0
  buffer_load_dwordx4 v33, s[68:71], s74 offen lds
  s_add_u32 s74, s72, 9472
  s_add_u32 m0, s73, 17408
  s_nop 0
  buffer_load_dwordx4 v33, s[68:71], s74 offen lds
  s_add_u32 s74, s72, 384
  s_add_u32 m0, s73, 24576
  s_nop 0
  buffer_load_dwordx4 v33, s[68:71], s74 offen lds
  s_add_u32 s74, s72, 9600
  s_add_u32 m0, s73, 25600
  s_nop 0
  buffer_load_dwordx4 v33, s[68:71], s74 offen lds
  s_add_u32 s74, s72, 512
  s_add_u32 m0, s73, 32768
  s_nop 0
  buffer_load_dwordx4 v33, s[68:71], s74 offen lds
  s_add_u32 s74, s72, 9728
  s_add_u32 m0, s73, 33792
  s_nop 0
  buffer_load_dwordx4 v33, s[68:71], s74 offen lds
  s_add_u32 s74, s72, 640
  s_add_u32 m0, s73, 40960
  s_nop 0
  buffer_load_dwordx4 v33, s[68:71], s74 offen lds
  s_add_u32 s74, s72, 9856
  s_add_u32 m0, s73, 41984
  s_nop 0
  buffer_load_dwordx4 v33, s[68:71], s74 offen lds
  s_add_u32 s74, s72, 768
  s_add_u32 m0, s73, 49152
  s_nop 0
  buffer_load_dwordx4 v33, s[68:71], s74 offen lds
  s_add_u32 s74, s72, 9984
  s_add_u32 m0, s73, 50176
  s_nop 0
  buffer_load_dwordx4 v33, s[68:71], s74 offen lds
  s_add_u32 s74, s72, 896
  s_add_u32 m0, s73, 57344
  s_nop 0
  buffer_load_dwordx4 v33, s[68:71], s74 offen lds
  s_add_u32 s74, s72, 10112
  s_add_u32 m0, s73, 58368
  s_nop 0
  buffer_load_dwordx4 v33, s[68:71], s74 offen lds
  s_add_u32 s74, s72, 1024
  s_add_u32 m0, s73, 65536
  s_nop 0
  buffer_load_dwordx4 v33, s[68:71], s74 offen lds
  s_add_u32 s74, s72, 10240
  s_add_u32 m0, s73, 66560
  s_nop 0
  buffer_load_dwordx4 v33, s[68:71], s74 offen lds
  s_waitcnt vmcnt(18)
  s_barrier
  v_add_u32 v40, 65536, v10
  ds_read_b64_tr_b16 a[180:181], v40 offset:8192
  v_add_u32 v40, 65536, v10
  ds_read_b64_tr_b16 a[182:183], v40 offset:8704
  v_add_u32 v40, 65536, v11
  ds_read_b64_tr_b16 a[252:253], v40 offset:8192
  v_add_u32 v40, 65536, v11
  ds_read_b64_tr_b16 a[254:255], v40 offset:8704
  v_add_u32 v40, 65536, v10
  ds_read_b64_tr_b16 a[184:185], v40 offset:16384
  v_add_u32 v40, 65536, v10
  ds_read_b64_tr_b16 a[186:187], v40 offset:16896
  v_add_u32 v40, 65536, v11
  ds_read_b64_tr_b16 v[80:81], v40 offset:16384
  v_add_u32 v40, 65536, v11
  ds_read_b64_tr_b16 v[82:83], v40 offset:16896
  v_add_u32 v40, 65536, v10
  ds_read_b64_tr_b16 a[188:189], v40 offset:24576
  v_add_u32 v40, 65536, v10
  ds_read_b64_tr_b16 a[190:191], v40 offset:25088
  v_add_u32 v40, 65536, v11
  ds_read_b64_tr_b16 v[84:85], v40 offset:24576
  v_add_u32 v40, 65536, v11
  ds_read_b64_tr_b16 v[86:87], v40 offset:25088
  v_add_u32 v40, 65536, v10
  ds_read_b64_tr_b16 a[192:193], v40 offset:32768
  v_add_u32 v40, 65536, v10
  ds_read_b64_tr_b16 a[194:195], v40 offset:33280
  v_add_u32 v40, 65536, v11
  ds_read_b64_tr_b16 v[88:89], v40 offset:32768
  v_add_u32 v40, 65536, v11
  ds_read_b64_tr_b16 v[90:91], v40 offset:33280
  v_add_u32 v40, 65536, v10
  ds_read_b64_tr_b16 a[196:197], v40 offset:40960
  v_add_u32 v40, 65536, v10
  ds_read_b64_tr_b16 a[198:199], v40 offset:41472
  v_add_u32 v40, 65536, v11
  ds_read_b64_tr_b16 v[92:93], v40 offset:40960
  v_add_u32 v40, 65536, v11
  ds_read_b64_tr_b16 v[94:95], v40 offset:41472
  v_add_u32 v40, 65536, v10
  ds_read_b64_tr_b16 a[200:201], v40 offset:49152
  v_add_u32 v40, 65536, v10
  ds_read_b64_tr_b16 a[202:203], v40 offset:49664
  v_add_u32 v40, 65536, v11
  ds_read_b64_tr_b16 v[96:97], v40 offset:49152
  v_add_u32 v40, 65536, v11
  ds_read_b64_tr_b16 v[98:99], v40 offset:49664
  v_add_u32 v40, 65536, v10
  ds_read_b64_tr_b16 a[204:205], v40 offset:57344
  v_add_u32 v40, 65536, v10
  ds_read_b64_tr_b16 a[206:207], v40 offset:57856
  v_add_u32 v40, 65536, v11
  ds_read_b64_tr_b16 v[100:101], v40 offset:57344
  v_add_u32 v40, 65536, v11
  ds_read_b64_tr_b16 v[102:103], v40 offset:57856
  v_add_u32 v40, 131072, v10
  ds_read_b64_tr_b16 a[208:209], v40 offset:0
  v_add_u32 v40, 131072, v10
  ds_read_b64_tr_b16 a[210:211], v40 offset:512
  v_add_u32 v40, 131072, v11
  ds_read_b64_tr_b16 v[104:105], v40 offset:0
  v_add_u32 v40, 131072, v11
  ds_read_b64_tr_b16 v[106:107], v40 offset:512
  v_add_u32 v40, 131072, v10
  ds_read_b64_tr_b16 a[212:213], v40 offset:8192
  v_add_u32 v40, 131072, v10
  ds_read_b64_tr_b16 a[214:215], v40 offset:8704
  v_add_u32 v40, 131072, v11
  ds_read_b64_tr_b16 v[108:109], v40 offset:8192
  v_add_u32 v40, 131072, v11
  ds_read_b64_tr_b16 v[110:111], v40 offset:8704
  s_waitcnt lgkmcnt(0)
  s_barrier
  s_add_u32 s74, s72, 73728
  s_add_u32 m0, s73, 73728
  s_nop 0
  buffer_load_dwordx4 v33, s[68:71], s74 offen lds
  s_add_u32 s74, s72, 82944
  s_add_u32 m0, s73, 74752
  s_nop 0
  buffer_load_dwordx4 v33, s[68:71], s74 offen lds
  s_add_u32 s74, s72, 73856
  s_add_u32 m0, s73, 81920
  s_nop 0
  buffer_load_dwordx4 v33, s[68:71], s74 offen lds
  s_add_u32 s74, s72, 83072
  s_add_u32 m0, s73, 82944
  s_nop 0
  buffer_load_dwordx4 v33, s[68:71], s74 offen lds
  s_add_u32 s74, s72, 73984
  s_add_u32 m0, s73, 90112
  s_nop 0
  buffer_load_dwordx4 v33, s[68:71], s74 offen lds
  s_add_u32 s74, s72, 83200
  s_add_u32 m0, s73, 91136
  s_nop 0
  buffer_load_dwordx4 v33, s[68:71], s74 offen lds
  s_add_u32 s74, s72, 74112
  s_add_u32 m0, s73, 98304
  s_nop 0
  buffer_load_dwordx4 v33, s[68:71], s74 offen lds
  s_add_u32 s74, s72, 83328
  s_add_u32 m0, s73, 99328
  s_nop 0
  buffer_load_dwordx4 v33, s[68:71], s74 offen lds
  s_add_u32 s74, s72, 74240
  s_add_u32 m0, s73, 106496
  s_nop 0
  buffer_load_dwordx4 v33, s[68:71], s74 offen lds
  s_add_u32 s74, s72, 83456
  s_add_u32 m0, s73, 107520
  s_nop 0
  buffer_load_dwordx4 v33, s[68:71], s74 offen lds
  s_add_u32 s74, s72, 74368
  s_add_u32 m0, s73, 114688
  s_nop 0
  buffer_load_dwordx4 v33, s[68:71], s74 offen lds
  s_add_u32 s74, s72, 83584
  s_add_u32 m0, s73, 115712
  s_nop 0
  buffer_load_dwordx4 v33, s[68:71], s74 offen lds
  s_add_u32 s74, s72, 74496
  s_add_u32 m0, s73, 122880
  s_nop 0
  buffer_load_dwordx4 v33, s[68:71], s74 offen lds
  s_add_u32 s74, s72, 83712
  s_add_u32 m0, s73, 123904
  s_nop 0
  buffer_load_dwordx4 v33, s[68:71], s74 offen lds
  s_add_u32 s74, s72, 74624
  s_add_u32 m0, s73, 131072
  s_nop 0
  buffer_load_dwordx4 v33, s[68:71], s74 offen lds
  s_add_u32 s74, s72, 83840
  s_add_u32 m0, s73, 132096
  s_nop 0
  buffer_load_dwordx4 v33, s[68:71], s74 offen lds
  s_add_u32 s74, s72, 74752
  s_add_u32 m0, s73, 139264
  s_nop 0
  buffer_load_dwordx4 v33, s[68:71], s74 offen lds
  s_add_u32 s74, s72, 83968
  s_add_u32 m0, s73, 140288
  s_nop 0
  buffer_load_dwordx4 v33, s[68:71], s74 offen lds
  s_waitcnt vmcnt(18)
  s_barrier
  s_mul_i32 s74, s3, 9
  s_add_u32 s74, s74, 0
  s_and_b32 s75, s74, 3
  s_lshr_b32 s74, s74, 2
  s_lshl_b32 s74, s74, 13
  s_add_u32 s74, s74, 0
  v_xor_b32 v41, s75, v39
  v_lshlrev_b32 v41, 5, v41
  v_add_u32 v41, v41, v38
  v_add_u32 v41, s74, v41
  ds_read_b64_tr_b16 v[112:113], v41 offset:0
  ds_read_b64_tr_b16 v[114:115], v41 offset:256
  ds_read_b64_tr_b16 v[116:117], v41 offset:4096
  ds_read_b64_tr_b16 v[118:119], v41 offset:4352
  s_mul_i32 s74, s3, 9
  s_add_u32 s74, s74, 1
  s_and_b32 s75, s74, 3
  s_lshr_b32 s74, s74, 2
  s_lshl_b32 s74, s74, 13
  s_add_u32 s74, s74, 0
  v_xor_b32 v41, s75, v39
  v_lshlrev_b32 v41, 5, v41
  v_add_u32 v41, v41, v38
  v_add_u32 v41, s74, v41
  ds_read_b64_tr_b16 v[128:129], v41 offset:0
  ds_read_b64_tr_b16 v[130:131], v41 offset:256
  ds_read_b64_tr_b16 v[132:133], v41 offset:4096
  ds_read_b64_tr_b16 v[134:135], v41 offset:4352
  s_mul_i32 s74, s3, 9
  s_add_u32 s74, s74, 2
  s_and_b32 s75, s74, 3
  s_lshr_b32 s74, s74, 2
  s_lshl_b32 s74, s74, 13
  s_add_u32 s74, s74, 0
  v_xor_b32 v41, s75, v39
  v_lshlrev_b32 v41, 5, v41
  v_add_u32 v41, v41, v38
  v_add_u32 v41, s74, v41
  ds_read_b64_tr_b16 v[144:145], v41 offset:0
  ds_read_b64_tr_b16 v[146:147], v41 offset:256
  ds_read_b64_tr_b16 v[148:149], v41 offset:4096
  ds_read_b64_tr_b16 v[150:151], v41 offset:4352
  s_mul_i32 s74, s3, 9
  s_add_u32 s74, s74, 3
  s_and_b32 s75, s74, 3
  s_lshr_b32 s74, s74, 2
  s_lshl_b32 s74, s74, 13
  s_add_u32 s74, s74, 0
  v_xor_b32 v41, s75, v39
  v_lshlrev_b32 v41, 5, v41
  v_add_u32 v41, v41, v38
  v_add_u32 v41, s74, v41
  ds_read_b64_tr_b16 v[160:161], v41 offset:0
  ds_read_b64_tr_b16 v[162:163], v41 offset:256
  ds_read_b64_tr_b16 v[164:165], v41 offset:4096
  ds_read_b64_tr_b16 v[166:167], v41 offset:4352
  s_mul_i32 s74, s3, 9
  s_add_u32 s74, s74, 4
  s_and_b32 s75, s74, 3
  s_lshr_b32 s74, s74, 2
  s_lshl_b32 s74, s74, 13
  s_add_u32 s74, s74, 0
  v_xor_b32 v41, s75, v39
  v_lshlrev_b32 v41, 5, v41
  v_add_u32 v41, v41, v38
  v_add_u32 v41, s74, v41
  ds_read_b64_tr_b16 v[176:177], v41 offset:0
  ds_read_b64_tr_b16 v[178:179], v41 offset:256
  ds_read_b64_tr_b16 v[180:181], v41 offset:4096
  ds_read_b64_tr_b16 v[182:183], v41 offset:4352
  s_mul_i32 s74, s3, 9
  s_add_u32 s74, s74, 5
  s_and_b32 s75, s74, 3
  s_lshr_b32 s74, s74, 2
  s_lshl_b32 s74, s74, 13
  s_add_u32 s74, s74, 0
  v_xor_b32 v41, s75, v39
  v_lshlrev_b32 v41, 5, v41
  v_add_u32 v41, v41, v38
  v_add_u32 v41, s74, v41
  ds_read_b64_tr_b16 v[192:193], v41 offset:0
  ds_read_b64_tr_b16 v[194:195], v41 offset:256
  ds_read_b64_tr_b16 v[196:197], v41 offset:4096
  ds_read_b64_tr_b16 v[198:199], v41 offset:4352
  s_mul_i32 s74, s3, 9
  s_add_u32 s74, s74, 6
  s_and_b32 s75, s74, 3
  s_lshr_b32 s74, s74, 2
  s_lshl_b32 s74, s74, 13
  s_add_u32 s74, s74, 0
  v_xor_b32 v41, s75, v39
  v_lshlrev_b32 v41, 5, v41
  v_add_u32 v41, v41, v38
  v_add_u32 v41, s74, v41
  ds_read_b64_tr_b16 v[208:209], v41 offset:0
  ds_read_b64_tr_b16 v[210:211], v41 offset:256
  ds_read_b64_tr_b16 v[212:213], v41 offset:4096
  ds_read_b64_tr_b16 v[214:215], v41 offset:4352
  s_mul_i32 s74, s3, 9
  s_add_u32 s74, s74, 7
  s_and_b32 s75, s74, 3
  s_lshr_b32 s74, s74, 2
  s_lshl_b32 s74, s74, 13
  s_add_u32 s74, s74, 0
  v_xor_b32 v41, s75, v39
  v_lshlrev_b32 v41, 5, v41
  v_add_u32 v41, v41, v38
  v_add_u32 v41, s74, v41
  ds_read_b64_tr_b16 v[224:225], v41 offset:0
  ds_read_b64_tr_b16 v[226:227], v41 offset:256
  ds_read_b64_tr_b16 v[228:229], v41 offset:4096
  ds_read_b64_tr_b16 v[230:231], v41 offset:4352
  s_mul_i32 s74, s3, 9
  s_add_u32 s74, s74, 8
  s_and_b32 s75, s74, 3
  s_lshr_b32 s74, s74, 2
  s_lshl_b32 s74, s74, 13
  s_add_u32 s74, s74, 0
  v_xor_b32 v41, s75, v39
  v_lshlrev_b32 v41, 5, v41
  v_add_u32 v41, v41, v38
  v_add_u32 v41, s74, v41
  ds_read_b64_tr_b16 v[240:241], v41 offset:0
  ds_read_b64_tr_b16 v[242:243], v41 offset:256
  ds_read_b64_tr_b16 v[244:245], v41 offset:4096
  ds_read_b64_tr_b16 v[246:247], v41 offset:4352
  s_waitcnt lgkmcnt(0)
  s_barrier
  s_add_u32 s74, s50, 0
  s_add_u32 m0, s51, 0
  s_nop 0
  buffer_load_dwordx4 v32, s[64:67], s74 offen lds
  s_add_u32 s74, s50, 131072
  s_add_u32 m0, s51, 4096
  s_nop 0
  buffer_load_dwordx4 v32, s[64:67], s74 offen lds
  s_add_u32 s74, s50, 262144
  s_add_u32 m0, s51, 8192
  s_nop 0
  buffer_load_dwordx4 v32, s[64:67], s74 offen lds
  s_add_u32 s74, s50, 393216
  s_add_u32 m0, s51, 12288
  s_nop 0
  buffer_load_dwordx4 v32, s[64:67], s74 offen lds
  s_add_u32 s74, s50, 524288
  s_add_u32 m0, s51, 16384
  s_nop 0
  buffer_load_dwordx4 v32, s[64:67], s74 offen lds
  s_add_u32 s74, s50, 655360
  s_add_u32 m0, s51, 20480
  s_nop 0
  buffer_load_dwordx4 v32, s[64:67], s74 offen lds
  s_add_u32 s74, s50, 786432
  s_add_u32 m0, s51, 24576
  s_nop 0
  buffer_load_dwordx4 v32, s[64:67], s74 offen lds
  s_add_u32 s74, s50, 917504
  s_add_u32 m0, s51, 28672
  s_nop 0
  buffer_load_dwordx4 v32, s[64:67], s74 offen lds
  s_add_u32 s74, s50, 1048576
  s_add_u32 m0, s51, 32768
  s_nop 0
  buffer_load_dwordx4 v32, s[64:67], s74 offen lds
  s_add_u32 s74, s50, 1179648
  s_add_u32 m0, s51, 36864
  s_nop 0
  buffer_load_dwordx4 v32, s[64:67], s74 offen lds
  s_add_u32 s74, s50, 1310720
  s_add_u32 m0, s51, 40960
  s_nop 0
  buffer_load_dwordx4 v32, s[64:67], s74 offen lds
  s_add_u32 s74, s50, 1441792
  s_add_u32 m0, s51, 45056
  s_nop 0
  buffer_load_dwordx4 v32, s[64:67], s74 offen lds
  s_add_u32 s74, s50, 1572864
  s_add_u32 m0, s51, 49152
  s_nop 0
  buffer_load_dwordx4 v32, s[64:67], s74 offen lds
  s_add_u32 s74, s50, 1703936
  s_add_u32 m0, s51, 53248
  s_nop 0
  buffer_load_dwordx4 v32, s[64:67], s74 offen lds
  s_add_u32 s74, s50, 1835008
  s_add_u32 m0, s51, 57344
  s_nop 0
  buffer_load_dwordx4 v32, s[64:67], s74 offen lds
  s_add_u32 s74, s50, 1966080
  s_add_u32 m0, s51, 61440
  s_nop 0
  buffer_load_dwordx4 v32, s[64:67], s74 offen lds
  s_add_u32 s74, s50, 2097152
  s_add_u32 m0, s51, 65536
  s_nop 0
  buffer_load_dwordx4 v32, s[64:67], s74 offen lds
  s_add_u32 s74, s50, 2228224
  s_add_u32 m0, s51, 69632
  s_nop 0
  buffer_load_dwordx4 v32, s[64:67], s74 offen lds
  s_waitcnt vmcnt(18)
  s_barrier
  s_mul_i32 s74, s3, 9
  s_add_u32 s74, s74, 0
  s_and_b32 s75, s74, 3
  s_lshr_b32 s74, s74, 2
  s_lshl_b32 s74, s74, 13
  s_add_u32 s74, s74, 73728
  v_xor_b32 v41, s75, v39
  v_lshlrev_b32 v41, 5, v41
  v_add_u32 v41, v41, v38
  v_add_u32 v41, s74, v41
  ds_read_b64_tr_b16 v[120:121], v41 offset:0
  ds_read_b64_tr_b16 v[122:123], v41 offset:256
  ds_read_b64_tr_b16 v[124:125], v41 offset:4096
  ds_read_b64_tr_b16 v[126:127], v41 offset:4352
  s_mul_i32 s74, s3, 9
  s_add_u32 s74, s74, 1
  s_and_b32 s75, s74, 3
  s_lshr_b32 s74, s74, 2
  s_lshl_b32 s74, s74, 13
  s_add_u32 s74, s74, 73728
  v_xor_b32 v41, s75, v39
  v_lshlrev_b32 v41, 5, v41
  v_add_u32 v41, v41, v38
  v_add_u32 v41, s74, v41
  ds_read_b64_tr_b16 v[136:137], v41 offset:0
  ds_read_b64_tr_b16 v[138:139], v41 offset:256
  ds_read_b64_tr_b16 v[140:141], v41 offset:4096
  ds_read_b64_tr_b16 v[142:143], v41 offset:4352
  s_mul_i32 s74, s3, 9
  s_add_u32 s74, s74, 2
  s_and_b32 s75, s74, 3
  s_lshr_b32 s74, s74, 2
  s_lshl_b32 s74, s74, 13
  s_add_u32 s74, s74, 73728
  v_xor_b32 v41, s75, v39
  v_lshlrev_b32 v41, 5, v41
  v_add_u32 v41, v41, v38
  v_add_u32 v41, s74, v41
  ds_read_b64_tr_b16 v[152:153], v41 offset:0
  ds_read_b64_tr_b16 v[154:155], v41 offset:256
  ds_read_b64_tr_b16 v[156:157], v41 offset:4096
  ds_read_b64_tr_b16 v[158:159], v41 offset:4352
  s_mul_i32 s74, s3, 9
  s_add_u32 s74, s74, 3
  s_and_b32 s75, s74, 3
  s_lshr_b32 s74, s74, 2
  s_lshl_b32 s74, s74, 13
  s_add_u32 s74, s74, 73728
  v_xor_b32 v41, s75, v39
  v_lshlrev_b32 v41, 5, v41
  v_add_u32 v41, v41, v38
  v_add_u32 v41, s74, v41
  ds_read_b64_tr_b16 v[168:169], v41 offset:0
  ds_read_b64_tr_b16 v[170:171], v41 offset:256
  ds_read_b64_tr_b16 v[172:173], v41 offset:4096
  ds_read_b64_tr_b16 v[174:175], v41 offset:4352
  s_mul_i32 s74, s3, 9
  s_add_u32 s74, s74, 4
  s_and_b32 s75, s74, 3
  s_lshr_b32 s74, s74, 2
  s_lshl_b32 s74, s74, 13
  s_add_u32 s74, s74, 73728
  v_xor_b32 v41, s75, v39
  v_lshlrev_b32 v41, 5, v41
  v_add_u32 v41, v41, v38
  v_add_u32 v41, s74, v41
  ds_read_b64_tr_b16 v[184:185], v41 offset:0
  ds_read_b64_tr_b16 v[186:187], v41 offset:256
  ds_read_b64_tr_b16 v[188:189], v41 offset:4096
  ds_read_b64_tr_b16 v[190:191], v41 offset:4352
  s_mul_i32 s74, s3, 9
  s_add_u32 s74, s74, 5
  s_and_b32 s75, s74, 3
  s_lshr_b32 s74, s74, 2
  s_lshl_b32 s74, s74, 13
  s_add_u32 s74, s74, 73728
  v_xor_b32 v41, s75, v39
  v_lshlrev_b32 v41, 5, v41
  v_add_u32 v41, v41, v38
  v_add_u32 v41, s74, v41
  ds_read_b64_tr_b16 v[200:201], v41 offset:0
  ds_read_b64_tr_b16 v[202:203], v41 offset:256
  ds_read_b64_tr_b16 v[204:205], v41 offset:4096
  ds_read_b64_tr_b16 v[206:207], v41 offset:4352
  s_mul_i32 s74, s3, 9
  s_add_u32 s74, s74, 6
  s_and_b32 s75, s74, 3
  s_lshr_b32 s74, s74, 2
  s_lshl_b32 s74, s74, 13
  s_add_u32 s74, s74, 73728
  v_xor_b32 v41, s75, v39
  v_lshlrev_b32 v41, 5, v41
  v_add_u32 v41, v41, v38
  v_add_u32 v41, s74, v41
  ds_read_b64_tr_b16 v[216:217], v41 offset:0
  ds_read_b64_tr_b16 v[218:219], v41 offset:256
  ds_read_b64_tr_b16 v[220:221], v41 offset:4096
  ds_read_b64_tr_b16 v[222:223], v41 offset:4352
  s_mul_i32 s74, s3, 9
  s_add_u32 s74, s74, 7
  s_and_b32 s75, s74, 3
  s_lshr_b32 s74, s74, 2
  s_lshl_b32 s74, s74, 13
  s_add_u32 s74, s74, 73728
  v_xor_b32 v41, s75, v39
  v_lshlrev_b32 v41, 5, v41
  v_add_u32 v41, v41, v38
  v_add_u32 v41, s74, v41
  ds_read_b64_tr_b16 v[232:233], v41 offset:0
  ds_read_b64_tr_b16 v[234:235], v41 offset:256
  ds_read_b64_tr_b16 v[236:237], v41 offset:4096
  ds_read_b64_tr_b16 v[238:239], v41 offset:4352
  s_mul_i32 s74, s3, 9
  s_add_u32 s74, s74, 8
  s_and_b32 s75, s74, 3
  s_lshr_b32 s74, s74, 2
  s_lshl_b32 s74, s74, 13
  s_add_u32 s74, s74, 73728
  v_xor_b32 v41, s75, v39
  v_lshlrev_b32 v41, 5, v41
  v_add_u32 v41, v41, v38
  v_add_u32 v41, s74, v41
  ds_read_b64_tr_b16 v[248:249], v41 offset:0
  ds_read_b64_tr_b16 v[250:251], v41 offset:256
  ds_read_b64_tr_b16 v[252:253], v41 offset:4096
  ds_read_b64_tr_b16 v[254:255], v41 offset:4352
  s_waitcnt lgkmcnt(0)
  s_barrier
  s_add_u32 s74, s50, 2359296
  s_add_u32 m0, s51, 73728
  s_nop 0
  buffer_load_dwordx4 v32, s[64:67], s74 offen lds
  s_add_u32 s74, s50, 2490368
  s_add_u32 m0, s51, 77824
  s_nop 0
  buffer_load_dwordx4 v32, s[64:67], s74 offen lds
  s_add_u32 s74, s50, 2621440
  s_add_u32 m0, s51, 81920
  s_nop 0
  buffer_load_dwordx4 v32, s[64:67], s74 offen lds
  s_add_u32 s74, s50, 2752512
  s_add_u32 m0, s51, 86016
  s_nop 0
  buffer_load_dwordx4 v32, s[64:67], s74 offen lds
  s_add_u32 s74, s50, 2883584
  s_add_u32 m0, s51, 90112
  s_nop 0
  buffer_load_dwordx4 v32, s[64:67], s74 offen lds
  s_add_u32 s74, s50, 3014656
  s_add_u32 m0, s51, 94208
  s_nop 0
  buffer_load_dwordx4 v32, s[64:67], s74 offen lds
  s_add_u32 s74, s50, 3145728
  s_add_u32 m0, s51, 98304
  s_nop 0
  buffer_load_dwordx4 v32, s[64:67], s74 offen lds
  s_add_u32 s74, s50, 3276800
  s_add_u32 m0, s51, 102400
  s_nop 0
  buffer_load_dwordx4 v32, s[64:67], s74 offen lds
  s_add_u32 s74, s50, 3407872
  s_add_u32 m0, s51, 106496
  s_nop 0
  buffer_load_dwordx4 v32, s[64:67], s74 offen lds
  s_add_u32 s74, s50, 3538944
  s_add_u32 m0, s51, 110592
  s_nop 0
  buffer_load_dwordx4 v32, s[64:67], s74 offen lds
  s_add_u32 s74, s50, 3670016
  s_add_u32 m0, s51, 114688
  s_nop 0
  buffer_load_dwordx4 v32, s[64:67], s74 offen lds
  s_add_u32 s74, s50, 3801088
  s_add_u32 m0, s51, 118784
  s_nop 0
  buffer_load_dwordx4 v32, s[64:67], s74 offen lds
  s_add_u32 s74, s50, 3932160
  s_add_u32 m0, s51, 122880
  s_nop 0
  buffer_load_dwordx4 v32, s[64:67], s74 offen lds
  s_add_u32 s74, s50, 4063232
  s_add_u32 m0, s51, 126976
  s_nop 0
  buffer_load_dwordx4 v32, s[64:67], s74 offen lds
  s_add_u32 s74, s50, 4194304
  s_add_u32 m0, s51, 131072
  s_nop 0
  buffer_load_dwordx4 v32, s[64:67], s74 offen lds
  s_add_u32 s74, s50, 4325376
  s_add_u32 m0, s51, 135168
  s_nop 0
  buffer_load_dwordx4 v32, s[64:67], s74 offen lds
  s_add_u32 s74, s50, 4456448
  s_add_u32 m0, s51, 139264
  s_nop 0
  buffer_load_dwordx4 v32, s[64:67], s74 offen lds
  s_add_u32 s74, s50, 4587520
  s_add_u32 m0, s51, 143360
  s_nop 0
  buffer_load_dwordx4 v32, s[64:67], s74 offen lds
  s_waitcnt vmcnt(0)
  s_barrier
  s_lshl_b32 s74, s3, 12
  v_add_u32 v42, s74, v1
  ds_read_b64_tr_b16 v[44:45], v10 offset:0
  ds_read_b64_tr_b16 v[46:47], v10 offset:512
  ds_read_b64_tr_b16 v[48:49], v10 offset:8192
  ds_read_b64_tr_b16 v[50:51], v10 offset:8704
  ds_read_b64_tr_b16 v[52:53], v11 offset:0
  ds_read_b64_tr_b16 v[54:55], v11 offset:512
  ds_read_b64_tr_b16 v[56:57], v11 offset:8192
  ds_read_b64_tr_b16 v[58:59], v11 offset:8704
  ds_read_b64_tr_b16 v[60:61], v10 offset:16384
  ds_read_b64_tr_b16 v[62:63], v10 offset:16896
  ds_read_b64_tr_b16 v[64:65], v10 offset:24576
  ds_read_b64_tr_b16 v[66:67], v10 offset:25088
  ds_read_b64_tr_b16 v[68:69], v11 offset:16384
  ds_read_b64_tr_b16 v[70:71], v11 offset:16896
  ds_read_b64_tr_b16 v[72:73], v11 offset:24576
  ds_read_b64_tr_b16 v[74:75], v11 offset:25088
  s_waitcnt lgkmcnt(0)
  s_barrier
  v_add_u32 v43, 0, v42
  ds_write_b128 v43, v[44:47] offset:0
  ds_write_b128 v43, v[48:51] offset:1024
  ds_write_b128 v43, v[52:55] offset:2048
  ds_write_b128 v43, v[56:59] offset:3072
  v_add_u32 v43, 16384, v42
  ds_write_b128 v43, v[60:63] offset:0
  ds_write_b128 v43, v[64:67] offset:1024
  ds_write_b128 v43, v[68:71] offset:2048
  ds_write_b128 v43, v[72:75] offset:3072
  s_waitcnt lgkmcnt(0)
  ds_read_b64_tr_b16 v[44:45], v10 offset:32768
  ds_read_b64_tr_b16 v[46:47], v10 offset:33280
  ds_read_b64_tr_b16 v[48:49], v10 offset:40960
  ds_read_b64_tr_b16 v[50:51], v10 offset:41472
  ds_read_b64_tr_b16 v[52:53], v11 offset:32768
  ds_read_b64_tr_b16 v[54:55], v11 offset:33280
  ds_read_b64_tr_b16 v[56:57], v11 offset:40960
  ds_read_b64_tr_b16 v[58:59], v11 offset:41472
  ds_read_b64_tr_b16 v[60:61], v10 offset:49152
  ds_read_b64_tr_b16 v[62:63], v10 offset:49664
  ds_read_b64_tr_b16 v[64:65], v10 offset:57344
  ds_read_b64_tr_b16 v[66:67], v10 offset:57856
  ds_read_b64_tr_b16 v[68:69], v11 offset:49152
  ds_read_b64_tr_b16 v[70:71], v11 offset:49664
  ds_read_b64_tr_b16 v[72:73], v11 offset:57344
  ds_read_b64_tr_b16 v[74:75], v11 offset:57856
  s_waitcnt lgkmcnt(0)
  s_barrier
  v_add_u32 v43, 32768, v42
  ds_write_b128 v43, v[44:47] offset:0
  ds_write_b128 v43, v[48:51] offset:1024
  ds_write_b128 v43, v[52:55] offset:2048
  ds_write_b128 v43, v[56:59] offset:3072
  v_add_u32 v43, 49152, v42
  ds_write_b128 v43, v[60:63] offset:0
  ds_write_b128 v43, v[64:67] offset:1024
  ds_write_b128 v43, v[68:71] offset:2048
  ds_write_b128 v43, v[72:75] offset:3072
  s_waitcnt lgkmcnt(0)
  v_add_u32 v40, 65536, v10
  ds_read_b64_tr_b16 v[44:45], v40 offset:0
  v_add_u32 v40, 65536, v10
  ds_read_b64_tr_b16 v[46:47], v40 offset:512
  v_add_u32 v40, 65536, v10
  ds_read_b64_tr_b16 v[48:49], v40 offset:8192
  v_add_u32 v40, 65536, v10
  ds_read_b64_tr_b16 v[50:51], v40 offset:8704
  v_add_u32 v40, 65536, v11
  ds_read_b64_tr_b16 v[52:53], v40 offset:0
  v_add_u32 v40, 65536, v11
  ds_read_b64_tr_b16 v[54:55], v40 offset:512
  v_add_u32 v40, 65536, v11
  ds_read_b64_tr_b16 v[56:57], v40 offset:8192
  v_add_u32 v40, 65536, v11
  ds_read_b64_tr_b16 v[58:59], v40 offset:8704
  v_add_u32 v40, 65536, v10
  ds_read_b64_tr_b16 v[60:61], v40 offset:16384
  v_add_u32 v40, 65536, v10
  ds_read_b64_tr_b16 v[62:63], v40 offset:16896
  v_add_u32 v40, 65536, v10
  ds_read_b64_tr_b16 v[64:65], v40 offset:24576
  v_add_u32 v40, 65536, v10
  ds_read_b64_tr_b16 v[66:67], v40 offset:25088
  v_add_u32 v40, 65536, v11
  ds_read_b64_tr_b16 v[68:69], v40 offset:16384
  v_add_u32 v40, 65536, v11
  ds_read_b64_tr_b16 v[70:71], v40 offset:16896
  v_add_u32 v40, 65536, v11
  ds_read_b64_tr_b16 v[72:73], v40 offset:24576
  v_add_u32 v40, 65536, v11
  ds_read_b64_tr_b16 v[74:75], v40 offset:25088
  s_waitcnt lgkmcnt(0)
  s_barrier
  v_add_u32 v43, 65536, v42
  ds_write_b128 v43, v[44:47] offset:0
  ds_write_b128 v43, v[48:51] offset:1024
  ds_write_b128 v43, v[52:55] offset:2048
  ds_write_b128 v43, v[56:59] offset:3072
  v_add_u32 v43, 81920, v42
  ds_write_b128 v43, v[60:63] offset:0
  ds_write_b128 v43, v[64:67] offset:1024
  ds_write_b128 v43, v[68:71] offset:2048
  ds_write_b128 v43, v[72:75] offset:3072
  s_waitcnt lgkmcnt(0)
  v_add_u32 v40, 65536, v10
  ds_read_b64_tr_b16 v[44:45], v40 offset:32768
  v_add_u32 v40, 65536, v10
  ds_read_b64_tr_b16 v[46:47], v40 offset:33280
  v_add_u32 v40, 65536, v10
  ds_read_b64_tr_b16 v[48:49], v40 offset:40960
  v_add_u32 v40, 65536, v10
  ds_read_b64_tr_b16 v[50:51], v40 offset:41472
  v_add_u32 v40, 65536, v11
  ds_read_b64_tr_b16 v[52:53], v40 offset:32768
  v_add_u32 v40, 65536, v11
  ds_read_b64_tr_b16 v[54:55], v40 offset:33280
  v_add_u32 v40, 65536, v11
  ds_read_b64_tr_b16 v[56:57], v40 offset:40960
  v_add_u32 v40, 65536, v11
  ds_read_b64_tr_b16 v[58:59], v40 offset:41472
  v_add_u32 v40, 65536, v10
  ds_read_b64_tr_b16 v[60:61], v40 offset:49152
  v_add_u32 v40, 65536, v10
  ds_read_b64_tr_b16 v[62:63], v40 offset:49664
  v_add_u32 v40, 65536, v10
  ds_read_b64_tr_b16 v[64:65], v40 offset:57344
  v_add_u32 v40, 65536, v10
  ds_read_b64_tr_b16 v[66:67], v40 offset:57856
  v_add_u32 v40, 65536, v11
  ds_read_b64_tr_b16 v[68:69], v40 offset:49152
  v_add_u32 v40, 65536, v11
  ds_read_b64_tr_b16 v[70:71], v40 offset:49664
  v_add_u32 v40, 65536, v11
  ds_read_b64_tr_b16 v[72:73], v40 offset:57344
  v_add_u32 v40, 65536, v11
  ds_read_b64_tr_b16 v[74:75], v40 offset:57856
  s_waitcnt lgkmcnt(0)
  s_barrier
  v_add_u32 v43, 98304, v42
  ds_write_b128 v43, v[44:47] offset:0
  ds_write_b128 v43, v[48:51] offset:1024
  ds_write_b128 v43, v[52:55] offset:2048
  ds_write_b128 v43, v[56:59] offset:3072
  v_add_u32 v43, 114688, v42
  ds_write_b128 v43, v[60:63] offset:0
  ds_write_b128 v43, v[64:67] offset:1024
  ds_write_b128 v43, v[68:71] offset:2048
  ds_write_b128 v43, v[72:75] offset:3072
  s_waitcnt lgkmcnt(0)
  v_add_u32 v40, 131072, v10
  ds_read_b64_tr_b16 v[44:45], v40 offset:0
  v_add_u32 v40, 131072, v10
  ds_read_b64_tr_b16 v[46:47], v40 offset:512
  v_add_u32 v40, 131072, v10
  ds_read_b64_tr_b16 v[48:49], v40 offset:8192
  v_add_u32 v40, 131072, v10
  ds_read_b64_tr_b16 v[50:51], v40 offset:8704
  v_add_u32 v40, 131072, v11
  ds_read_b64_tr_b16 v[52:53], v40 offset:0
  v_add_u32 v40, 131072, v11
  ds_read_b64_tr_b16 v[54:55], v40 offset:512
  v_add_u32 v40, 131072, v11
  ds_read_b64_tr_b16 v[56:57], v40 offset:8192
  v_add_u32 v40, 131072, v11
  ds_read_b64_tr_b16 v[58:59], v40 offset:8704
  s_waitcnt lgkmcnt(0)
  s_barrier
  v_add_u32 v43, 131072, v42
  ds_write_b128 v43, v[44:47] offset:0
  ds_write_b128 v43, v[48:51] offset:1024
  ds_write_b128 v43, v[52:55] offset:2048
  ds_write_b128 v43, v[56:59] offset:3072
  s_waitcnt lgkmcnt(0)
  v_mov_b32 v10, v42
  v_mov_b32 v11, v42
  s_barrier
  v_mov_b32 v2, 0x44444444
  v_mov_b32 v34, 0xeeeeeeee
  v_cmp_gt_u32 vcc, 8, v22
  s_nop 1
  v_cndmask_b32 v2, v34, v2, vcc
  s_mul_i32 s74, s3, 1280
  s_add_u32 s74, s74, 156672
  v_and_b32 v34, 1, v21
  v_lshlrev_b32 v34, 2, v34
  v_lshrrev_b32 v35, 1, v21
  v_lshlrev_b32 v35, 1, v35
  v_add_u32 v34, v34, v35
  v_mul_u32_u24 v34, 80, v34
  v_lshlrev_b32 v35, 2, v22
  v_add_u32 v34, v34, v35
  v_add_u32 v3, s74, v34
  v_and_b32 v34, 7, v20
  v_mul_u32_u24 v34, 80, v34
  v_lshlrev_b32 v35, 4, v21
  v_add_u32 v34, v34, v35
  v_add_u32 v4, s74, v34
  v_and_b32 v34, 1, v24
  v_lshlrev_b32 v34, 2, v34
  v_lshrrev_b32 v36, 1, v24
  v_lshlrev_b32 v36, 1, v36
  v_add_u32 v34, v34, v36
  v_and_b32 v36, 1, v22
  v_add_u32 v34, v34, v36
  v_mul_u32_u24 v34, 80, v34
  v_add_u32 v34, v34, v35
  v_add_u32 v5, s74, v34
  v_add_u32 v5, 640, v5
  v_add_u32 v6, s74, v1
  v_add_u32 v7, 147456, v1
  v_lshlrev_b32 v35, 2, v20
  v_add_u32 v18, 157696, v35
  s_mul_i32 s75, s3, 1280
  v_add_u32 v19, s75, v18
  v_lshlrev_b32 v34, 3, v21
  v_and_b32 v35, 7, v20
  v_add_u32 v34, v34, v35
  v_lshlrev_b32 v35, 4, v34
  s_lshl_b32 s75, s3, 9
  s_add_u32 s75, s75, 161792
  v_add_u32 v8, s75, v35
  v_mul_u32_u24 v34, 2304, v21
  v_lshlrev_b32 v35, 2, v22
  v_add_u32 v34, v34, v35
  s_mul_i32 s75, s3, 576
  v_add_u32 v12, s75, v34
  v_mul_u32_u24 v35, 12, v22
  v_add_u32 v9, v12, v35
  v_and_b32 v34, 31, v20
  v_lshrrev_b32 v35, 2, v34
  v_lshlrev_b32 v35, 1, v35
  v_and_b32 v36, 1, v34
  v_add_u32 v17, v35, v36
  v_mov_b32 v36, 99
  v_cmp_gt_u32 vcc, 8, v34
  s_nop 1
  v_cndmask_b32 v17, v36, v17, vcc
  v_and_b32 v36, 2, v34
  v_mov_b32 v14, 0x3f80
  v_mov_b32 v35, 0x3f800000
  v_cmp_eq_u32 vcc, 2, v36
  s_nop 1
  v_cndmask_b32 v14, v14, v35, vcc
  s_mov_b32 s21, 0
  s_mov_b32 s22, 0x4d80000
  s_mov_b32 s23, 0x4d82400
  s_mov_b32 s24, 0x4d84800
  s_mul_i32 s80, s20, 9216
  s_add_u32 s80, s80, 0x4c00000
  s_mul_i32 s81, s49, 2304
  s_mul_i32 s74, s48, 288
  s_add_u32 s81, s81, s74
  s_mul_i32 s74, s3, 73728
  s_add_u32 s81, s81, s74
  s_add_u32 s81, s81, 0x4c00000
  s_mul_i32 s70, s3, 2304
  s_add_u32 s70, s70, s80
  s_mov_b32 s25, s80
  s_mov_b32 s26, s81
  s_mov_b32 s27, 0
  s_mov_b32 s70, 0
  s_lshl_b32 s28, s20, 13
  s_lshl_b32 s74, s3, 11
  s_add_u32 s28, s28, s74
  s_lshl_b32 s29, s20, 12
  s_lshl_b32 s74, s3, 10
  s_add_u32 s29, s29, s74
  s_add_u32 s29, s29, 0x4000000
  s_lshl_b32 s30, s20, 11
  s_lshl_b32 s74, s3, 9
  s_add_u32 s30, s30, s74
  s_add_u32 s30, s30, 0x4800000
  s_mov_b32 s31, 0x20000
  s_mov_b32 s68, 0x3db504f3
  s_mov_b32 s69, 0x3fb8aa3b
  s_mov_b32 s76, 0x00ff00ff
  s_mov_b32 s77, s76
  s_mov_b32 s78, 0x3ffff
  s_mov_b32 s79, 0x3ffff
  s_lshl_b32 s64, s3, 11
  s_lshl_b32 s74, s3, 4
  s_mov_b64 s[66:67], 0xffff
  s_lshl_b64 s[66:67], s[66:67], s74
  s_mul_i32 s65, s3, 1280
  s_add_u32 s65, s65, 157312
  s_and_b32 s63, s3, 1
  s_lshl_b32 s63, s63, 3
  s_mov_b32 s44, -1
  s_mov_b32 s45, 15
  s_mov_b32 s71, 0x0c0c0703
  v_mov_b32 v33, 72
  s_mov_b32 s74, 0
  s_nop 0
C_RDY_s:
  buffer_load_dword v32, v33, s[16:19], 0 offen sc1
  s_waitcnt vmcnt(0)
  v_readfirstlane_b32 s75, v32
  s_add_u32 s74, s74, 1
  s_cmp_ge_u32 s75, 32
  s_nop 2
  s_cbranch_scc1 C_GO_s
  s_cmp_lt_u32 s74, 20000
  s_cbranch_scc1 C_RDY_s
C_GO_s:
  s_waitcnt vmcnt(0)
  s_barrier
  s_mov_b32 s33, 0
  s_add_u32 s74, s21, 0
  s_lshr_b32 s74, s74, 2
  s_min_u32 s74, s74, 15
  s_cmp_lt_u32 s74, s33
  s_cbranch_scc1 pw_11
  v_lshrrev_b32 v28, 2, v1
  v_add_u32 v28, 128, v28
  s_mov_b32 s75, 0
pl_12:
  s_mov_b64 exec, 0xffff
  buffer_load_dword v29, v28, s[16:19], 0 offen sc1
  s_waitcnt vmcnt(0)
  v_cmp_eq_u32 vcc, 0xc0, v29
  s_mov_b64 exec, -1
  s_nop 4
  s_not_b32 s33, vcc_lo
  s_ff1_i32_b32 s33, s33
  s_add_u32 s75, s75, 1
  s_cmp_lt_u32 s74, s33
  s_cbranch_scc1 pw_11
  s_cmp_lt_u32 s75, 100000
  s_cbranch_scc1 pl_12
pw_11:
  buffer_load_dwordx4 v[32:35], v1, s[12:15], s28 offen
  buffer_load_dwordx4 v[76:79], v1, s[12:15], s28 offen offset:1024
  s_waitcnt vmcnt(0)
C_STEP_s:
  s_add_u32 s72, s22, s64
  s_add_u32 s73, s22, 8192
  v_mov_b64 v[28:29], 0
  v_mov_b64 v[30:31], 0
  ds_read_b128 v[60:63], v10 offset:0
  ds_read_b128 v[64:67], v10 offset:1024
  ds_read_b128 v[68:71], v10 offset:16384
  ds_read_b128 v[72:75], v10 offset:17408
  v_mov_b64 v[36:37], 0
  v_mov_b64 v[38:39], 0
  v_mov_b64 v[40:41], 0
  v_mov_b64 v[42:43], 0
  v_mov_b64 v[44:45], 0
  v_mov_b64 v[46:47], 0
  v_mov_b64 v[48:49], 0
  v_mov_b64 v[50:51], 0
  v_mov_b64 v[52:53], 0
  v_mov_b64 v[54:55], 0
  v_mov_b64 v[56:57], 0
  v_mov_b64 v[58:59], 0
  buffer_load_dwordx4 v[20:23], v1, s[12:15], s72 offen sc1
  buffer_load_dwordx4 v[24:27], v1, s[12:15], s72 offen offset:1024 sc1
  s_mov_b64 exec, s[66:67]
  buffer_load_dwordx4 v[28:31], v1, s[12:15], s73 offen sc1
  s_mov_b64 exec, -1
  v_add_u32 v13, s64, v7
  s_waitcnt vmcnt(2)
  v_max3_u32 v15, v20, v21, v22
  s_waitcnt vmcnt(1)
  v_max3_u32 v15, v15, v23, v24
  v_max3_u32 v15, v15, v25, v26
  s_waitcnt vmcnt(0)
  v_max3_u32 v15, v15, v27, v28
  v_max3_u32 v15, v15, v29, v30
  v_max_u32 v15, v15, v31
  v_cmp_eq_u32 vcc, -1, v15
  s_nop 4
  s_cbranch_vccz mok_13
mrt_14:
  s_sub_u32 s31, s31, 1
  s_cbranch_scc1 mok_13_x
  buffer_load_dwordx4 v[20:23], v1, s[12:15], s72 offen sc1
  buffer_load_dwordx4 v[24:27], v1, s[12:15], s72 offen offset:1024 sc1
  s_mov_b64 exec, s[66:67]
  buffer_load_dwordx4 v[28:31], v1, s[12:15], s73 offen sc1
  s_mov_b64 exec, -1
  s_waitcnt vmcnt(0)
  v_max3_u32 v15, v20, v21, v22
  v_max3_u32 v15, v15, v23, v24
  v_max3_u32 v15, v15, v25, v26
  v_max3_u32 v15, v15, v27, v28
  v_max3_u32 v15, v15, v29, v30
  v_max_u32 v15, v15, v31
  v_cmp_eq_u32 vcc, -1, v15
  s_nop 4
  s_cbranch_vccnz mrt_14
  s_branch mok_13
mok_13_x:
  s_mov_b32 s31, 0
mok_13:
  ds_write_b128 v13, v[20:23]
  ds_write_b128 v13, v[24:27] offset:1024
  s_mov_b64 exec, s[66:67]
  ds_write_b128 v7, v[28:31] offset:8192
  s_mov_b64 exec, -1
  s_cmp_eq_u32 s21, 0
  s_cbranch_scc1 sk_15
  v_lshrrev_b32 v15, 2, v1
  s_sub_u32 s74, s30, 65536
  buffer_store_dword v9, v15, s[12:15], s74 offen sc1
  buffer_store_dword v0, v15, s[12:15], s74 offen offset:256 sc1
  s_sub_u32 s74, s21, 1
  v_mov_b32 v15, s74
  s_mov_b64 exec, 1
  s_nop 0
  buffer_store_dword v15, off, s[12:15], s34 sc1
  s_mov_b64 exec, -1
sk_15:
  v_lshlrev_b32 v15, 2, v1
  s_add_u32 s75, s28, 0x1040000
  s_mov_b32 exec_hi, 0
  buffer_load_dword v0, v15, s[12:15], s75 offen
  s_add_u32 s74, s28, 524288
  s_min_u32 s74, s74, 0xfff800
  buffer_load_dword v0, v15, s[12:15], s74 offen
  s_mov_b64 exec, -1
  s_waitcnt lgkmcnt(0)
  s_barrier
  ds_read_b128 v[20:23], v7 offset:0
  ds_read_b128 v[24:27], v7 offset:1024
  ds_read_b128 v[28:31], v7 offset:2048
  s_waitcnt lgkmcnt(2)
  v_smfmac_f32_16x16x64_bf16 v[36:39], v[20:23], a[0:7], v2
  v_smfmac_f32_16x16x64_bf16 v[44:47], v[20:23], a[144:151], v2
  v_smfmac_f32_16x16x64_bf16 v[40:43], v[20:23], a[72:79], v2
  v_smfmac_f32_16x16x64_bf16 v[48:51], v[20:23], a[216:223], v2
  v_smfmac_f32_16x16x64_bf16 v[52:55], v[20:23], v[60:67], v2
  ds_read_b128 v[20:23], v7 offset:3072
  ds_read_b128 v[60:63], v10 offset:32768
  ds_read_b128 v[64:67], v10 offset:33792
  s_waitcnt lgkmcnt(4)
  v_smfmac_f32_16x16x64_bf16 v[36:39], v[24:27], a[8:15], v2
  v_smfmac_f32_16x16x64_bf16 v[44:47], v[24:27], a[152:159], v2
  v_smfmac_f32_16x16x64_bf16 v[40:43], v[24:27], a[80:87], v2
  v_smfmac_f32_16x16x64_bf16 v[48:51], v[24:27], a[224:231], v2
  v_smfmac_f32_16x16x64_bf16 v[52:55], v[24:27], v[68:75], v2
  ds_read_b128 v[24:27], v7 offset:4096
  ds_read_b128 v[68:71], v10 offset:49152
  ds_read_b128 v[72:75], v10 offset:50176
  s_waitcnt lgkmcnt(6)
  v_smfmac_f32_16x16x64_bf16 v[36:39], v[28:31], a[16:23], v2
  v_smfmac_f32_16x16x64_bf16 v[44:47], v[28:31], a[160:167], v2
  v_smfmac_f32_16x16x64_bf16 v[40:43], v[28:31], a[88:95], v2
  v_smfmac_f32_16x16x64_bf16 v[48:51], v[28:31], a[232:239], v2
  s_waitcnt lgkmcnt(3)
  v_smfmac_f32_16x16x64_bf16 v[52:55], v[28:31], v[60:67], v2
  ds_read_b128 v[28:31], v7 offset:5120
  v_add_u32 v10, 0x10000, v10
  ds_read_b128 v[60:63], v10 offset:0
  ds_read_b128 v[64:67], v10 offset:1024
  v_smfmac_f32_16x16x64_bf16 v[36:39], v[20:23], a[24:31], v2
  v_smfmac_f32_16x16x64_bf16 v[44:47], v[20:23], a[168:175], v2
  v_smfmac_f32_16x16x64_bf16 v[40:43], v[20:23], a[96:103], v2
  v_smfmac_f32_16x16x64_bf16 v[48:51], v[20:23], a[240:247], v2
  s_waitcnt lgkmcnt(3)
  v_smfmac_f32_16x16x64_bf16 v[52:55], v[20:23], v[68:75], v2
  ds_read_b128 v[20:23], v7 offset:6144
  ds_read_b128 v[68:71], v10 offset:16384
  ds_read_b128 v[72:75], v10 offset:17408
  v_smfmac_f32_16x16x64_bf16 v[36:39], v[24:27], a[32:39], v2
  v_smfmac_f32_16x16x64_bf16 v[44:47], v[24:27], a[176:183], v2
  v_smfmac_f32_16x16x64_bf16 v[40:43], v[24:27], a[104:111], v2
  v_smfmac_f32_16x16x64_bf16 v[48:51], v[24:27], a[248:255], v2
  s_waitcnt lgkmcnt(3)
  v_smfmac_f32_16x16x64_bf16 v[52:55], v[24:27], v[60:67], v2
  ds_read_b128 v[24:27], v7 offset:7168
  ds_read_b128 v[60:63], v10 offset:32768
  ds_read_b128 v[64:67], v10 offset:33792
  v_smfmac_f32_16x16x64_bf16 v[36:39], v[28:31], a[40:47], v2
  v_smfmac_f32_16x16x64_bf16 v[44:47], v[28:31], a[184:191], v2
  v_smfmac_f32_16x16x64_bf16 v[40:43], v[28:31], a[112:119], v2
  v_smfmac_f32_16x16x64_bf16 v[48:51], v[28:31], v[80:87], v2
  s_waitcnt lgkmcnt(3)
  v_smfmac_f32_16x16x64_bf16 v[52:55], v[28:31], v[68:75], v2
  ds_read_b128 v[28:31], v7 offset:8192
  ds_read_b128 v[68:71], v10 offset:49152
  ds_read_b128 v[72:75], v10 offset:50176
  v_smfmac_f32_16x16x64_bf16 v[36:39], v[20:23], a[48:55], v2
  v_smfmac_f32_16x16x64_bf16 v[44:47], v[20:23], a[192:199], v2
  v_smfmac_f32_16x16x64_bf16 v[40:43], v[20:23], a[120:127], v2
  v_smfmac_f32_16x16x64_bf16 v[48:51], v[20:23], v[88:95], v2
  s_waitcnt lgkmcnt(3)
  v_smfmac_f32_16x16x64_bf16 v[52:55], v[20:23], v[60:67], v2
  v_add_u32 v10, 0x10000, v10
  ds_read_b128 v[60:63], v10 offset:0
  ds_read_b128 v[64:67], v10 offset:1024
  v_smfmac_f32_16x16x64_bf16 v[36:39], v[24:27], a[56:63], v2
  v_smfmac_f32_16x16x64_bf16 v[44:47], v[24:27], a[200:207], v2
  v_smfmac_f32_16x16x64_bf16 v[40:43], v[24:27], a[128:135], v2
  v_smfmac_f32_16x16x64_bf16 v[48:51], v[24:27], v[96:103], v2
  s_waitcnt lgkmcnt(2)
  v_smfmac_f32_16x16x64_bf16 v[52:55], v[24:27], v[68:75], v2
  ds_read_b128 v[68:71], v11 offset:2048
  ds_read_b128 v[72:75], v11 offset:3072
  v_smfmac_f32_16x16x64_bf16 v[36:39], v[28:31], a[64:71], v2
  v_smfmac_f32_16x16x64_bf16 v[44:47], v[28:31], a[208:215], v2
  v_smfmac_f32_16x16x64_bf16 v[40:43], v[28:31], a[136:143], v2
  v_smfmac_f32_16x16x64_bf16 v[48:51], v[28:31], v[104:111], v2
  s_waitcnt lgkmcnt(2)
  v_smfmac_f32_16x16x64_bf16 v[52:55], v[28:31], v[60:67], v2
  v_subrev_u32 v10, 0x20000, v10
  ds_read_b128 v[20:23], v7 offset:0
  ds_read_b128 v[24:27], v7 offset:1024
  ds_read_b128 v[60:63], v11 offset:18432
  ds_read_b128 v[64:67], v11 offset:19456
  v_permlane32_swap_b32 v36, v38
  v_permlane32_swap_b32 v37, v39
  v_permlane32_swap_b32 v40, v42
  v_permlane32_swap_b32 v41, v43
  v_permlane32_swap_b32 v44, v46
  v_permlane32_swap_b32 v45, v47
  v_permlane32_swap_b32 v48, v50
  v_permlane32_swap_b32 v49, v51
  v_add_f32 v36, v36, v38
  v_add_f32 v37, v37, v39
  v_add_f32 v40, v40, v42
  v_add_f32 v41, v41, v43
  v_add_f32 v44, v44, v46
  v_add_f32 v45, v45, v47
  v_add_f32 v48, v48, v50
  v_add_f32 v49, v49, v51
  v_cvt_pk_bf16_f32 v36, v36, v40
  v_cvt_pk_bf16_f32 v37, v37, v41
  v_cvt_pk_bf16_f32 v38, v44, v48
  v_cvt_pk_bf16_f32 v39, v45, v49
  ds_write_b32 v3, v36
  ds_write_b32 v3, v37 offset:80
  ds_write_b32 v3, v38 offset:640
  ds_write_b32 v3, v39 offset:720
  ds_read_b128 v[40:43], v4
  ds_read_b128 v[44:47], v5
  s_waitcnt lgkmcnt(9)
  v_smfmac_f32_16x16x64_bf16 v[56:59], v[20:23], v[68:75], v2
  ds_read_b128 v[20:23], v7 offset:2048
  ds_read_b128 v[68:71], v11 offset:34816
  ds_read_b128 v[72:75], v11 offset:35840
  v_permlane32_swap_b32 v52, v54
  v_permlane32_swap_b32 v53, v55
  v_add_f32 v52, v52, v54
  v_add_f32 v53, v53, v55
  v_cvt_pk_bf16_f32 v52, v52, v53
  v_mov_b32 v53, 0
  v_mov_b32 v9, v52
  s_waitcnt lgkmcnt(9)
  v_smfmac_f32_16x16x64_bf16 v[56:59], v[24:27], v[60:67], v2
  ds_read_b128 v[24:27], v7 offset:3072
  ds_read_b128 v[60:63], v11 offset:51200
  ds_read_b128 v[64:67], v11 offset:52224
  s_waitcnt lgkmcnt(7)
  v_mfma_f32_16x16x32_bf16 v[48:51], v[32:35], v[40:43], 0
  v_mfma_f32_16x16x32_bf16 v[28:31], v[76:79], v[40:43], 0
  s_waitcnt lgkmcnt(6)
  v_mfma_f32_16x16x32_bf16 v[36:39], v[44:47], v[40:43], 0
  s_add_u32 s74, s28, 0x1000000
  buffer_load_dwordx4 v[76:79], v1, s[12:15], s74 offen
  buffer_load_dwordx4 v[32:35], v1, s[12:15], s74 offen offset:1024
  buffer_store_dwordx4 v[44:47], v1, s[12:15], s29 offen sc1
  s_nop 1
  v_cndmask_b32 v40, v28, v48, s[76:77]
  v_cndmask_b32 v41, v29, v49, s[76:77]
  v_cndmask_b32 v42, v30, v50, s[76:77]
  v_cndmask_b32 v43, v31, v51, s[76:77]
  v_cndmask_b32 v44, v37, v36, s[76:77]
  ds_write_b128 v6, v[40:43]
  ds_write_b32 v19, v44
  s_waitcnt lgkmcnt(0)
  s_barrier
  ds_read_b128 v[28:31], v7 offset:9216
  ds_read_b32 v44, v18 offset:0
  ds_read_b128 v[36:39], v7 offset:10496
  ds_read_b32 v45, v18 offset:1280
  ds_read_b128 v[48:51], v7 offset:11776
  ds_read_b32 v46, v18 offset:2560
  ds_read_b128 v[40:43], v7 offset:13056
  ds_read_b32 v47, v18 offset:3840
  v_smfmac_f32_16x16x64_bf16 v[56:59], v[20:23], v[68:75], v2
  ds_read_b128 v[20:23], v7 offset:4096
  v_add_u32 v11, 0x10000, v11
  ds_read_b128 v[68:71], v11 offset:2048
  ds_read_b128 v[72:75], v11 offset:3072
  s_waitcnt lgkmcnt(8)
  v_pk_add_f32 v[28:29], v[28:29], v[36:37]
  v_pk_add_f32 v[30:31], v[30:31], v[38:39]
  s_waitcnt lgkmcnt(4)
  v_pk_add_f32 v[48:49], v[48:49], v[40:41]
  v_pk_add_f32 v[50:51], v[50:51], v[42:43]
  s_waitcnt lgkmcnt(3)
  v_pk_add_f32 v[44:45], v[44:45], v[46:47]
  v_pk_add_f32 v[28:29], v[28:29], v[48:49]
  v_pk_add_f32 v[30:31], v[30:31], v[50:51]
  v_add_f32 v44, v44, v45
  v_cvt_pk_bf16_f32 v36, v28, v29
  v_cvt_pk_bf16_f32 v37, v30, v31
  v_cvt_pk_bf16_f32 v38, v44, v44
  v_lshlrev_b32 v28, 16, v36
  v_and_b32 v29, 0xffff0000, v36
  v_lshlrev_b32 v30, 16, v37
  v_and_b32 v31, 0xffff0000, v37
  v_lshlrev_b32 v44, 16, v38
  v_smfmac_f32_16x16x64_bf16 v[56:59], v[24:27], v[60:67], v2
  ds_read_b128 v[24:27], v7 offset:5120
  ds_read_b128 v[60:63], v11 offset:18432
  ds_read_b128 v[64:67], v11 offset:19456
  v_mul_f32 v28, s68, v28
  v_mul_f32 v29, s68, v29
  v_mul_f32 v30, s68, v30
  v_mul_f32 v31, s68, v31
  v_mul_f32 v44, s68, v44
  v_cvt_pk_bf16_f32 v36, v28, v29
  v_cvt_pk_bf16_f32 v37, v30, v31
  v_cvt_pk_bf16_f32 v38, v44, v44
  v_lshlrev_b32 v28, 16, v36
  v_and_b32 v29, 0xffff0000, v36
  v_lshlrev_b32 v30, 16, v37
  v_and_b32 v31, 0xffff0000, v37
  v_lshlrev_b32 v44, 16, v38
  s_waitcnt lgkmcnt(3)
  v_smfmac_f32_16x16x64_bf16 v[56:59], v[20:23], v[68:75], v2
  ds_read_b128 v[20:23], v7 offset:6144
  ds_read_b128 v[68:71], v11 offset:34816
  ds_read_b128 v[72:75], v11 offset:35840
  v_max3_f32 v36, v28, v29, v30
  v_max3_f32 v36, v36, v31, v44
  v_mov_b32 v37, v36
  s_nop 1
  v_permlane32_swap_b32 v36, v37
  v_max_f32 v36, v36, v37
  v_mov_b32 v37, v36
  s_nop 1
  v_permlane16_swap_b32 v36, v37
  v_max_f32 v36, v36, v37
  s_nop 1
  v_max_f32_dpp v36, v36, v36 row_ror:8 row_mask:0xf bank_mask:0xf
  s_waitcnt lgkmcnt(3)
  v_smfmac_f32_16x16x64_bf16 v[56:59], v[24:27], v[60:67], v2
  ds_read_b128 v[24:27], v7 offset:7168
  ds_read_b128 v[60:63], v11 offset:51200
  ds_read_b128 v[64:67], v11 offset:52224
  v_mul_f32 v36, s69, v36
  v_fma_f32 v28, v28, s69, -v36
  v_fma_f32 v29, v29, s69, -v36
  v_fma_f32 v30, v30, s69, -v36
  v_fma_f32 v31, v31, s69, -v36
  v_fma_f32 v44, v44, s69, -v36
  v_exp_f32 v28, v28
  v_exp_f32 v29, v29
  v_exp_f32 v30, v30
  v_exp_f32 v31, v31
  v_exp_f32 v44, v44
  s_waitcnt lgkmcnt(3)
  v_smfmac_f32_16x16x64_bf16 v[56:59], v[20:23], v[68:75], v2
  ds_read_b128 v[20:23], v7 offset:8192
  v_add_u32 v11, 0x10000, v11
  ds_read_b128 v[68:71], v11 offset:2048
  ds_read_b128 v[72:75], v11 offset:3072
  v_add_f32 v36, v28, v29
  v_add_f32 v37, v30, v31
  v_add_f32 v36, v36, v44
  v_add_f32 v36, v36, v37
  v_mov_b32 v37, v36
  s_nop 1
  v_permlane32_swap_b32 v36, v37
  v_add_f32 v36, v36, v37
  v_mov_b32 v37, v36
  s_nop 1
  v_permlane16_swap_b32 v36, v37
  v_add_f32 v36, v36, v37
  s_nop 1
  v_add_f32_dpp v36, v36, v36 row_ror:8 row_mask:0xf bank_mask:0xf
  s_waitcnt lgkmcnt(3)
  v_smfmac_f32_16x16x64_bf16 v[56:59], v[24:27], v[60:67], v2
  v_rcp_f32 v36, v36
  s_nop 0
  v_mul_f32 v28, v28, v36
  v_mul_f32 v29, v29, v36
  v_mul_f32 v30, v30, v36
  v_mul_f32 v31, v31, v36
  v_mul_f32 v44, v44, v36
  v_cvt_pk_bf16_f32 v40, v28, v29
  v_cvt_pk_bf16_f32 v41, v30, v31
  v_mov_b32_dpp v45, v44 row_ror:8 row_mask:0xf bank_mask:0xf
  v_mov_b32_dpp v42, v40 row_ror:8 row_mask:0xf bank_mask:0xf
  v_mov_b32_dpp v43, v41 row_ror:8 row_mask:0xf bank_mask:0xf
  v_cvt_pk_bf16_f32 v44, v44, v45
  v_mov_b32 v45, 0
  s_waitcnt lgkmcnt(0)
  v_smfmac_f32_16x16x64_bf16 v[56:59], v[20:23], v[68:75], v2
  s_waitcnt vmcnt(2)
  v_mfma_f32_16x16x32_bf16 v[28:31], v[76:79], v[40:43], 0
  s_waitcnt vmcnt(1)
  v_mfma_f32_16x16x32_bf16 v[48:51], v[32:35], v[40:43], 0
  s_nop 3
  v_permlane32_swap_b32 v56, v58
  v_permlane32_swap_b32 v57, v59
  v_add_f32 v56, v56, v58
  v_add_f32 v57, v57, v59
  v_cvt_pk_bf16_f32 v56, v56, v57
  v_mov_b32 v57, 0
  v_subrev_u32 v11, 0x20000, v11
  v_mfma_f32_16x16x16_bf16 v[28:31], v[52:53], v[44:45], v[28:31]
  v_mfma_f32_16x16x16_bf16 v[48:51], v[56:57], v[44:45], v[48:51]
  v_mov_b32 v0, v56
  s_cmp_eq_u32 s21, 63
  s_nop 5
  s_cbranch_scc1 C_END_s
  v_mov_b64 v[60:61], 0
  v_mov_b64 v[62:63], 0
  v_mov_b64 v[64:65], 0
  v_mov_b64 v[66:67], 0
  v_mov_b64 v[68:69], 0
  v_mov_b64 v[70:71], 0
  v_mov_b64 v[72:73], 0
  v_mov_b64 v[74:75], 0
  v_mov_b64 v[40:41], 0
  v_mov_b64 v[42:43], 0
  v_cvt_pk_bf16_f32 v36, v28, v29
  v_cvt_pk_bf16_f32 v37, v30, v31
  v_cvt_pk_bf16_f32 v38, v48, v49
  v_cvt_pk_bf16_f32 v39, v50, v51
  s_mov_b64 exec, s[76:77]
  ds_write_b128 v8, v[36:39]
  s_mov_b64 exec, -1
  s_add_u32 s74, s21, 3
  s_lshr_b32 s74, s74, 2
  s_min_u32 s74, s74, 15
  s_cmp_lt_u32 s74, s33
  s_cbranch_scc1 pw_16
  v_lshrrev_b32 v28, 2, v1
  v_add_u32 v28, 128, v28
  s_mov_b32 s75, 0
pl_17:
  s_mov_b64 exec, 0xffff
  buffer_load_dword v29, v28, s[16:19], 0 offen sc1
  s_waitcnt vmcnt(0)
  v_cmp_eq_u32 vcc, 0xc0, v29
  s_mov_b64 exec, -1
  s_nop 4
  s_not_b32 s33, vcc_lo
  s_ff1_i32_b32 s33, s33
  s_add_u32 s75, s75, 1
  s_cmp_lt_u32 s74, s33
  s_cbranch_scc1 pw_16
  s_cmp_lt_u32 s75, 100000
  s_cbranch_scc1 pl_17
pw_16:
  s_add_u32 s74, s28, 262144
  buffer_load_dwordx4 v[32:35], v1, s[12:15], s74 offen
  buffer_load_dwordx4 v[76:79], v1, s[12:15], s74 offen offset:1024
  v_mov_b64 v[44:45], 0
  v_mov_b64 v[46:47], 0
  v_mov_b64 v[48:49], 0
  v_mov_b64 v[50:51], 0
  v_mov_b64 v[52:53], 0
  v_mov_b64 v[54:55], 0
  v_mov_b64 v[56:57], 0
  v_mov_b64 v[58:59], 0
  s_waitcnt lgkmcnt(0)
  s_barrier
  ds_read_b128 v[20:23], v7 offset:14336
  ds_read_b128 v[24:27], v7 offset:15360
  s_waitcnt lgkmcnt(1)
  v_smfmac_f32_16x16x64_bf16 v[40:43], v[20:23], v[112:119], v2
  v_smfmac_f32_16x16x64_bf16 v[44:47], v[20:23], v[128:135], v2
  v_smfmac_f32_16x16x64_bf16 v[48:51], v[20:23], v[144:151], v2
  v_smfmac_f32_16x16x64_bf16 v[52:55], v[20:23], v[160:167], v2
  v_smfmac_f32_16x16x64_bf16 v[56:59], v[20:23], v[176:183], v2
  v_smfmac_f32_16x16x64_bf16 v[60:63], v[20:23], v[192:199], v2
  v_smfmac_f32_16x16x64_bf16 v[64:67], v[20:23], v[208:215], v2
  v_smfmac_f32_16x16x64_bf16 v[68:71], v[20:23], v[224:231], v2
  v_smfmac_f32_16x16x64_bf16 v[72:75], v[20:23], v[240:247], v2
  s_waitcnt lgkmcnt(0)
  v_smfmac_f32_16x16x64_bf16 v[40:43], v[24:27], v[120:127], v2
  v_smfmac_f32_16x16x64_bf16 v[44:47], v[24:27], v[136:143], v2
  v_smfmac_f32_16x16x64_bf16 v[48:51], v[24:27], v[152:159], v2
  s_nop 5
  v_permlane32_swap_b32 v40, v42
  v_permlane32_swap_b32 v41, v43
  v_pk_add_f32 v[40:41], v[40:41], v[42:43]
  v_cvt_pk_bf16_f32 v40, v40, v41
  v_and_or_b32 v40, v40, -2, s27
  buffer_store_dword v40, v12, s[12:15], s25 offen offset:0 sc1
  v_smfmac_f32_16x16x64_bf16 v[52:55], v[24:27], v[168:175], v2
  v_permlane32_swap_b32 v44, v46
  v_permlane32_swap_b32 v45, v47
  v_pk_add_f32 v[44:45], v[44:45], v[46:47]
  v_cvt_pk_bf16_f32 v44, v44, v45
  v_and_or_b32 v44, v44, -2, s27
  buffer_store_dword v44, v12, s[12:15], s25 offen offset:64 sc1
  v_smfmac_f32_16x16x64_bf16 v[56:59], v[24:27], v[184:191], v2
  v_permlane32_swap_b32 v48, v50
  v_permlane32_swap_b32 v49, v51
  v_pk_add_f32 v[48:49], v[48:49], v[50:51]
  v_cvt_pk_bf16_f32 v48, v48, v49
  v_and_or_b32 v48, v48, -2, s27
  buffer_store_dword v48, v12, s[12:15], s25 offen offset:128 sc1
  v_smfmac_f32_16x16x64_bf16 v[60:63], v[24:27], v[200:207], v2
  v_permlane32_swap_b32 v52, v54
  v_permlane32_swap_b32 v53, v55
  v_pk_add_f32 v[52:53], v[52:53], v[54:55]
  v_cvt_pk_bf16_f32 v52, v52, v53
  v_and_or_b32 v52, v52, -2, s27
  buffer_store_dword v52, v12, s[12:15], s25 offen offset:192 sc1
  v_smfmac_f32_16x16x64_bf16 v[64:67], v[24:27], v[216:223], v2
  v_permlane32_swap_b32 v56, v58
  v_permlane32_swap_b32 v57, v59
  v_pk_add_f32 v[56:57], v[56:57], v[58:59]
  v_cvt_pk_bf16_f32 v56, v56, v57
  v_and_or_b32 v56, v56, -2, s27
  buffer_store_dword v56, v12, s[12:15], s25 offen offset:256 sc1
  v_smfmac_f32_16x16x64_bf16 v[68:71], v[24:27], v[232:239], v2
  v_permlane32_swap_b32 v60, v62
  v_permlane32_swap_b32 v61, v63
  v_pk_add_f32 v[60:61], v[60:61], v[62:63]
  v_cvt_pk_bf16_f32 v60, v60, v61
  v_and_or_b32 v60, v60, -2, s27
  buffer_store_dword v60, v12, s[12:15], s25 offen offset:320 sc1
  v_smfmac_f32_16x16x64_bf16 v[72:75], v[24:27], v[248:255], v2
  v_permlane32_swap_b32 v64, v66
  v_permlane32_swap_b32 v65, v67
  v_pk_add_f32 v[64:65], v[64:65], v[66:67]
  v_cvt_pk_bf16_f32 v64, v64, v65
  v_and_or_b32 v64, v64, -2, s27
  buffer_store_dword v64, v12, s[12:15], s25 offen offset:384 sc1
  v_permlane32_swap_b32 v68, v70
  v_permlane32_swap_b32 v69, v71
  v_pk_add_f32 v[68:69], v[68:69], v[70:71]
  v_cvt_pk_bf16_f32 v68, v68, v69
  v_and_or_b32 v68, v68, -2, s27
  buffer_store_dword v68, v12, s[12:15], s25 offen offset:448 sc1
  v_permlane32_swap_b32 v72, v74
  v_permlane32_swap_b32 v73, v75
  v_pk_add_f32 v[72:73], v[72:73], v[74:75]
  v_cvt_pk_bf16_f32 v72, v72, v73
  v_and_or_b32 v72, v72, -2, s27
  buffer_store_dword v72, v12, s[12:15], s25 offen offset:512 sc1
  v_and_b32 v13, 0x1ff, v1
  v_lshrrev_b32 v15, 9, v1
  v_mul_u32_u24 v20, 9216, v15
  v_add_u32 v20, v20, v13
  v_lshlrev_b32 v13, 1, v13
  v_lshlrev_b32 v15, 4, v15
  v_add_u32 v13, v13, v15
  v_add_u32 v13, s65, v13
  v_cmp_eq_u32 vcc, 0, v17
  s_nop 1
  v_cndmask_b32 v40, 0, v14, vcc
  v_cmp_eq_u32 vcc, 1, v17
  s_nop 1
  v_cndmask_b32 v41, 0, v14, vcc
  v_cmp_eq_u32 vcc, 2, v17
  s_nop 1
  v_cndmask_b32 v42, 0, v14, vcc
  v_cmp_eq_u32 vcc, 3, v17
  s_nop 1
  v_cndmask_b32 v43, 0, v14, vcc
  s_mov_b64 exec, s[78:79]
  s_add_u32 s74, s26, 0
  buffer_load_dwordx4 v[60:63], v20, s[12:15], s74 offen sc1
  s_add_u32 s74, s26, 18432
  buffer_load_dwordx4 v[64:67], v20, s[12:15], s74 offen sc1
  s_add_u32 s74, s26, 36864
  buffer_load_dwordx4 v[68:71], v20, s[12:15], s74 offen sc1
  s_add_u32 s74, s26, 55296
  buffer_load_dwordx4 v[72:75], v20, s[12:15], s74 offen sc1
  s_mov_b64 exec, -1
  s_waitcnt vmcnt(3)
  v_alignbit_b32 v21, v60, v60, 1
  v_alignbit_b32 v22, v61, v61, 1
  v_alignbit_b32 v21, v62, v21, 1
  v_alignbit_b32 v22, v63, v22, 1
  s_waitcnt vmcnt(2)
  v_alignbit_b32 v21, v64, v21, 1
  v_alignbit_b32 v22, v65, v22, 1
  v_alignbit_b32 v21, v66, v21, 1
  v_alignbit_b32 v22, v67, v22, 1
  s_waitcnt vmcnt(1)
  v_alignbit_b32 v21, v68, v21, 1
  v_alignbit_b32 v22, v69, v22, 1
  v_alignbit_b32 v21, v70, v21, 1
  v_alignbit_b32 v22, v71, v22, 1
  s_waitcnt vmcnt(0)
  v_alignbit_b32 v21, v72, v21, 1
  v_alignbit_b32 v22, v73, v22, 1
  v_alignbit_b32 v21, v74, v21, 1
  v_alignbit_b32 v22, v75, v22, 1
  v_perm_b32 v21, v21, v22, s71
  v_cmp_ne_u32 vcc, s70, v21
  s_and_b64 vcc, vcc, s[78:79]
  s_nop 3
  s_cbranch_vccz ro_19
rr_18:
  s_sub_u32 s31, s31, 1
  s_cbranch_scc1 ro_19_x
  s_mov_b64 exec, s[78:79]
  s_add_u32 s74, s26, 0
  buffer_load_dwordx4 v[60:63], v20, s[12:15], s74 offen sc1
  s_add_u32 s74, s26, 18432
  buffer_load_dwordx4 v[64:67], v20, s[12:15], s74 offen sc1
  s_add_u32 s74, s26, 36864
  buffer_load_dwordx4 v[68:71], v20, s[12:15], s74 offen sc1
  s_add_u32 s74, s26, 55296
  buffer_load_dwordx4 v[72:75], v20, s[12:15], s74 offen sc1
  s_mov_b64 exec, -1
  s_waitcnt vmcnt(0)
  v_alignbit_b32 v21, v60, v60, 1
  v_alignbit_b32 v22, v61, v61, 1
  v_alignbit_b32 v21, v62, v21, 1
  v_alignbit_b32 v22, v63, v22, 1
  v_alignbit_b32 v21, v64, v21, 1
  v_alignbit_b32 v22, v65, v22, 1
  v_alignbit_b32 v21, v66, v21, 1
  v_alignbit_b32 v22, v67, v22, 1
  v_alignbit_b32 v21, v68, v21, 1
  v_alignbit_b32 v22, v69, v22, 1
  v_alignbit_b32 v21, v70, v21, 1
  v_alignbit_b32 v22, v71, v22, 1
  v_alignbit_b32 v21, v72, v21, 1
  v_alignbit_b32 v22, v73, v22, 1
  v_alignbit_b32 v21, v74, v21, 1
  v_alignbit_b32 v22, v75, v22, 1
  v_perm_b32 v21, v21, v22, s71
  v_cmp_ne_u32 vcc, s70, v21
  s_and_b64 vcc, vcc, s[78:79]
  s_nop 3
  s_cbranch_vccnz rr_18
  s_branch ro_19
ro_19_x:
  s_mov_b32 s31, 0
ro_19:
  v_mfma_f32_32x32x16_bf16 v[44:59], v[40:43], v[60:63], 0
  v_mfma_f32_32x32x16_bf16 v[44:59], v[40:43], v[64:67], v[44:59]
  v_mfma_f32_32x32x16_bf16 v[44:59], v[40:43], v[68:71], v[44:59]
  v_mfma_f32_32x32x16_bf16 v[44:59], v[40:43], v[72:75], v[44:59]
  s_mov_b64 exec, s[78:79]
  s_nop 10
  ds_write_b128 v13, v[44:47]
  s_mov_b64 exec, -1
  s_waitcnt lgkmcnt(0)
  s_barrier
  s_cmp_ge_u32 s3, 2
  s_cbranch_scc1 nf_20
  v_add_u32 v13, s63, v7
  ds_read_b64 v[20:21], v13 offset:9856
  ds_read_b64 v[22:23], v13 offset:11136
  ds_read_b64 v[24:25], v13 offset:12416
  ds_read_b64 v[26:27], v13 offset:13696
  s_waitcnt lgkmcnt(2)
  v_add_f32 v20, v20, v22
  v_add_f32 v21, v21, v23
  s_waitcnt lgkmcnt(0)
  v_add_f32 v24, v24, v26
  v_add_f32 v25, v25, v27
  v_add_f32 v20, v20, v24
  v_add_f32 v21, v21, v25
  v_cvt_pk_bf16_f32 v20, v20, v21
  v_mov_b32 v21, -1
  s_mov_b64 exec, s[44:45]
  buffer_store_dword v20, v16, s[12:15], s23 offen sc1
  buffer_store_dword v21, v16, s[12:15], s24 offen sc1
  s_mov_b64 exec, -1
nf_20:
  s_barrier
  s_mov_b32 s74, s22
  s_mov_b32 s22, s23
  s_mov_b32 s23, s24
  s_mov_b32 s24, s74
  s_xor_b32 s27, s27, 1
  s_xor_b32 s70, s70, 0xffff
  s_add_u32 s28, s28, 262144
  s_add_u32 s29, s29, 131072
  s_add_u32 s30, s30, 65536
  s_add_u32 s21, s21, 1
  s_branch C_STEP_s
C_END_s:
  v_lshrrev_b32 v15, 2, v1
  s_sub_u32 s74, s30, 0
  buffer_store_dword v9, v15, s[12:15], s74 offen sc1
  buffer_store_dword v0, v15, s[12:15], s74 offen offset:256 sc1
  s_waitcnt vmcnt(0)
  v_mov_b32 v15, 64
  s_mov_b64 exec, 1
  s_nop 0
  buffer_store_dword v15, off, s[12:15], s34 sc1
  s_mov_b64 exec, -1
  s_waitcnt vmcnt(0)
  s_branch C_FIN
C_WORK:
  s_load_dwordx2 s[4:5], s[0:1], 136
  s_waitcnt lgkmcnt(0)
  s_mov_b32 s16, s4
  s_mov_b32 s17, s5
  s_mov_b32 s18, 256
  s_mov_b32 s19, 0x00020000
  s_cmp_lg_u32 s3, 0
  s_cbranch_scc1 WK_W0
  s_mov_b64 exec, 1
  v_mov_b32 v4, 1
  v_mov_b32 v3, 76
  buffer_atomic_add v4, v3, s[16:19], 0 offen sc0 sc1
  v_mov_b32 v3, 0
  s_waitcnt vmcnt(0)
  ds_write_b32 v3, v4
  s_waitcnt lgkmcnt(0)
  s_mov_b64 exec, -1
WK_W0:
  s_barrier
  v_mov_b32 v3, 0
  ds_read_b32 v4, v3
  s_waitcnt lgkmcnt(0)
  v_readfirstlane_b32 s40, v4
  s_waitcnt lgkmcnt(0)
  s_barrier
  s_cmp_ge_u32 s40, 192
  s_nop 1
  s_cbranch_scc1 WK_T
  s_lshr_b32 s41, s40, 2
  s_and_b32 s42, s40, 3
  s_lshr_b32 s43, s41, 4
  s_lshl_b32 s44, s43, 3
  s_add_u32 s44, s44, 16
  s_load_dwordx2 s[4:5], s[0:1], 0
  s_load_dwordx2 s[8:9], s[0:1], 144
  s_add_u32 s46, s0, s44
  s_addc_u32 s47, s1, 0
  s_load_dwordx2 s[6:7], s[46:47], 0
  s_waitcnt lgkmcnt(0)
  s_and_b32 s45, s41, 15
  s_lshl_b32 s46, s45, 9
  s_mov_b32 s12, s4
  s_mov_b32 s13, s5
  s_mov_b32 s14, 2359296
  s_mov_b32 s15, 0x00020000
  s_mov_b32 s16, s6
  s_mov_b32 s17, s7
  s_mov_b32 s18, 4718592
  s_mov_b32 s19, 0x00020000
  s_mov_b32 s47, 0x2000000
  s_cmp_eq_u32 s43, 1
  s_cselect_b32 s47, 0, s47
  s_cmp_eq_u32 s43, 2
  s_cselect_b32 s47, 0x1000000, s47
  s_add_u32 s20, s8, s47
  s_addc_u32 s21, s9, 0
  s_mov_b32 s22, 16777216
  s_mov_b32 s23, 0x00020000
  s_add_u32 s24, s8, 0x4f00000
  s_addc_u32 s25, s9, 0
  s_mov_b32 s26, 65536
  s_mov_b32 s27, 0x00020000
  v_and_b32 v1, 63, v0
  v_lshrrev_b32 v4, 5, v1
  v_and_b32 v5, 31, v1
  v_add_u32 v6, 0, v4
  v_lshlrev_b32 v7, 2, v6
  v_xor_b32 v7, v7, v5
  v_lshlrev_b32 v7, 4, v7
  v_lshlrev_b32 v6, 13, v6
  v_add_u32 v2, v6, v7
  v_add_u32 v6, 2, v4
  v_lshlrev_b32 v7, 2, v6
  v_xor_b32 v7, v7, v5
  v_lshlrev_b32 v7, 4, v7
  v_lshlrev_b32 v6, 13, v6
  v_add_u32 v3, v6, v7
  s_mul_i32 s48, s3, 294912
  s_add_u32 s48, s48, s46
  s_mul_i32 s49, s3, 18432
  s_add_u32 s50, s48, 0
  s_add_u32 m0, s49, 0
  s_nop 0
  buffer_load_dwordx4 v2, s[16:19], s50 offen lds
  s_add_u32 s50, s48, 0
  s_add_u32 m0, s49, 1024
  s_nop 0
  buffer_load_dwordx4 v3, s[16:19], s50 offen lds
  s_add_u32 s50, s48, 32768
  s_add_u32 m0, s49, 2048
  s_nop 0
  buffer_load_dwordx4 v2, s[16:19], s50 offen lds
  s_add_u32 s50, s48, 32768
  s_add_u32 m0, s49, 3072
  s_nop 0
  buffer_load_dwordx4 v3, s[16:19], s50 offen lds
  s_add_u32 s50, s48, 65536
  s_add_u32 m0, s49, 4096
  s_nop 0
  buffer_load_dwordx4 v2, s[16:19], s50 offen lds
  s_add_u32 s50, s48, 65536
  s_add_u32 m0, s49, 5120
  s_nop 0
  buffer_load_dwordx4 v3, s[16:19], s50 offen lds
  s_add_u32 s50, s48, 98304
  s_add_u32 m0, s49, 6144
  s_nop 0
  buffer_load_dwordx4 v2, s[16:19], s50 offen lds
  s_add_u32 s50, s48, 98304
  s_add_u32 m0, s49, 7168
  s_nop 0
  buffer_load_dwordx4 v3, s[16:19], s50 offen lds
  s_add_u32 s50, s48, 131072
  s_add_u32 m0, s49, 8192
  s_nop 0
  buffer_load_dwordx4 v2, s[16:19], s50 offen lds
  s_add_u32 s50, s48, 131072
  s_add_u32 m0, s49, 9216
  s_nop 0
  buffer_load_dwordx4 v3, s[16:19], s50 offen lds
  s_add_u32 s50, s48, 163840
  s_add_u32 m0, s49, 10240
  s_nop 0
  buffer_load_dwordx4 v2, s[16:19], s50 offen lds
  s_add_u32 s50, s48, 163840
  s_add_u32 m0, s49, 11264
  s_nop 0
  buffer_load_dwordx4 v3, s[16:19], s50 offen lds
  s_add_u32 s50, s48, 196608
  s_add_u32 m0, s49, 12288
  s_nop 0
  buffer_load_dwordx4 v2, s[16:19], s50 offen lds
  s_add_u32 s50, s48, 196608
  s_add_u32 m0, s49, 13312
  s_nop 0
  buffer_load_dwordx4 v3, s[16:19], s50 offen lds
  s_add_u32 s50, s48, 229376
  s_add_u32 m0, s49, 14336
  s_nop 0
  buffer_load_dwordx4 v2, s[16:19], s50 offen lds
  s_add_u32 s50, s48, 229376
  s_add_u32 m0, s49, 15360
  s_nop 0
  buffer_load_dwordx4 v3, s[16:19], s50 offen lds
  s_add_u32 s50, s48, 262144
  s_add_u32 m0, s49, 16384
  s_nop 0
  buffer_load_dwordx4 v2, s[16:19], s50 offen lds
  s_add_u32 s50, s48, 262144
  s_add_u32 m0, s49, 17408
  s_nop 0
  buffer_load_dwordx4 v3, s[16:19], s50 offen lds
  s_add_u32 s50, s48, 1179648
  s_add_u32 m0, s49, 73728
  s_nop 0
  buffer_load_dwordx4 v2, s[16:19], s50 offen lds
  s_add_u32 s50, s48, 1179648
  s_add_u32 m0, s49, 74752
  s_nop 0
  buffer_load_dwordx4 v3, s[16:19], s50 offen lds
  s_add_u32 s50, s48, 1212416
  s_add_u32 m0, s49, 75776
  s_nop 0
  buffer_load_dwordx4 v2, s[16:19], s50 offen lds
  s_add_u32 s50, s48, 1212416
  s_add_u32 m0, s49, 76800
  s_nop 0
  buffer_load_dwordx4 v3, s[16:19], s50 offen lds
  s_add_u32 s50, s48, 1245184
  s_add_u32 m0, s49, 77824
  s_nop 0
  buffer_load_dwordx4 v2, s[16:19], s50 offen lds
  s_add_u32 s50, s48, 1245184
  s_add_u32 m0, s49, 78848
  s_nop 0
  buffer_load_dwordx4 v3, s[16:19], s50 offen lds
  s_add_u32 s50, s48, 1277952
  s_add_u32 m0, s49, 79872
  s_nop 0
  buffer_load_dwordx4 v2, s[16:19], s50 offen lds
  s_add_u32 s50, s48, 1277952
  s_add_u32 m0, s49, 80896
  s_nop 0
  buffer_load_dwordx4 v3, s[16:19], s50 offen lds
  s_add_u32 s50, s48, 1310720
  s_add_u32 m0, s49, 81920
  s_nop 0
  buffer_load_dwordx4 v2, s[16:19], s50 offen lds
  s_add_u32 s50, s48, 1310720
  s_add_u32 m0, s49, 82944
  s_nop 0
  buffer_load_dwordx4 v3, s[16:19], s50 offen lds
  s_add_u32 s50, s48, 1343488
  s_add_u32 m0, s49, 83968
  s_nop 0
  buffer_load_dwordx4 v2, s[16:19], s50 offen lds
  s_add_u32 s50, s48, 1343488
  s_add_u32 m0, s49, 84992
  s_nop 0
  buffer_load_dwordx4 v3, s[16:19], s50 offen lds
  s_add_u32 s50, s48, 1376256
  s_add_u32 m0, s49, 86016
  s_nop 0
  buffer_load_dwordx4 v2, s[16:19], s50 offen lds
  s_add_u32 s50, s48, 1376256
  s_add_u32 m0, s49, 87040
  s_nop 0
  buffer_load_dwordx4 v3, s[16:19], s50 offen lds
  s_add_u32 s50, s48, 1409024
  s_add_u32 m0, s49, 88064
  s_nop 0
  buffer_load_dwordx4 v2, s[16:19], s50 offen lds
  s_add_u32 s50, s48, 1409024
  s_add_u32 m0, s49, 89088
  s_nop 0
  buffer_load_dwordx4 v3, s[16:19], s50 offen lds
  s_add_u32 s50, s48, 1441792
  s_add_u32 m0, s49, 90112
  s_nop 0
  buffer_load_dwordx4 v2, s[16:19], s50 offen lds
  s_add_u32 s50, s48, 1441792
  s_add_u32 m0, s49, 91136
  s_nop 0
  buffer_load_dwordx4 v3, s[16:19], s50 offen lds
  v_and_b32 v6, 15, v1
  v_lshrrev_b32 v6, 2, v6
  v_lshrrev_b32 v7, 5, v1
  v_lshlrev_b32 v7, 3, v7
  v_add_u32 v7, v7, v6
  v_lshlrev_b32 v7, 9, v7
  v_lshrrev_b32 v8, 4, v1
  v_and_b32 v8, 1, v8
  v_lshlrev_b32 v8, 1, v8
  v_and_b32 v9, 3, v1
  v_lshrrev_b32 v10, 1, v9
  v_add_u32 v8, v8, v10
  s_lshl_b32 s50, s3, 3
  v_add_u32 v8, s50, v8
  v_lshlrev_b32 v6, 2, v6
  v_and_b32 v9, 1, v9
  v_lshlrev_b32 v9, 3, v9
  v_add_u32 v7, v7, v9
  v_xor_b32 v10, v8, v6
  v_lshlrev_b32 v10, 4, v10
  v_add_u32 v4, v7, v10
  v_add_u32 v8, 4, v8
  v_xor_b32 v10, v8, v6
  v_lshlrev_b32 v10, 4, v10
  v_add_u32 v5, v7, v10
  s_mul_i32 s50, s3, 576
  s_mov_b32 s51, 58255
  v_add_u32 v6, s50, v1
  v_add_u32 v6, 0, v6
  v_mul_lo_u32 v7, v6, s51
  v_lshrrev_b32 v7, 22, v7
  v_mul_u32_u24 v8, 72, v7
  v_sub_u32 v8, v6, v8
  v_lshrrev_b32 v9, 1, v7
  v_and_b32 v9, 7, v9
  v_xor_b32 v8, v8, v9
  v_mul_u32_u24 v7, 1152, v7
  v_lshlrev_b32 v8, 4, v8
  v_add_u32 v16, v7, v8
  v_add_u32 v6, s50, v1
  v_add_u32 v6, 64, v6
  v_mul_lo_u32 v7, v6, s51
  v_lshrrev_b32 v7, 22, v7
  v_mul_u32_u24 v8, 72, v7
  v_sub_u32 v8, v6, v8
  v_lshrrev_b32 v9, 1, v7
  v_and_b32 v9, 7, v9
  v_xor_b32 v8, v8, v9
  v_mul_u32_u24 v7, 1152, v7
  v_lshlrev_b32 v8, 4, v8
  v_add_u32 v17, v7, v8
  v_add_u32 v6, s50, v1
  v_add_u32 v6, 128, v6
  v_mul_lo_u32 v7, v6, s51
  v_lshrrev_b32 v7, 22, v7
  v_mul_u32_u24 v8, 72, v7
  v_sub_u32 v8, v6, v8
  v_lshrrev_b32 v9, 1, v7
  v_and_b32 v9, 7, v9
  v_xor_b32 v8, v8, v9
  v_mul_u32_u24 v7, 1152, v7
  v_lshlrev_b32 v8, 4, v8
  v_add_u32 v18, v7, v8
  v_add_u32 v6, s50, v1
  v_add_u32 v6, 192, v6
  v_mul_lo_u32 v7, v6, s51
  v_lshrrev_b32 v7, 22, v7
  v_mul_u32_u24 v8, 72, v7
  v_sub_u32 v8, v6, v8
  v_lshrrev_b32 v9, 1, v7
  v_and_b32 v9, 7, v9
  v_xor_b32 v8, v8, v9
  v_mul_u32_u24 v7, 1152, v7
  v_lshlrev_b32 v8, 4, v8
  v_add_u32 v19, v7, v8
  v_add_u32 v6, s50, v1
  v_add_u32 v6, 256, v6
  v_mul_lo_u32 v7, v6, s51
  v_lshrrev_b32 v7, 22, v7
  v_mul_u32_u24 v8, 72, v7
  v_sub_u32 v8, v6, v8
  v_lshrrev_b32 v9, 1, v7
  v_and_b32 v9, 7, v9
  v_xor_b32 v8, v8, v9
  v_mul_u32_u24 v7, 1152, v7
  v_lshlrev_b32 v8, 4, v8
  v_add_u32 v20, v7, v8
  v_add_u32 v6, s50, v1
  v_add_u32 v6, 320, v6
  v_mul_lo_u32 v7, v6, s51
  v_lshrrev_b32 v7, 22, v7
  v_mul_u32_u24 v8, 72, v7
  v_sub_u32 v8, v6, v8
  v_lshrrev_b32 v9, 1, v7
  v_and_b32 v9, 7, v9
  v_xor_b32 v8, v8, v9
  v_mul_u32_u24 v7, 1152, v7
  v_lshlrev_b32 v8, 4, v8
  v_add_u32 v21, v7, v8
  v_add_u32 v6, s50, v1
  v_add_u32 v6, 384, v6
  v_mul_lo_u32 v7, v6, s51
  v_lshrrev_b32 v7, 22, v7
  v_mul_u32_u24 v8, 72, v7
  v_sub_u32 v8, v6, v8
  v_lshrrev_b32 v9, 1, v7
  v_and_b32 v9, 7, v9
  v_xor_b32 v8, v8, v9
  v_mul_u32_u24 v7, 1152, v7
  v_lshlrev_b32 v8, 4, v8
  v_add_u32 v22, v7, v8
  v_add_u32 v6, s50, v1
  v_add_u32 v6, 448, v6
  v_mul_lo_u32 v7, v6, s51
  v_lshrrev_b32 v7, 22, v7
  v_mul_u32_u24 v8, 72, v7
  v_sub_u32 v8, v6, v8
  v_lshrrev_b32 v9, 1, v7
  v_and_b32 v9, 7, v9
  v_xor_b32 v8, v8, v9
  v_mul_u32_u24 v7, 1152, v7
  v_lshlrev_b32 v8, 4, v8
  v_add_u32 v23, v7, v8
  v_add_u32 v6, s50, v1
  v_add_u32 v6, 512, v6
  v_mul_lo_u32 v7, v6, s51
  v_lshrrev_b32 v7, 22, v7
  v_mul_u32_u24 v8, 72, v7
  v_sub_u32 v8, v6, v8
  v_lshrrev_b32 v9, 1, v7
  v_and_b32 v9, 7, v9
  v_xor_b32 v8, v8, v9
  v_mul_u32_u24 v7, 1152, v7
  v_lshlrev_b32 v8, 4, v8
  v_add_u32 v24, v7, v8
  v_and_b32 v6, 31, v1
  v_lshrrev_b32 v7, 5, v1
  v_lshrrev_b32 v25, 1, v6
  v_and_b32 v25, 7, v25
  v_mul_u32_u24 v6, 1152, v6
  v_add_u32 v26, 0, v7
  v_xor_b32 v26, v26, v25
  v_lshlrev_b32 v26, 4, v26
  v_add_u32 v8, v6, v26
  v_add_u32 v12, 73728, v8
  v_add_u32 v26, 2, v7
  v_xor_b32 v26, v26, v25
  v_lshlrev_b32 v26, 4, v26
  v_add_u32 v9, v6, v26
  v_add_u32 v13, 73728, v9
  v_add_u32 v26, 4, v7
  v_xor_b32 v26, v26, v25
  v_lshlrev_b32 v26, 4, v26
  v_add_u32 v10, v6, v26
  v_add_u32 v14, 73728, v10
  v_add_u32 v26, 6, v7
  v_xor_b32 v26, v26, v25
  v_lshlrev_b32 v26, 4, v26
  v_add_u32 v11, v6, v26
  v_add_u32 v15, 73728, v11
  v_and_b32 v6, 31, v1
  v_lshrrev_b32 v7, 4, v6
  v_lshlrev_b32 v7, 10, v7
  v_and_b32 v6, 15, v6
  v_lshlrev_b32 v6, 4, v6
  v_add_u32 v6, v6, v7
  v_lshrrev_b32 v7, 5, v1
  v_lshlrev_b32 v7, 8, v7
  v_add_u32 v25, v6, v7
  s_lshl_b32 s52, s45, 14
  s_lshl_b32 s53, s3, 12
  s_add_u32 s52, s52, s53
  s_waitcnt vmcnt(18)
  s_barrier
  ds_read_b64_tr_b16 a[0:1], v4 offset:0
  ds_read_b64_tr_b16 a[2:3], v4 offset:2048
  ds_read_b64_tr_b16 a[4:5], v5 offset:0
  ds_read_b64_tr_b16 a[6:7], v5 offset:2048
  ds_read_b64_tr_b16 a[8:9], v4 offset:8192
  ds_read_b64_tr_b16 a[10:11], v4 offset:10240
  ds_read_b64_tr_b16 a[12:13], v5 offset:8192
  ds_read_b64_tr_b16 a[14:15], v5 offset:10240
  ds_read_b64_tr_b16 a[16:17], v4 offset:16384
  ds_read_b64_tr_b16 a[18:19], v4 offset:18432
  ds_read_b64_tr_b16 a[20:21], v5 offset:16384
  ds_read_b64_tr_b16 a[22:23], v5 offset:18432
  ds_read_b64_tr_b16 a[24:25], v4 offset:24576
  ds_read_b64_tr_b16 a[26:27], v4 offset:26624
  ds_read_b64_tr_b16 a[28:29], v5 offset:24576
  ds_read_b64_tr_b16 a[30:31], v5 offset:26624
  ds_read_b64_tr_b16 a[32:33], v4 offset:32768
  ds_read_b64_tr_b16 a[34:35], v4 offset:34816
  ds_read_b64_tr_b16 a[36:37], v5 offset:32768
  ds_read_b64_tr_b16 a[38:39], v5 offset:34816
  ds_read_b64_tr_b16 a[40:41], v4 offset:40960
  ds_read_b64_tr_b16 a[42:43], v4 offset:43008
  ds_read_b64_tr_b16 a[44:45], v5 offset:40960
  ds_read_b64_tr_b16 a[46:47], v5 offset:43008
  ds_read_b64_tr_b16 a[48:49], v4 offset:49152
  ds_read_b64_tr_b16 a[50:51], v4 offset:51200
  ds_read_b64_tr_b16 a[52:53], v5 offset:49152
  ds_read_b64_tr_b16 a[54:55], v5 offset:51200
  ds_read_b64_tr_b16 a[56:57], v4 offset:57344
  ds_read_b64_tr_b16 a[58:59], v4 offset:59392
  ds_read_b64_tr_b16 a[60:61], v5 offset:57344
  ds_read_b64_tr_b16 a[62:63], v5 offset:59392
  v_add_u32 v6, 65536, v4
  ds_read_b64_tr_b16 a[64:65], v6 offset:0
  v_add_u32 v6, 65536, v4
  ds_read_b64_tr_b16 a[66:67], v6 offset:2048
  v_add_u32 v6, 65536, v5
  ds_read_b64_tr_b16 a[68:69], v6 offset:0
  v_add_u32 v6, 65536, v5
  ds_read_b64_tr_b16 a[70:71], v6 offset:2048
  s_waitcnt lgkmcnt(0)
  s_barrier
  s_add_u32 s50, s48, 2359296
  s_add_u32 m0, s49, 0
  s_nop 0
  buffer_load_dwordx4 v2, s[16:19], s50 offen lds
  s_add_u32 s50, s48, 2359296
  s_add_u32 m0, s49, 1024
  s_nop 0
  buffer_load_dwordx4 v3, s[16:19], s50 offen lds
  s_add_u32 s50, s48, 2392064
  s_add_u32 m0, s49, 2048
  s_nop 0
  buffer_load_dwordx4 v2, s[16:19], s50 offen lds
  s_add_u32 s50, s48, 2392064
  s_add_u32 m0, s49, 3072
  s_nop 0
  buffer_load_dwordx4 v3, s[16:19], s50 offen lds
  s_add_u32 s50, s48, 2424832
  s_add_u32 m0, s49, 4096
  s_nop 0
  buffer_load_dwordx4 v2, s[16:19], s50 offen lds
  s_add_u32 s50, s48, 2424832
  s_add_u32 m0, s49, 5120
  s_nop 0
  buffer_load_dwordx4 v3, s[16:19], s50 offen lds
  s_add_u32 s50, s48, 2457600
  s_add_u32 m0, s49, 6144
  s_nop 0
  buffer_load_dwordx4 v2, s[16:19], s50 offen lds
  s_add_u32 s50, s48, 2457600
  s_add_u32 m0, s49, 7168
  s_nop 0
  buffer_load_dwordx4 v3, s[16:19], s50 offen lds
  s_add_u32 s50, s48, 2490368
  s_add_u32 m0, s49, 8192
  s_nop 0
  buffer_load_dwordx4 v2, s[16:19], s50 offen lds
  s_add_u32 s50, s48, 2490368
  s_add_u32 m0, s49, 9216
  s_nop 0
  buffer_load_dwordx4 v3, s[16:19], s50 offen lds
  s_add_u32 s50, s48, 2523136
  s_add_u32 m0, s49, 10240
  s_nop 0
  buffer_load_dwordx4 v2, s[16:19], s50 offen lds
  s_add_u32 s50, s48, 2523136
  s_add_u32 m0, s49, 11264
  s_nop 0
  buffer_load_dwordx4 v3, s[16:19], s50 offen lds
  s_add_u32 s50, s48, 2555904
  s_add_u32 m0, s49, 12288
  s_nop 0
  buffer_load_dwordx4 v2, s[16:19], s50 offen lds
  s_add_u32 s50, s48, 2555904
  s_add_u32 m0, s49, 13312
  s_nop 0
  buffer_load_dwordx4 v3, s[16:19], s50 offen lds
  s_add_u32 s50, s48, 2588672
  s_add_u32 m0, s49, 14336
  s_nop 0
  buffer_load_dwordx4 v2, s[16:19], s50 offen lds
  s_add_u32 s50, s48, 2588672
  s_add_u32 m0, s49, 15360
  s_nop 0
  buffer_load_dwordx4 v3, s[16:19], s50 offen lds
  s_add_u32 s50, s48, 2621440
  s_add_u32 m0, s49, 16384
  s_nop 0
  buffer_load_dwordx4 v2, s[16:19], s50 offen lds
  s_add_u32 s50, s48, 2621440
  s_add_u32 m0, s49, 17408
  s_nop 0
  buffer_load_dwordx4 v3, s[16:19], s50 offen lds
  s_waitcnt vmcnt(18)
  s_barrier
  v_add_u32 v6, 65536, v4
  ds_read_b64_tr_b16 a[72:73], v6 offset:8192
  v_add_u32 v6, 65536, v4
  ds_read_b64_tr_b16 a[74:75], v6 offset:10240
  v_add_u32 v6, 65536, v5
  ds_read_b64_tr_b16 a[76:77], v6 offset:8192
  v_add_u32 v6, 65536, v5
  ds_read_b64_tr_b16 a[78:79], v6 offset:10240
  v_add_u32 v6, 65536, v4
  ds_read_b64_tr_b16 a[80:81], v6 offset:16384
  v_add_u32 v6, 65536, v4
  ds_read_b64_tr_b16 a[82:83], v6 offset:18432
  v_add_u32 v6, 65536, v5
  ds_read_b64_tr_b16 a[84:85], v6 offset:16384
  v_add_u32 v6, 65536, v5
  ds_read_b64_tr_b16 a[86:87], v6 offset:18432
  v_add_u32 v6, 65536, v4
  ds_read_b64_tr_b16 a[88:89], v6 offset:24576
  v_add_u32 v6, 65536, v4
  ds_read_b64_tr_b16 a[90:91], v6 offset:26624
  v_add_u32 v6, 65536, v5
  ds_read_b64_tr_b16 a[92:93], v6 offset:24576
  v_add_u32 v6, 65536, v5
  ds_read_b64_tr_b16 a[94:95], v6 offset:26624
  v_add_u32 v6, 98304, v4
  ds_read_b64_tr_b16 a[96:97], v6 offset:0
  v_add_u32 v6, 98304, v4
  ds_read_b64_tr_b16 a[98:99], v6 offset:2048
  v_add_u32 v6, 98304, v5
  ds_read_b64_tr_b16 a[100:101], v6 offset:0
  v_add_u32 v6, 98304, v5
  ds_read_b64_tr_b16 a[102:103], v6 offset:2048
  v_add_u32 v6, 98304, v4
  ds_read_b64_tr_b16 a[104:105], v6 offset:8192
  v_add_u32 v6, 98304, v4
  ds_read_b64_tr_b16 a[106:107], v6 offset:10240
  v_add_u32 v6, 98304, v5
  ds_read_b64_tr_b16 a[108:109], v6 offset:8192
  v_add_u32 v6, 98304, v5
  ds_read_b64_tr_b16 a[110:111], v6 offset:10240
  v_add_u32 v6, 98304, v4
  ds_read_b64_tr_b16 a[112:113], v6 offset:16384
  v_add_u32 v6, 98304, v4
  ds_read_b64_tr_b16 a[114:115], v6 offset:18432
  v_add_u32 v6, 98304, v5
  ds_read_b64_tr_b16 a[116:117], v6 offset:16384
  v_add_u32 v6, 98304, v5
  ds_read_b64_tr_b16 a[118:119], v6 offset:18432
  v_add_u32 v6, 98304, v4
  ds_read_b64_tr_b16 a[120:121], v6 offset:24576
  v_add_u32 v6, 98304, v4
  ds_read_b64_tr_b16 a[122:123], v6 offset:26624
  v_add_u32 v6, 98304, v5
  ds_read_b64_tr_b16 a[124:125], v6 offset:24576
  v_add_u32 v6, 98304, v5
  ds_read_b64_tr_b16 a[126:127], v6 offset:26624
  v_add_u32 v6, 131072, v4
  ds_read_b64_tr_b16 a[128:129], v6 offset:0
  v_add_u32 v6, 131072, v4
  ds_read_b64_tr_b16 a[130:131], v6 offset:2048
  v_add_u32 v6, 131072, v5
  ds_read_b64_tr_b16 a[132:133], v6 offset:0
  v_add_u32 v6, 131072, v5
  ds_read_b64_tr_b16 a[134:135], v6 offset:2048
  v_add_u32 v6, 131072, v4
  ds_read_b64_tr_b16 a[136:137], v6 offset:8192
  v_add_u32 v6, 131072, v4
  ds_read_b64_tr_b16 a[138:139], v6 offset:10240
  v_add_u32 v6, 131072, v5
  ds_read_b64_tr_b16 a[140:141], v6 offset:8192
  v_add_u32 v6, 131072, v5
  ds_read_b64_tr_b16 a[142:143], v6 offset:10240
  s_waitcnt lgkmcnt(0)
  s_barrier
  s_add_u32 s50, s48, 3538944
  s_add_u32 m0, s49, 73728
  s_nop 0
  buffer_load_dwordx4 v2, s[16:19], s50 offen lds
  s_add_u32 s50, s48, 3538944
  s_add_u32 m0, s49, 74752
  s_nop 0
  buffer_load_dwordx4 v3, s[16:19], s50 offen lds
  s_add_u32 s50, s48, 3571712
  s_add_u32 m0, s49, 75776
  s_nop 0
  buffer_load_dwordx4 v2, s[16:19], s50 offen lds
  s_add_u32 s50, s48, 3571712
  s_add_u32 m0, s49, 76800
  s_nop 0
  buffer_load_dwordx4 v3, s[16:19], s50 offen lds
  s_add_u32 s50, s48, 3604480
  s_add_u32 m0, s49, 77824
  s_nop 0
  buffer_load_dwordx4 v2, s[16:19], s50 offen lds
  s_add_u32 s50, s48, 3604480
  s_add_u32 m0, s49, 78848
  s_nop 0
  buffer_load_dwordx4 v3, s[16:19], s50 offen lds
  s_add_u32 s50, s48, 3637248
  s_add_u32 m0, s49, 79872
  s_nop 0
  buffer_load_dwordx4 v2, s[16:19], s50 offen lds
  s_add_u32 s50, s48, 3637248
  s_add_u32 m0, s49, 80896
  s_nop 0
  buffer_load_dwordx4 v3, s[16:19], s50 offen lds
  s_add_u32 s50, s48, 3670016
  s_add_u32 m0, s49, 81920
  s_nop 0
  buffer_load_dwordx4 v2, s[16:19], s50 offen lds
  s_add_u32 s50, s48, 3670016
  s_add_u32 m0, s49, 82944
  s_nop 0
  buffer_load_dwordx4 v3, s[16:19], s50 offen lds
  s_add_u32 s50, s48, 3702784
  s_add_u32 m0, s49, 83968
  s_nop 0
  buffer_load_dwordx4 v2, s[16:19], s50 offen lds
  s_add_u32 s50, s48, 3702784
  s_add_u32 m0, s49, 84992
  s_nop 0
  buffer_load_dwordx4 v3, s[16:19], s50 offen lds
  s_add_u32 s50, s48, 3735552
  s_add_u32 m0, s49, 86016
  s_nop 0
  buffer_load_dwordx4 v2, s[16:19], s50 offen lds
  s_add_u32 s50, s48, 3735552
  s_add_u32 m0, s49, 87040
  s_nop 0
  buffer_load_dwordx4 v3, s[16:19], s50 offen lds
  s_add_u32 s50, s48, 3768320
  s_add_u32 m0, s49, 88064
  s_nop 0
  buffer_load_dwordx4 v2, s[16:19], s50 offen lds
  s_add_u32 s50, s48, 3768320
  s_add_u32 m0, s49, 89088
  s_nop 0
  buffer_load_dwordx4 v3, s[16:19], s50 offen lds
  s_add_u32 s50, s48, 3801088
  s_add_u32 m0, s49, 90112
  s_nop 0
  buffer_load_dwordx4 v2, s[16:19], s50 offen lds
  s_add_u32 s50, s48, 3801088
  s_add_u32 m0, s49, 91136
  s_nop 0
  buffer_load_dwordx4 v3, s[16:19], s50 offen lds
  s_waitcnt vmcnt(18)
  s_barrier
  ds_read_b64_tr_b16 a[144:145], v4 offset:0
  ds_read_b64_tr_b16 a[146:147], v4 offset:2048
  ds_read_b64_tr_b16 a[148:149], v5 offset:0
  ds_read_b64_tr_b16 a[150:151], v5 offset:2048
  ds_read_b64_tr_b16 a[152:153], v4 offset:8192
  ds_read_b64_tr_b16 a[154:155], v4 offset:10240
  ds_read_b64_tr_b16 a[156:157], v5 offset:8192
  ds_read_b64_tr_b16 a[158:159], v5 offset:10240
  ds_read_b64_tr_b16 a[160:161], v4 offset:16384
  ds_read_b64_tr_b16 a[162:163], v4 offset:18432
  ds_read_b64_tr_b16 a[164:165], v5 offset:16384
  ds_read_b64_tr_b16 a[166:167], v5 offset:18432
  ds_read_b64_tr_b16 a[168:169], v4 offset:24576
  ds_read_b64_tr_b16 a[170:171], v4 offset:26624
  ds_read_b64_tr_b16 a[172:173], v5 offset:24576
  ds_read_b64_tr_b16 a[174:175], v5 offset:26624
  ds_read_b64_tr_b16 a[176:177], v4 offset:32768
  ds_read_b64_tr_b16 a[178:179], v4 offset:34816
  ds_read_b64_tr_b16 a[180:181], v5 offset:32768
  ds_read_b64_tr_b16 a[182:183], v5 offset:34816
  ds_read_b64_tr_b16 a[184:185], v4 offset:40960
  ds_read_b64_tr_b16 a[186:187], v4 offset:43008
  ds_read_b64_tr_b16 a[188:189], v5 offset:40960
  ds_read_b64_tr_b16 a[190:191], v5 offset:43008
  ds_read_b64_tr_b16 a[192:193], v4 offset:49152
  ds_read_b64_tr_b16 a[194:195], v4 offset:51200
  ds_read_b64_tr_b16 a[196:197], v5 offset:49152
  ds_read_b64_tr_b16 a[198:199], v5 offset:51200
  ds_read_b64_tr_b16 a[200:201], v4 offset:57344
  ds_read_b64_tr_b16 a[202:203], v4 offset:59392
  ds_read_b64_tr_b16 a[204:205], v5 offset:57344
  ds_read_b64_tr_b16 a[206:207], v5 offset:59392
  v_add_u32 v6, 65536, v4
  ds_read_b64_tr_b16 a[208:209], v6 offset:0
  v_add_u32 v6, 65536, v4
  ds_read_b64_tr_b16 a[210:211], v6 offset:2048
  v_add_u32 v6, 65536, v5
  ds_read_b64_tr_b16 a[212:213], v6 offset:0
  v_add_u32 v6, 65536, v5
  ds_read_b64_tr_b16 a[214:215], v6 offset:2048
  s_waitcnt lgkmcnt(0)
  s_waitcnt vmcnt(0)
  s_barrier
  v_add_u32 v6, 65536, v4
  ds_read_b64_tr_b16 a[216:217], v6 offset:8192
  v_add_u32 v6, 65536, v4
  ds_read_b64_tr_b16 a[218:219], v6 offset:10240
  v_add_u32 v6, 65536, v5
  ds_read_b64_tr_b16 a[220:221], v6 offset:8192
  v_add_u32 v6, 65536, v5
  ds_read_b64_tr_b16 a[222:223], v6 offset:10240
  v_add_u32 v6, 65536, v4
  ds_read_b64_tr_b16 a[224:225], v6 offset:16384
  v_add_u32 v6, 65536, v4
  ds_read_b64_tr_b16 a[226:227], v6 offset:18432
  v_add_u32 v6, 65536, v5
  ds_read_b64_tr_b16 a[228:229], v6 offset:16384
  v_add_u32 v6, 65536, v5
  ds_read_b64_tr_b16 a[230:231], v6 offset:18432
  v_add_u32 v6, 65536, v4
  ds_read_b64_tr_b16 a[232:233], v6 offset:24576
  v_add_u32 v6, 65536, v4
  ds_read_b64_tr_b16 a[234:235], v6 offset:26624
  v_add_u32 v6, 65536, v5
  ds_read_b64_tr_b16 a[236:237], v6 offset:24576
  v_add_u32 v6, 65536, v5
  ds_read_b64_tr_b16 a[238:239], v6 offset:26624
  v_add_u32 v6, 98304, v4
  ds_read_b64_tr_b16 a[240:241], v6 offset:0
  v_add_u32 v6, 98304, v4
  ds_read_b64_tr_b16 a[242:243], v6 offset:2048
  v_add_u32 v6, 98304, v5
  ds_read_b64_tr_b16 a[244:245], v6 offset:0
  v_add_u32 v6, 98304, v5
  ds_read_b64_tr_b16 a[246:247], v6 offset:2048
  v_add_u32 v6, 98304, v4
  ds_read_b64_tr_b16 a[248:249], v6 offset:8192
  v_add_u32 v6, 98304, v4
  ds_read_b64_tr_b16 a[250:251], v6 offset:10240
  v_add_u32 v6, 98304, v5
  ds_read_b64_tr_b16 a[252:253], v6 offset:8192
  v_add_u32 v6, 98304, v5
  ds_read_b64_tr_b16 a[254:255], v6 offset:10240
  v_add_u32 v6, 98304, v4
  ds_read_b64_tr_b16 v[224:225], v6 offset:16384
  v_add_u32 v6, 98304, v4
  ds_read_b64_tr_b16 v[226:227], v6 offset:18432
  v_add_u32 v6, 98304, v5
  ds_read_b64_tr_b16 v[228:229], v6 offset:16384
  v_add_u32 v6, 98304, v5
  ds_read_b64_tr_b16 v[230:231], v6 offset:18432
  v_add_u32 v6, 98304, v4
  ds_read_b64_tr_b16 v[232:233], v6 offset:24576
  v_add_u32 v6, 98304, v4
  ds_read_b64_tr_b16 v[234:235], v6 offset:26624
  v_add_u32 v6, 98304, v5
  ds_read_b64_tr_b16 v[236:237], v6 offset:24576
  v_add_u32 v6, 98304, v5
  ds_read_b64_tr_b16 v[238:239], v6 offset:26624
  v_add_u32 v6, 131072, v4
  ds_read_b64_tr_b16 v[240:241], v6 offset:0
  v_add_u32 v6, 131072, v4
  ds_read_b64_tr_b16 v[242:243], v6 offset:2048
  v_add_u32 v6, 131072, v5
  ds_read_b64_tr_b16 v[244:245], v6 offset:0
  v_add_u32 v6, 131072, v5
  ds_read_b64_tr_b16 v[246:247], v6 offset:2048
  v_add_u32 v6, 131072, v4
  ds_read_b64_tr_b16 v[248:249], v6 offset:8192
  v_add_u32 v6, 131072, v4
  ds_read_b64_tr_b16 v[250:251], v6 offset:10240
  v_add_u32 v6, 131072, v5
  ds_read_b64_tr_b16 v[252:253], v6 offset:8192
  v_add_u32 v6, 131072, v5
  ds_read_b64_tr_b16 v[254:255], v6 offset:10240
  s_waitcnt lgkmcnt(0)
  s_barrier
  s_load_dwordx2 s[4:5], s[0:1], 136
  s_waitcnt lgkmcnt(0)
  s_mov_b32 s16, s4
  s_mov_b32 s17, s5
  s_mov_b32 s18, 256
  s_mov_b32 s19, 0x00020000
  v_mov_b32 v27, 1
  s_mul_i32 s49, s3, 9216
  s_mul_i32 s54, s42, 36864
  s_add_u32 m0, s49, 0
  s_nop 0
  buffer_load_dwordx4 v16, s[12:15], s54 offen lds
  s_add_u32 m0, s49, 1024
  s_nop 0
  buffer_load_dwordx4 v17, s[12:15], s54 offen lds
  s_add_u32 m0, s49, 2048
  s_nop 0
  buffer_load_dwordx4 v18, s[12:15], s54 offen lds
  s_add_u32 m0, s49, 3072
  s_nop 0
  buffer_load_dwordx4 v19, s[12:15], s54 offen lds
  s_add_u32 m0, s49, 4096
  s_nop 0
  buffer_load_dwordx4 v20, s[12:15], s54 offen lds
  s_add_u32 m0, s49, 5120
  s_nop 0
  buffer_load_dwordx4 v21, s[12:15], s54 offen lds
  s_add_u32 m0, s49, 6144
  s_nop 0
  buffer_load_dwordx4 v22, s[12:15], s54 offen lds
  s_add_u32 m0, s49, 7168
  s_nop 0
  buffer_load_dwordx4 v23, s[12:15], s54 offen lds
  s_add_u32 m0, s49, 8192
  s_nop 0
  buffer_load_dwordx4 v24, s[12:15], s54 offen lds
  s_add_u32 s54, s54, 147456
  s_add_u32 m0, s49, 36864
  s_nop 0
  buffer_load_dwordx4 v16, s[12:15], s54 offen lds
  s_add_u32 m0, s49, 37888
  s_nop 0
  buffer_load_dwordx4 v17, s[12:15], s54 offen lds
  s_add_u32 m0, s49, 38912
  s_nop 0
  buffer_load_dwordx4 v18, s[12:15], s54 offen lds
  s_add_u32 m0, s49, 39936
  s_nop 0
  buffer_load_dwordx4 v19, s[12:15], s54 offen lds
  s_add_u32 m0, s49, 40960
  s_nop 0
  buffer_load_dwordx4 v20, s[12:15], s54 offen lds
  s_add_u32 m0, s49, 41984
  s_nop 0
  buffer_load_dwordx4 v21, s[12:15], s54 offen lds
  s_add_u32 m0, s49, 43008
  s_nop 0
  buffer_load_dwordx4 v22, s[12:15], s54 offen lds
  s_add_u32 m0, s49, 44032
  s_nop 0
  buffer_load_dwordx4 v23, s[12:15], s54 offen lds
  s_add_u32 m0, s49, 45056
  s_nop 0
  buffer_load_dwordx4 v24, s[12:15], s54 offen lds
  s_add_u32 s54, s54, 147456
  s_add_u32 m0, s49, 73728
  s_nop 0
  buffer_load_dwordx4 v16, s[12:15], s54 offen lds
  s_add_u32 m0, s49, 74752
  s_nop 0
  buffer_load_dwordx4 v17, s[12:15], s54 offen lds
  s_add_u32 m0, s49, 75776
  s_nop 0
  buffer_load_dwordx4 v18, s[12:15], s54 offen lds
  s_add_u32 m0, s49, 76800
  s_nop 0
  buffer_load_dwordx4 v19, s[12:15], s54 offen lds
  s_add_u32 m0, s49, 77824
  s_nop 0
  buffer_load_dwordx4 v20, s[12:15], s54 offen lds
  s_add_u32 m0, s49, 78848
  s_nop 0
  buffer_load_dwordx4 v21, s[12:15], s54 offen lds
  s_add_u32 m0, s49, 79872
  s_nop 0
  buffer_load_dwordx4 v22, s[12:15], s54 offen lds
  s_add_u32 m0, s49, 80896
  s_nop 0
  buffer_load_dwordx4 v23, s[12:15], s54 offen lds
  s_add_u32 m0, s49, 81920
  s_nop 0
  buffer_load_dwordx4 v24, s[12:15], s54 offen lds
  s_add_u32 s54, s54, 147456
  s_lshl_b32 s55, s42, 18
  s_add_u32 s55, s55, s52
  s_mov_b32 s57, 0
  s_cmp_eq_u32 s43, 2
  s_cbranch_scc1 P_V_21
  s_mov_b32 s56, 0
  s_mov_b32 s58, 1
  s_mov_b32 s28, s24
  s_mov_b32 s29, s25
  s_mov_b32 s30, s26
  s_mov_b32 s31, s27
P_LQ_23:
  s_waitcnt vmcnt(9)
  s_barrier
  s_cmp_lg_u32 s3, 0
  s_cbranch_scc1 P_sg_24
  s_lshl_b32 s60, s57, 2
  s_add_u32 s60, s60, 0
  s_cmp_lt_u32 s60, 2
  s_cbranch_scc1 P_sg_24
  s_sub_u32 s60, s60, 2
  s_lshl_b32 s60, s60, 2
  s_add_u32 s60, s60, 128
  v_mov_b32 v26, s60
  s_mov_b64 exec, 1
  s_nop 0
  buffer_atomic_add v27, v26, s[16:19], 0 offen offset:0 sc1
  s_mov_b64 exec, -1
P_sg_24:
  ds_read_b128 v[96:99], v8 offset:0
  ds_read_b128 v[100:103], v9 offset:0
  ds_read_b128 v[104:107], v10 offset:0
  ds_read_b128 v[108:111], v11 offset:0
  s_waitcnt lgkmcnt(3)
  v_mfma_f32_32x32x16_bf16 v[32:47], a[0:3], v[96:99], 0
  v_mfma_f32_32x32x16_bf16 v[48:63], a[4:7], v[96:99], 0
  ds_read_b128 v[96:99], v8 offset:128
  s_waitcnt lgkmcnt(3)
  v_mfma_f32_32x32x16_bf16 v[32:47], a[8:11], v[100:103], v[32:47]
  v_mfma_f32_32x32x16_bf16 v[48:63], a[12:15], v[100:103], v[48:63]
  ds_read_b128 v[100:103], v9 offset:128
  s_waitcnt lgkmcnt(3)
  v_mfma_f32_32x32x16_bf16 v[32:47], a[16:19], v[104:107], v[32:47]
  v_mfma_f32_32x32x16_bf16 v[48:63], a[20:23], v[104:107], v[48:63]
  v_cvt_pk_bf16_f32 v112, v64, v72
  ds_read_b128 v[104:107], v10 offset:128
  s_waitcnt lgkmcnt(3)
  v_mfma_f32_32x32x16_bf16 v[32:47], a[24:27], v[108:111], v[32:47]
  v_cvt_pk_bf16_f32 v113, v65, v73
  v_mfma_f32_32x32x16_bf16 v[48:63], a[28:31], v[108:111], v[48:63]
  ds_read_b128 v[108:111], v11 offset:128
  v_cvt_pk_bf16_f32 v114, v66, v74
  s_waitcnt lgkmcnt(3)
  v_mfma_f32_32x32x16_bf16 v[32:47], a[32:35], v[96:99], v[32:47]
  v_mfma_f32_32x32x16_bf16 v[48:63], a[36:39], v[96:99], v[48:63]
  v_cvt_pk_bf16_f32 v115, v67, v75
  ds_read_b128 v[96:99], v8 offset:256
  s_waitcnt lgkmcnt(3)
  v_mfma_f32_32x32x16_bf16 v[32:47], a[40:43], v[100:103], v[32:47]
  v_cvt_pk_bf16_f32 v116, v68, v76
  v_mfma_f32_32x32x16_bf16 v[48:63], a[44:47], v[100:103], v[48:63]
  ds_read_b128 v[100:103], v9 offset:256
  v_cvt_pk_bf16_f32 v117, v69, v77
  s_waitcnt lgkmcnt(3)
  v_mfma_f32_32x32x16_bf16 v[32:47], a[48:51], v[104:107], v[32:47]
  v_mfma_f32_32x32x16_bf16 v[48:63], a[52:55], v[104:107], v[48:63]
  v_cvt_pk_bf16_f32 v118, v70, v78
  ds_read_b128 v[104:107], v10 offset:256
  s_waitcnt lgkmcnt(3)
  v_mfma_f32_32x32x16_bf16 v[32:47], a[56:59], v[108:111], v[32:47]
  v_cvt_pk_bf16_f32 v119, v71, v79
  v_mfma_f32_32x32x16_bf16 v[48:63], a[60:63], v[108:111], v[48:63]
  ds_read_b128 v[108:111], v11 offset:256
  buffer_store_dwordx4 v[112:115], v25, s[28:31], s56 offen offset:0 sc1
  s_waitcnt lgkmcnt(3)
  v_mfma_f32_32x32x16_bf16 v[32:47], a[64:67], v[96:99], v[32:47]
  v_mfma_f32_32x32x16_bf16 v[48:63], a[68:71], v[96:99], v[48:63]
  buffer_store_dwordx4 v[116:119], v25, s[28:31], s56 offen offset:512 sc1
  ds_read_b128 v[96:99], v8 offset:384
  s_waitcnt lgkmcnt(3)
  v_mfma_f32_32x32x16_bf16 v[32:47], a[72:75], v[100:103], v[32:47]
  v_cvt_pk_bf16_f32 v120, v80, v88
  v_mfma_f32_32x32x16_bf16 v[48:63], a[76:79], v[100:103], v[48:63]
  ds_read_b128 v[100:103], v9 offset:384
  v_cvt_pk_bf16_f32 v121, v81, v89
  s_waitcnt lgkmcnt(3)
  v_mfma_f32_32x32x16_bf16 v[32:47], a[80:83], v[104:107], v[32:47]
  v_mfma_f32_32x32x16_bf16 v[48:63], a[84:87], v[104:107], v[48:63]
  v_cvt_pk_bf16_f32 v122, v82, v90
  ds_read_b128 v[104:107], v10 offset:384
  s_waitcnt lgkmcnt(3)
  v_mfma_f32_32x32x16_bf16 v[32:47], a[88:91], v[108:111], v[32:47]
  v_cvt_pk_bf16_f32 v123, v83, v91
  v_mfma_f32_32x32x16_bf16 v[48:63], a[92:95], v[108:111], v[48:63]
  ds_read_b128 v[108:111], v11 offset:384
  v_cvt_pk_bf16_f32 v124, v84, v92
  s_waitcnt lgkmcnt(3)
  v_mfma_f32_32x32x16_bf16 v[32:47], a[96:99], v[96:99], v[32:47]
  v_mfma_f32_32x32x16_bf16 v[48:63], a[100:103], v[96:99], v[48:63]
  v_cvt_pk_bf16_f32 v125, v85, v93
  ds_read_b128 v[96:99], v8 offset:512
  s_waitcnt lgkmcnt(3)
  v_mfma_f32_32x32x16_bf16 v[32:47], a[104:107], v[100:103], v[32:47]
  v_cvt_pk_bf16_f32 v126, v86, v94
  v_mfma_f32_32x32x16_bf16 v[48:63], a[108:111], v[100:103], v[48:63]
  ds_read_b128 v[100:103], v9 offset:512
  v_cvt_pk_bf16_f32 v127, v87, v95
  s_waitcnt lgkmcnt(3)
  v_mfma_f32_32x32x16_bf16 v[32:47], a[112:115], v[104:107], v[32:47]
  v_mfma_f32_32x32x16_bf16 v[48:63], a[116:119], v[104:107], v[48:63]
  buffer_store_dwordx4 v[120:123], v25, s[28:31], s56 offen offset:2048 sc1
  ds_read_b128 v[104:107], v10 offset:512
  s_waitcnt lgkmcnt(3)
  v_mfma_f32_32x32x16_bf16 v[32:47], a[120:123], v[108:111], v[32:47]
  buffer_store_dwordx4 v[124:127], v25, s[28:31], s56 offen offset:2560 sc1
  v_mfma_f32_32x32x16_bf16 v[48:63], a[124:127], v[108:111], v[48:63]
  ds_read_b128 v[108:111], v11 offset:512
  s_min_u32 s59, s54, 2322432
  s_waitcnt lgkmcnt(3)
  v_mfma_f32_32x32x16_bf16 v[32:47], a[128:131], v[96:99], v[32:47]
  v_mfma_f32_32x32x16_bf16 v[48:63], a[132:135], v[96:99], v[48:63]
  s_add_u32 m0, s49, 110592
  ds_read_b128 v[96:99], v8 offset:640
  s_waitcnt lgkmcnt(3)
  v_mfma_f32_32x32x16_bf16 v[32:47], a[136:139], v[100:103], v[32:47]
  buffer_load_dwordx4 v16, s[12:15], s59 offen lds
  v_mfma_f32_32x32x16_bf16 v[48:63], a[140:143], v[100:103], v[48:63]
  ds_read_b128 v[100:103], v9 offset:640
  s_add_u32 m0, s49, 111616
  s_waitcnt lgkmcnt(3)
  v_mfma_f32_32x32x16_bf16 v[32:47], a[144:147], v[104:107], v[32:47]
  v_mfma_f32_32x32x16_bf16 v[48:63], a[148:151], v[104:107], v[48:63]
  buffer_load_dwordx4 v17, s[12:15], s59 offen lds
  ds_read_b128 v[104:107], v10 offset:640
  s_waitcnt lgkmcnt(3)
  v_mfma_f32_32x32x16_bf16 v[32:47], a[152:155], v[108:111], v[32:47]
  s_add_u32 m0, s49, 112640
  v_mfma_f32_32x32x16_bf16 v[48:63], a[156:159], v[108:111], v[48:63]
  ds_read_b128 v[108:111], v11 offset:640
  buffer_load_dwordx4 v18, s[12:15], s59 offen lds
  s_waitcnt lgkmcnt(3)
  v_mfma_f32_32x32x16_bf16 v[32:47], a[160:163], v[96:99], v[32:47]
  v_mfma_f32_32x32x16_bf16 v[48:63], a[164:167], v[96:99], v[48:63]
  s_add_u32 m0, s49, 113664
  ds_read_b128 v[96:99], v8 offset:768
  s_waitcnt lgkmcnt(3)
  v_mfma_f32_32x32x16_bf16 v[32:47], a[168:171], v[100:103], v[32:47]
  buffer_load_dwordx4 v19, s[12:15], s59 offen lds
  v_mfma_f32_32x32x16_bf16 v[48:63], a[172:175], v[100:103], v[48:63]
  ds_read_b128 v[100:103], v9 offset:768
  s_add_u32 m0, s49, 114688
  s_waitcnt lgkmcnt(3)
  v_mfma_f32_32x32x16_bf16 v[32:47], a[176:179], v[104:107], v[32:47]
  v_mfma_f32_32x32x16_bf16 v[48:63], a[180:183], v[104:107], v[48:63]
  buffer_load_dwordx4 v20, s[12:15], s59 offen lds
  ds_read_b128 v[104:107], v10 offset:768
  s_waitcnt lgkmcnt(3)
  v_mfma_f32_32x32x16_bf16 v[32:47], a[184:187], v[108:111], v[32:47]
  s_add_u32 m0, s49, 115712
  v_mfma_f32_32x32x16_bf16 v[48:63], a[188:191], v[108:111], v[48:63]
  ds_read_b128 v[108:111], v11 offset:768
  buffer_load_dwordx4 v21, s[12:15], s59 offen lds
  s_waitcnt lgkmcnt(3)
  v_mfma_f32_32x32x16_bf16 v[32:47], a[192:195], v[96:99], v[32:47]
  v_mfma_f32_32x32x16_bf16 v[48:63], a[196:199], v[96:99], v[48:63]
  s_add_u32 m0, s49, 116736
  ds_read_b128 v[96:99], v8 offset:896
  s_waitcnt lgkmcnt(3)
  v_mfma_f32_32x32x16_bf16 v[32:47], a[200:203], v[100:103], v[32:47]
  buffer_load_dwordx4 v22, s[12:15], s59 offen lds
  v_mfma_f32_32x32x16_bf16 v[48:63], a[204:207], v[100:103], v[48:63]
  ds_read_b128 v[100:103], v9 offset:896
  s_add_u32 m0, s49, 117760
  s_waitcnt lgkmcnt(3)
  v_mfma_f32_32x32x16_bf16 v[32:47], a[208:211], v[104:107], v[32:47]
  v_mfma_f32_32x32x16_bf16 v[48:63], a[212:215], v[104:107], v[48:63]
  buffer_load_dwordx4 v23, s[12:15], s59 offen lds
  ds_read_b128 v[104:107], v10 offset:896
  s_waitcnt lgkmcnt(3)
  v_mfma_f32_32x32x16_bf16 v[32:47], a[216:219], v[108:111], v[32:47]
  s_add_u32 m0, s49, 118784
  v_mfma_f32_32x32x16_bf16 v[48:63], a[220:223], v[108:111], v[48:63]
  ds_read_b128 v[108:111], v11 offset:896
  buffer_load_dwordx4 v24, s[12:15], s59 offen lds
  s_waitcnt lgkmcnt(3)
  v_mfma_f32_32x32x16_bf16 v[32:47], a[224:227], v[96:99], v[32:47]
  v_mfma_f32_32x32x16_bf16 v[48:63], a[228:231], v[96:99], v[48:63]
  s_add_u32 s54, s54, 147456
  ds_read_b128 v[96:99], v8 offset:1024
  s_waitcnt lgkmcnt(3)
  v_mfma_f32_32x32x16_bf16 v[32:47], a[232:235], v[100:103], v[32:47]
  v_mfma_f32_32x32x16_bf16 v[48:63], a[236:239], v[100:103], v[48:63]
  ds_read_b128 v[100:103], v9 offset:1024
  s_waitcnt lgkmcnt(3)
  v_mfma_f32_32x32x16_bf16 v[32:47], a[240:243], v[104:107], v[32:47]
  v_mfma_f32_32x32x16_bf16 v[48:63], a[244:247], v[104:107], v[48:63]
  ds_read_b128 v[104:107], v10 offset:1024
  s_waitcnt lgkmcnt(3)
  v_mfma_f32_32x32x16_bf16 v[32:47], a[248:251], v[108:111], v[32:47]
  v_mfma_f32_32x32x16_bf16 v[48:63], a[252:255], v[108:111], v[48:63]
  ds_read_b128 v[108:111], v11 offset:1024
  s_waitcnt lgkmcnt(3)
  v_mfma_f32_32x32x16_bf16 v[32:47], v[224:227], v[96:99], v[32:47]
  v_mfma_f32_32x32x16_bf16 v[48:63], v[228:231], v[96:99], v[48:63]
  s_waitcnt lgkmcnt(2)
  v_mfma_f32_32x32x16_bf16 v[32:47], v[232:235], v[100:103], v[32:47]
  v_mfma_f32_32x32x16_bf16 v[48:63], v[236:239], v[100:103], v[48:63]
  s_waitcnt lgkmcnt(1)
  v_mfma_f32_32x32x16_bf16 v[32:47], v[240:243], v[104:107], v[32:47]
  v_mfma_f32_32x32x16_bf16 v[48:63], v[244:247], v[104:107], v[48:63]
  s_waitcnt lgkmcnt(0)
  v_mfma_f32_32x32x16_bf16 v[32:47], v[248:251], v[108:111], v[32:47]
  v_mfma_f32_32x32x16_bf16 v[48:63], v[252:255], v[108:111], v[48:63]
  s_mov_b32 s56, s55
  s_add_u32 s55, s55, 1048576
  s_mov_b32 s28, s20
  s_mov_b32 s29, s21
  s_mov_b32 s30, s22
  s_mov_b32 s31, s23
  s_waitcnt vmcnt(9)
  s_barrier
  s_cmp_lg_u32 s3, 0
  s_nop 2
  s_cbranch_scc1 P_sg_25
  s_lshl_b32 s60, s57, 2
  s_add_u32 s60, s60, 1
  s_cmp_lt_u32 s60, 2
  s_cbranch_scc1 P_sg_25
  s_sub_u32 s60, s60, 2
  s_lshl_b32 s60, s60, 2
  s_add_u32 s60, s60, 128
  v_mov_b32 v26, s60
  s_mov_b64 exec, 1
  s_nop 0
  buffer_atomic_add v27, v26, s[16:19], 0 offen offset:0 sc1
  s_mov_b64 exec, -1
P_sg_25:
  ds_read_b128 v[96:99], v8 offset:36864
  ds_read_b128 v[100:103], v9 offset:36864
  ds_read_b128 v[104:107], v10 offset:36864
  ds_read_b128 v[108:111], v11 offset:36864
  s_waitcnt lgkmcnt(3)
  v_mfma_f32_32x32x16_bf16 v[64:79], a[0:3], v[96:99], 0
  v_mfma_f32_32x32x16_bf16 v[80:95], a[4:7], v[96:99], 0
  ds_read_b128 v[96:99], v8 offset:36992
  s_waitcnt lgkmcnt(3)
  v_mfma_f32_32x32x16_bf16 v[64:79], a[8:11], v[100:103], v[64:79]
  v_mfma_f32_32x32x16_bf16 v[80:95], a[12:15], v[100:103], v[80:95]
  ds_read_b128 v[100:103], v9 offset:36992
  s_waitcnt lgkmcnt(3)
  v_mfma_f32_32x32x16_bf16 v[64:79], a[16:19], v[104:107], v[64:79]
  v_mfma_f32_32x32x16_bf16 v[80:95], a[20:23], v[104:107], v[80:95]
  v_cvt_pk_bf16_f32 v112, v32, v40
  ds_read_b128 v[104:107], v10 offset:36992
  s_waitcnt lgkmcnt(3)
  v_mfma_f32_32x32x16_bf16 v[64:79], a[24:27], v[108:111], v[64:79]
  v_cvt_pk_bf16_f32 v113, v33, v41
  v_mfma_f32_32x32x16_bf16 v[80:95], a[28:31], v[108:111], v[80:95]
  ds_read_b128 v[108:111], v11 offset:36992
  v_cvt_pk_bf16_f32 v114, v34, v42
  s_waitcnt lgkmcnt(3)
  v_mfma_f32_32x32x16_bf16 v[64:79], a[32:35], v[96:99], v[64:79]
  v_mfma_f32_32x32x16_bf16 v[80:95], a[36:39], v[96:99], v[80:95]
  v_cvt_pk_bf16_f32 v115, v35, v43
  ds_read_b128 v[96:99], v8 offset:37120
  s_waitcnt lgkmcnt(3)
  v_mfma_f32_32x32x16_bf16 v[64:79], a[40:43], v[100:103], v[64:79]
  v_cvt_pk_bf16_f32 v116, v36, v44
  v_mfma_f32_32x32x16_bf16 v[80:95], a[44:47], v[100:103], v[80:95]
  ds_read_b128 v[100:103], v9 offset:37120
  v_cvt_pk_bf16_f32 v117, v37, v45
  s_waitcnt lgkmcnt(3)
  v_mfma_f32_32x32x16_bf16 v[64:79], a[48:51], v[104:107], v[64:79]
  v_mfma_f32_32x32x16_bf16 v[80:95], a[52:55], v[104:107], v[80:95]
  v_cvt_pk_bf16_f32 v118, v38, v46
  ds_read_b128 v[104:107], v10 offset:37120
  s_waitcnt lgkmcnt(3)
  v_mfma_f32_32x32x16_bf16 v[64:79], a[56:59], v[108:111], v[64:79]
  v_cvt_pk_bf16_f32 v119, v39, v47
  v_mfma_f32_32x32x16_bf16 v[80:95], a[60:63], v[108:111], v[80:95]
  ds_read_b128 v[108:111], v11 offset:37120
  buffer_store_dwordx4 v[112:115], v25, s[28:31], s56 offen offset:0 sc1
  s_waitcnt lgkmcnt(3)
  v_mfma_f32_32x32x16_bf16 v[64:79], a[64:67], v[96:99], v[64:79]
  v_mfma_f32_32x32x16_bf16 v[80:95], a[68:71], v[96:99], v[80:95]
  buffer_store_dwordx4 v[116:119], v25, s[28:31], s56 offen offset:512 sc1
  ds_read_b128 v[96:99], v8 offset:37248
  s_waitcnt lgkmcnt(3)
  v_mfma_f32_32x32x16_bf16 v[64:79], a[72:75], v[100:103], v[64:79]
  v_cvt_pk_bf16_f32 v120, v48, v56
  v_mfma_f32_32x32x16_bf16 v[80:95], a[76:79], v[100:103], v[80:95]
  ds_read_b128 v[100:103], v9 offset:37248
  v_cvt_pk_bf16_f32 v121, v49, v57
  s_waitcnt lgkmcnt(3)
  v_mfma_f32_32x32x16_bf16 v[64:79], a[80:83], v[104:107], v[64:79]
  v_mfma_f32_32x32x16_bf16 v[80:95], a[84:87], v[104:107], v[80:95]
  v_cvt_pk_bf16_f32 v122, v50, v58
  ds_read_b128 v[104:107], v10 offset:37248
  s_waitcnt lgkmcnt(3)
  v_mfma_f32_32x32x16_bf16 v[64:79], a[88:91], v[108:111], v[64:79]
  v_cvt_pk_bf16_f32 v123, v51, v59
  v_mfma_f32_32x32x16_bf16 v[80:95], a[92:95], v[108:111], v[80:95]
  ds_read_b128 v[108:111], v11 offset:37248
  v_cvt_pk_bf16_f32 v124, v52, v60
  s_waitcnt lgkmcnt(3)
  v_mfma_f32_32x32x16_bf16 v[64:79], a[96:99], v[96:99], v[64:79]
  v_mfma_f32_32x32x16_bf16 v[80:95], a[100:103], v[96:99], v[80:95]
  v_cvt_pk_bf16_f32 v125, v53, v61
  ds_read_b128 v[96:99], v8 offset:37376
  s_waitcnt lgkmcnt(3)
  v_mfma_f32_32x32x16_bf16 v[64:79], a[104:107], v[100:103], v[64:79]
  v_cvt_pk_bf16_f32 v126, v54, v62
  v_mfma_f32_32x32x16_bf16 v[80:95], a[108:111], v[100:103], v[80:95]
  ds_read_b128 v[100:103], v9 offset:37376
  v_cvt_pk_bf16_f32 v127, v55, v63
  s_waitcnt lgkmcnt(3)
  v_mfma_f32_32x32x16_bf16 v[64:79], a[112:115], v[104:107], v[64:79]
  v_mfma_f32_32x32x16_bf16 v[80:95], a[116:119], v[104:107], v[80:95]
  buffer_store_dwordx4 v[120:123], v25, s[28:31], s56 offen offset:2048 sc1
  ds_read_b128 v[104:107], v10 offset:37376
  s_waitcnt lgkmcnt(3)
  v_mfma_f32_32x32x16_bf16 v[64:79], a[120:123], v[108:111], v[64:79]
  buffer_store_dwordx4 v[124:127], v25, s[28:31], s56 offen offset:2560 sc1
  v_mfma_f32_32x32x16_bf16 v[80:95], a[124:127], v[108:111], v[80:95]
  ds_read_b128 v[108:111], v11 offset:37376
  s_min_u32 s59, s54, 2322432
  s_waitcnt lgkmcnt(3)
  v_mfma_f32_32x32x16_bf16 v[64:79], a[128:131], v[96:99], v[64:79]
  v_mfma_f32_32x32x16_bf16 v[80:95], a[132:135], v[96:99], v[80:95]
  s_add_u32 m0, s49, 0
  ds_read_b128 v[96:99], v8 offset:37504
  s_waitcnt lgkmcnt(3)
  v_mfma_f32_32x32x16_bf16 v[64:79], a[136:139], v[100:103], v[64:79]
  buffer_load_dwordx4 v16, s[12:15], s59 offen lds
  v_mfma_f32_32x32x16_bf16 v[80:95], a[140:143], v[100:103], v[80:95]
  ds_read_b128 v[100:103], v9 offset:37504
  s_add_u32 m0, s49, 1024
  s_waitcnt lgkmcnt(3)
  v_mfma_f32_32x32x16_bf16 v[64:79], a[144:147], v[104:107], v[64:79]
  v_mfma_f32_32x32x16_bf16 v[80:95], a[148:151], v[104:107], v[80:95]
  buffer_load_dwordx4 v17, s[12:15], s59 offen lds
  ds_read_b128 v[104:107], v10 offset:37504
  s_waitcnt lgkmcnt(3)
  v_mfma_f32_32x32x16_bf16 v[64:79], a[152:155], v[108:111], v[64:79]
  s_add_u32 m0, s49, 2048
  v_mfma_f32_32x32x16_bf16 v[80:95], a[156:159], v[108:111], v[80:95]
  ds_read_b128 v[108:111], v11 offset:37504
  buffer_load_dwordx4 v18, s[12:15], s59 offen lds
  s_waitcnt lgkmcnt(3)
  v_mfma_f32_32x32x16_bf16 v[64:79], a[160:163], v[96:99], v[64:79]
  v_mfma_f32_32x32x16_bf16 v[80:95], a[164:167], v[96:99], v[80:95]
  s_add_u32 m0, s49, 3072
  ds_read_b128 v[96:99], v8 offset:37632
  s_waitcnt lgkmcnt(3)
  v_mfma_f32_32x32x16_bf16 v[64:79], a[168:171], v[100:103], v[64:79]
  buffer_load_dwordx4 v19, s[12:15], s59 offen lds
  v_mfma_f32_32x32x16_bf16 v[80:95], a[172:175], v[100:103], v[80:95]
  ds_read_b128 v[100:103], v9 offset:37632
  s_add_u32 m0, s49, 4096
  s_waitcnt lgkmcnt(3)
  v_mfma_f32_32x32x16_bf16 v[64:79], a[176:179], v[104:107], v[64:79]
  v_mfma_f32_32x32x16_bf16 v[80:95], a[180:183], v[104:107], v[80:95]
  buffer_load_dwordx4 v20, s[12:15], s59 offen lds
  ds_read_b128 v[104:107], v10 offset:37632
  s_waitcnt lgkmcnt(3)
  v_mfma_f32_32x32x16_bf16 v[64:79], a[184:187], v[108:111], v[64:79]
  s_add_u32 m0, s49, 5120
  v_mfma_f32_32x32x16_bf16 v[80:95], a[188:191], v[108:111], v[80:95]
  ds_read_b128 v[108:111], v11 offset:37632
  buffer_load_dwordx4 v21, s[12:15], s59 offen lds
  s_waitcnt lgkmcnt(3)
  v_mfma_f32_32x32x16_bf16 v[64:79], a[192:195], v[96:99], v[64:79]
  v_mfma_f32_32x32x16_bf16 v[80:95], a[196:199], v[96:99], v[80:95]
  s_add_u32 m0, s49, 6144
  ds_read_b128 v[96:99], v8 offset:37760
  s_waitcnt lgkmcnt(3)
  v_mfma_f32_32x32x16_bf16 v[64:79], a[200:203], v[100:103], v[64:79]
  buffer_load_dwordx4 v22, s[12:15], s59 offen lds
  v_mfma_f32_32x32x16_bf16 v[80:95], a[204:207], v[100:103], v[80:95]
  ds_read_b128 v[100:103], v9 offset:37760
  s_add_u32 m0, s49, 7168
  s_waitcnt lgkmcnt(3)
  v_mfma_f32_32x32x16_bf16 v[64:79], a[208:211], v[104:107], v[64:79]
  v_mfma_f32_32x32x16_bf16 v[80:95], a[212:215], v[104:107], v[80:95]
  buffer_load_dwordx4 v23, s[12:15], s59 offen lds
  ds_read_b128 v[104:107], v10 offset:37760
  s_waitcnt lgkmcnt(3)
  v_mfma_f32_32x32x16_bf16 v[64:79], a[216:219], v[108:111], v[64:79]
  s_add_u32 m0, s49, 8192
  v_mfma_f32_32x32x16_bf16 v[80:95], a[220:223], v[108:111], v[80:95]
  ds_read_b128 v[108:111], v11 offset:37760
  buffer_load_dwordx4 v24, s[12:15], s59 offen lds
  s_waitcnt lgkmcnt(3)
  v_mfma_f32_32x32x16_bf16 v[64:79], a[224:227], v[96:99], v[64:79]
  v_mfma_f32_32x32x16_bf16 v[80:95], a[228:231], v[96:99], v[80:95]
  s_add_u32 s54, s54, 147456
  ds_read_b128 v[96:99], v8 offset:37888
  s_waitcnt lgkmcnt(3)
  v_mfma_f32_32x32x16_bf16 v[64:79], a[232:235], v[100:103], v[64:79]
  v_mfma_f32_32x32x16_bf16 v[80:95], a[236:239], v[100:103], v[80:95]
  ds_read_b128 v[100:103], v9 offset:37888
  s_waitcnt lgkmcnt(3)
  v_mfma_f32_32x32x16_bf16 v[64:79], a[240:243], v[104:107], v[64:79]
  v_mfma_f32_32x32x16_bf16 v[80:95], a[244:247], v[104:107], v[80:95]
  ds_read_b128 v[104:107], v10 offset:37888
  s_waitcnt lgkmcnt(3)
  v_mfma_f32_32x32x16_bf16 v[64:79], a[248:251], v[108:111], v[64:79]
  v_mfma_f32_32x32x16_bf16 v[80:95], a[252:255], v[108:111], v[80:95]
  ds_read_b128 v[108:111], v11 offset:37888
  s_waitcnt lgkmcnt(3)
  v_mfma_f32_32x32x16_bf16 v[64:79], v[224:227], v[96:99], v[64:79]
  v_mfma_f32_32x32x16_bf16 v[80:95], v[228:231], v[96:99], v[80:95]
  s_waitcnt lgkmcnt(2)
  v_mfma_f32_32x32x16_bf16 v[64:79], v[232:235], v[100:103], v[64:79]
  v_mfma_f32_32x32x16_bf16 v[80:95], v[236:239], v[100:103], v[80:95]
  s_waitcnt lgkmcnt(1)
  v_mfma_f32_32x32x16_bf16 v[64:79], v[240:243], v[104:107], v[64:79]
  v_mfma_f32_32x32x16_bf16 v[80:95], v[244:247], v[104:107], v[80:95]
  s_waitcnt lgkmcnt(0)
  v_mfma_f32_32x32x16_bf16 v[64:79], v[248:251], v[108:111], v[64:79]
  v_mfma_f32_32x32x16_bf16 v[80:95], v[252:255], v[108:111], v[80:95]
  s_mov_b32 s56, s55
  s_add_u32 s55, s55, 1048576
  s_waitcnt vmcnt(9)
  s_barrier
  s_cmp_lg_u32 s3, 0
  s_nop 6
  s_cbranch_scc1 P_sg_26
  s_lshl_b32 s60, s57, 2
  s_add_u32 s60, s60, 2
  s_cmp_lt_u32 s60, 2
  s_cbranch_scc1 P_sg_26
  s_sub_u32 s60, s60, 2
  s_lshl_b32 s60, s60, 2
  s_add_u32 s60, s60, 128
  v_mov_b32 v26, s60
  s_mov_b64 exec, 1
  s_nop 0
  buffer_atomic_add v27, v26, s[16:19], 0 offen offset:0 sc1
  s_mov_b64 exec, -1
P_sg_26:
  ds_read_b128 v[96:99], v12 offset:0
  ds_read_b128 v[100:103], v13 offset:0
  ds_read_b128 v[104:107], v14 offset:0
  ds_read_b128 v[108:111], v15 offset:0
  s_waitcnt lgkmcnt(3)
  v_mfma_f32_32x32x16_bf16 v[32:47], a[0:3], v[96:99], 0
  v_mfma_f32_32x32x16_bf16 v[48:63], a[4:7], v[96:99], 0
  ds_read_b128 v[96:99], v12 offset:128
  s_waitcnt lgkmcnt(3)
  v_mfma_f32_32x32x16_bf16 v[32:47], a[8:11], v[100:103], v[32:47]
  v_mfma_f32_32x32x16_bf16 v[48:63], a[12:15], v[100:103], v[48:63]
  ds_read_b128 v[100:103], v13 offset:128
  s_waitcnt lgkmcnt(3)
  v_mfma_f32_32x32x16_bf16 v[32:47], a[16:19], v[104:107], v[32:47]
  v_mfma_f32_32x32x16_bf16 v[48:63], a[20:23], v[104:107], v[48:63]
  v_cvt_pk_bf16_f32 v112, v64, v72
  ds_read_b128 v[104:107], v14 offset:128
  s_waitcnt lgkmcnt(3)
  v_mfma_f32_32x32x16_bf16 v[32:47], a[24:27], v[108:111], v[32:47]
  v_cvt_pk_bf16_f32 v113, v65, v73
  v_mfma_f32_32x32x16_bf16 v[48:63], a[28:31], v[108:111], v[48:63]
  ds_read_b128 v[108:111], v15 offset:128
  v_cvt_pk_bf16_f32 v114, v66, v74
  s_waitcnt lgkmcnt(3)
  v_mfma_f32_32x32x16_bf16 v[32:47], a[32:35], v[96:99], v[32:47]
  v_mfma_f32_32x32x16_bf16 v[48:63], a[36:39], v[96:99], v[48:63]
  v_cvt_pk_bf16_f32 v115, v67, v75
  ds_read_b128 v[96:99], v12 offset:256
  s_waitcnt lgkmcnt(3)
  v_mfma_f32_32x32x16_bf16 v[32:47], a[40:43], v[100:103], v[32:47]
  v_cvt_pk_bf16_f32 v116, v68, v76
  v_mfma_f32_32x32x16_bf16 v[48:63], a[44:47], v[100:103], v[48:63]
  ds_read_b128 v[100:103], v13 offset:256
  v_cvt_pk_bf16_f32 v117, v69, v77
  s_waitcnt lgkmcnt(3)
  v_mfma_f32_32x32x16_bf16 v[32:47], a[48:51], v[104:107], v[32:47]
  v_mfma_f32_32x32x16_bf16 v[48:63], a[52:55], v[104:107], v[48:63]
  v_cvt_pk_bf16_f32 v118, v70, v78
  ds_read_b128 v[104:107], v14 offset:256
  s_waitcnt lgkmcnt(3)
  v_mfma_f32_32x32x16_bf16 v[32:47], a[56:59], v[108:111], v[32:47]
  v_cvt_pk_bf16_f32 v119, v71, v79
  v_mfma_f32_32x32x16_bf16 v[48:63], a[60:63], v[108:111], v[48:63]
  ds_read_b128 v[108:111], v15 offset:256
  buffer_store_dwordx4 v[112:115], v25, s[28:31], s56 offen offset:0 sc1
  s_waitcnt lgkmcnt(3)
  v_mfma_f32_32x32x16_bf16 v[32:47], a[64:67], v[96:99], v[32:47]
  v_mfma_f32_32x32x16_bf16 v[48:63], a[68:71], v[96:99], v[48:63]
  buffer_store_dwordx4 v[116:119], v25, s[28:31], s56 offen offset:512 sc1
  ds_read_b128 v[96:99], v12 offset:384
  s_waitcnt lgkmcnt(3)
  v_mfma_f32_32x32x16_bf16 v[32:47], a[72:75], v[100:103], v[32:47]
  v_cvt_pk_bf16_f32 v120, v80, v88
  v_mfma_f32_32x32x16_bf16 v[48:63], a[76:79], v[100:103], v[48:63]
  ds_read_b128 v[100:103], v13 offset:384
  v_cvt_pk_bf16_f32 v121, v81, v89
  s_waitcnt lgkmcnt(3)
  v_mfma_f32_32x32x16_bf16 v[32:47], a[80:83], v[104:107], v[32:47]
  v_mfma_f32_32x32x16_bf16 v[48:63], a[84:87], v[104:107], v[48:63]
  v_cvt_pk_bf16_f32 v122, v82, v90
  ds_read_b128 v[104:107], v14 offset:384
  s_waitcnt lgkmcnt(3)
  v_mfma_f32_32x32x16_bf16 v[32:47], a[88:91], v[108:111], v[32:47]
  v_cvt_pk_bf16_f32 v123, v83, v91
  v_mfma_f32_32x32x16_bf16 v[48:63], a[92:95], v[108:111], v[48:63]
  ds_read_b128 v[108:111], v15 offset:384
  v_cvt_pk_bf16_f32 v124, v84, v92
  s_waitcnt lgkmcnt(3)
  v_mfma_f32_32x32x16_bf16 v[32:47], a[96:99], v[96:99], v[32:47]
  v_mfma_f32_32x32x16_bf16 v[48:63], a[100:103], v[96:99], v[48:63]
  v_cvt_pk_bf16_f32 v125, v85, v93
  ds_read_b128 v[96:99], v12 offset:512
  s_waitcnt lgkmcnt(3)
  v_mfma_f32_32x32x16_bf16 v[32:47], a[104:107], v[100:103], v[32:47]
  v_cvt_pk_bf16_f32 v126, v86, v94
  v_mfma_f32_32x32x16_bf16 v[48:63], a[108:111], v[100:103], v[48:63]
  ds_read_b128 v[100:103], v13 offset:512
  v_cvt_pk_bf16_f32 v127, v87, v95
  s_waitcnt lgkmcnt(3)
  v_mfma_f32_32x32x16_bf16 v[32:47], a[112:115], v[104:107], v[32:47]
  v_mfma_f32_32x32x16_bf16 v[48:63], a[116:119], v[104:107], v[48:63]
  buffer_store_dwordx4 v[120:123], v25, s[28:31], s56 offen offset:2048 sc1
  ds_read_b128 v[104:107], v14 offset:512
  s_waitcnt lgkmcnt(3)
  v_mfma_f32_32x32x16_bf16 v[32:47], a[120:123], v[108:111], v[32:47]
  buffer_store_dwordx4 v[124:127], v25, s[28:31], s56 offen offset:2560 sc1
  v_mfma_f32_32x32x16_bf16 v[48:63], a[124:127], v[108:111], v[48:63]
  ds_read_b128 v[108:111], v15 offset:512
  s_min_u32 s59, s54, 2322432
  s_waitcnt lgkmcnt(3)
  v_mfma_f32_32x32x16_bf16 v[32:47], a[128:131], v[96:99], v[32:47]
  v_mfma_f32_32x32x16_bf16 v[48:63], a[132:135], v[96:99], v[48:63]
  s_add_u32 m0, s49, 36864
  ds_read_b128 v[96:99], v12 offset:640
  s_waitcnt lgkmcnt(3)
  v_mfma_f32_32x32x16_bf16 v[32:47], a[136:139], v[100:103], v[32:47]
  buffer_load_dwordx4 v16, s[12:15], s59 offen lds
  v_mfma_f32_32x32x16_bf16 v[48:63], a[140:143], v[100:103], v[48:63]
  ds_read_b128 v[100:103], v13 offset:640
  s_add_u32 m0, s49, 37888
  s_waitcnt lgkmcnt(3)
  v_mfma_f32_32x32x16_bf16 v[32:47], a[144:147], v[104:107], v[32:47]
  v_mfma_f32_32x32x16_bf16 v[48:63], a[148:151], v[104:107], v[48:63]
  buffer_load_dwordx4 v17, s[12:15], s59 offen lds
  ds_read_b128 v[104:107], v14 offset:640
  s_waitcnt lgkmcnt(3)
  v_mfma_f32_32x32x16_bf16 v[32:47], a[152:155], v[108:111], v[32:47]
  s_add_u32 m0, s49, 38912
  v_mfma_f32_32x32x16_bf16 v[48:63], a[156:159], v[108:111], v[48:63]
  ds_read_b128 v[108:111], v15 offset:640
  buffer_load_dwordx4 v18, s[12:15], s59 offen lds
  s_waitcnt lgkmcnt(3)
  v_mfma_f32_32x32x16_bf16 v[32:47], a[160:163], v[96:99], v[32:47]
  v_mfma_f32_32x32x16_bf16 v[48:63], a[164:167], v[96:99], v[48:63]
  s_add_u32 m0, s49, 39936
  ds_read_b128 v[96:99], v12 offset:768
  s_waitcnt lgkmcnt(3)
  v_mfma_f32_32x32x16_bf16 v[32:47], a[168:171], v[100:103], v[32:47]
  buffer_load_dwordx4 v19, s[12:15], s59 offen lds
  v_mfma_f32_32x32x16_bf16 v[48:63], a[172:175], v[100:103], v[48:63]
  ds_read_b128 v[100:103], v13 offset:768
  s_add_u32 m0, s49, 40960
  s_waitcnt lgkmcnt(3)
  v_mfma_f32_32x32x16_bf16 v[32:47], a[176:179], v[104:107], v[32:47]
  v_mfma_f32_32x32x16_bf16 v[48:63], a[180:183], v[104:107], v[48:63]
  buffer_load_dwordx4 v20, s[12:15], s59 offen lds
  ds_read_b128 v[104:107], v14 offset:768
  s_waitcnt lgkmcnt(3)
  v_mfma_f32_32x32x16_bf16 v[32:47], a[184:187], v[108:111], v[32:47]
  s_add_u32 m0, s49, 41984
  v_mfma_f32_32x32x16_bf16 v[48:63], a[188:191], v[108:111], v[48:63]
  ds_read_b128 v[108:111], v15 offset:768
  buffer_load_dwordx4 v21, s[12:15], s59 offen lds
  s_waitcnt lgkmcnt(3)
  v_mfma_f32_32x32x16_bf16 v[32:47], a[192:195], v[96:99], v[32:47]
  v_mfma_f32_32x32x16_bf16 v[48:63], a[196:199], v[96:99], v[48:63]
  s_add_u32 m0, s49, 43008
  ds_read_b128 v[96:99], v12 offset:896
  s_waitcnt lgkmcnt(3)
  v_mfma_f32_32x32x16_bf16 v[32:47], a[200:203], v[100:103], v[32:47]
  buffer_load_dwordx4 v22, s[12:15], s59 offen lds
  v_mfma_f32_32x32x16_bf16 v[48:63], a[204:207], v[100:103], v[48:63]
  ds_read_b128 v[100:103], v13 offset:896
  s_add_u32 m0, s49, 44032
  s_waitcnt lgkmcnt(3)
  v_mfma_f32_32x32x16_bf16 v[32:47], a[208:211], v[104:107], v[32:47]
  v_mfma_f32_32x32x16_bf16 v[48:63], a[212:215], v[104:107], v[48:63]
  buffer_load_dwordx4 v23, s[12:15], s59 offen lds
  ds_read_b128 v[104:107], v14 offset:896
  s_waitcnt lgkmcnt(3)
  v_mfma_f32_32x32x16_bf16 v[32:47], a[216:219], v[108:111], v[32:47]
  s_add_u32 m0, s49, 45056
  v_mfma_f32_32x32x16_bf16 v[48:63], a[220:223], v[108:111], v[48:63]
  ds_read_b128 v[108:111], v15 offset:896
  buffer_load_dwordx4 v24, s[12:15], s59 offen lds
  s_waitcnt lgkmcnt(3)
  v_mfma_f32_32x32x16_bf16 v[32:47], a[224:227], v[96:99], v[32:47]
  v_mfma_f32_32x32x16_bf16 v[48:63], a[228:231], v[96:99], v[48:63]
  s_add_u32 s54, s54, 147456
  ds_read_b128 v[96:99], v12 offset:1024
  s_waitcnt lgkmcnt(3)
  v_mfma_f32_32x32x16_bf16 v[32:47], a[232:235], v[100:103], v[32:47]
  v_mfma_f32_32x32x16_bf16 v[48:63], a[236:239], v[100:103], v[48:63]
  ds_read_b128 v[100:103], v13 offset:1024
  s_waitcnt lgkmcnt(3)
  v_mfma_f32_32x32x16_bf16 v[32:47], a[240:243], v[104:107], v[32:47]
  v_mfma_f32_32x32x16_bf16 v[48:63], a[244:247], v[104:107], v[48:63]
  ds_read_b128 v[104:107], v14 offset:1024
  s_waitcnt lgkmcnt(3)
  v_mfma_f32_32x32x16_bf16 v[32:47], a[248:251], v[108:111], v[32:47]
  v_mfma_f32_32x32x16_bf16 v[48:63], a[252:255], v[108:111], v[48:63]
  ds_read_b128 v[108:111], v15 offset:1024
  s_waitcnt lgkmcnt(3)
  v_mfma_f32_32x32x16_bf16 v[32:47], v[224:227], v[96:99], v[32:47]
  v_mfma_f32_32x32x16_bf16 v[48:63], v[228:231], v[96:99], v[48:63]
  s_waitcnt lgkmcnt(2)
  v_mfma_f32_32x32x16_bf16 v[32:47], v[232:235], v[100:103], v[32:47]
  v_mfma_f32_32x32x16_bf16 v[48:63], v[236:239], v[100:103], v[48:63]
  s_waitcnt lgkmcnt(1)
  v_mfma_f32_32x32x16_bf16 v[32:47], v[240:243], v[104:107], v[32:47]
  v_mfma_f32_32x32x16_bf16 v[48:63], v[244:247], v[104:107], v[48:63]
  s_waitcnt lgkmcnt(0)
  v_mfma_f32_32x32x16_bf16 v[32:47], v[248:251], v[108:111], v[32:47]
  v_mfma_f32_32x32x16_bf16 v[48:63], v[252:255], v[108:111], v[48:63]
  s_mov_b32 s56, s55
  s_add_u32 s55, s55, 1048576
  s_waitcnt vmcnt(9)
  s_barrier
  s_cmp_lg_u32 s3, 0
  s_nop 6
  s_cbranch_scc1 P_sg_27
  s_lshl_b32 s60, s57, 2
  s_add_u32 s60, s60, 3
  s_cmp_lt_u32 s60, 2
  s_cbranch_scc1 P_sg_27
  s_sub_u32 s60, s60, 2
  s_lshl_b32 s60, s60, 2
  s_add_u32 s60, s60, 128
  v_mov_b32 v26, s60
  s_mov_b64 exec, 1
  s_nop 0
  buffer_atomic_add v27, v26, s[16:19], 0 offen offset:0 sc1
  s_mov_b64 exec, -1
P_sg_27:
  ds_read_b128 v[96:99], v12 offset:36864
  ds_read_b128 v[100:103], v13 offset:36864
  ds_read_b128 v[104:107], v14 offset:36864
  ds_read_b128 v[108:111], v15 offset:36864
  s_waitcnt lgkmcnt(3)
  v_mfma_f32_32x32x16_bf16 v[64:79], a[0:3], v[96:99], 0
  v_mfma_f32_32x32x16_bf16 v[80:95], a[4:7], v[96:99], 0
  ds_read_b128 v[96:99], v12 offset:36992
  s_waitcnt lgkmcnt(3)
  v_mfma_f32_32x32x16_bf16 v[64:79], a[8:11], v[100:103], v[64:79]
  v_mfma_f32_32x32x16_bf16 v[80:95], a[12:15], v[100:103], v[80:95]
  ds_read_b128 v[100:103], v13 offset:36992
  s_waitcnt lgkmcnt(3)
  v_mfma_f32_32x32x16_bf16 v[64:79], a[16:19], v[104:107], v[64:79]
  v_mfma_f32_32x32x16_bf16 v[80:95], a[20:23], v[104:107], v[80:95]
  v_cvt_pk_bf16_f32 v112, v32, v40
  ds_read_b128 v[104:107], v14 offset:36992
  s_waitcnt lgkmcnt(3)
  v_mfma_f32_32x32x16_bf16 v[64:79], a[24:27], v[108:111], v[64:79]
  v_cvt_pk_bf16_f32 v113, v33, v41
  v_mfma_f32_32x32x16_bf16 v[80:95], a[28:31], v[108:111], v[80:95]
  ds_read_b128 v[108:111], v15 offset:36992
  v_cvt_pk_bf16_f32 v114, v34, v42
  s_waitcnt lgkmcnt(3)
  v_mfma_f32_32x32x16_bf16 v[64:79], a[32:35], v[96:99], v[64:79]
  v_mfma_f32_32x32x16_bf16 v[80:95], a[36:39], v[96:99], v[80:95]
  v_cvt_pk_bf16_f32 v115, v35, v43
  ds_read_b128 v[96:99], v12 offset:37120
  s_waitcnt lgkmcnt(3)
  v_mfma_f32_32x32x16_bf16 v[64:79], a[40:43], v[100:103], v[64:79]
  v_cvt_pk_bf16_f32 v116, v36, v44
  v_mfma_f32_32x32x16_bf16 v[80:95], a[44:47], v[100:103], v[80:95]
  ds_read_b128 v[100:103], v13 offset:37120
  v_cvt_pk_bf16_f32 v117, v37, v45
  s_waitcnt lgkmcnt(3)
  v_mfma_f32_32x32x16_bf16 v[64:79], a[48:51], v[104:107], v[64:79]
  v_mfma_f32_32x32x16_bf16 v[80:95], a[52:55], v[104:107], v[80:95]
  v_cvt_pk_bf16_f32 v118, v38, v46
  ds_read_b128 v[104:107], v14 offset:37120
  s_waitcnt lgkmcnt(3)
  v_mfma_f32_32x32x16_bf16 v[64:79], a[56:59], v[108:111], v[64:79]
  v_cvt_pk_bf16_f32 v119, v39, v47
  v_mfma_f32_32x32x16_bf16 v[80:95], a[60:63], v[108:111], v[80:95]
  ds_read_b128 v[108:111], v15 offset:37120
  buffer_store_dwordx4 v[112:115], v25, s[28:31], s56 offen offset:0 sc1
  s_waitcnt lgkmcnt(3)
  v_mfma_f32_32x32x16_bf16 v[64:79], a[64:67], v[96:99], v[64:79]
  v_mfma_f32_32x32x16_bf16 v[80:95], a[68:71], v[96:99], v[80:95]
  buffer_store_dwordx4 v[116:119], v25, s[28:31], s56 offen offset:512 sc1
  ds_read_b128 v[96:99], v12 offset:37248
  s_waitcnt lgkmcnt(3)
  v_mfma_f32_32x32x16_bf16 v[64:79], a[72:75], v[100:103], v[64:79]
  v_cvt_pk_bf16_f32 v120, v48, v56
  v_mfma_f32_32x32x16_bf16 v[80:95], a[76:79], v[100:103], v[80:95]
  ds_read_b128 v[100:103], v13 offset:37248
  v_cvt_pk_bf16_f32 v121, v49, v57
  s_waitcnt lgkmcnt(3)
  v_mfma_f32_32x32x16_bf16 v[64:79], a[80:83], v[104:107], v[64:79]
  v_mfma_f32_32x32x16_bf16 v[80:95], a[84:87], v[104:107], v[80:95]
  v_cvt_pk_bf16_f32 v122, v50, v58
  ds_read_b128 v[104:107], v14 offset:37248
  s_waitcnt lgkmcnt(3)
  v_mfma_f32_32x32x16_bf16 v[64:79], a[88:91], v[108:111], v[64:79]
  v_cvt_pk_bf16_f32 v123, v51, v59
  v_mfma_f32_32x32x16_bf16 v[80:95], a[92:95], v[108:111], v[80:95]
  ds_read_b128 v[108:111], v15 offset:37248
  v_cvt_pk_bf16_f32 v124, v52, v60
  s_waitcnt lgkmcnt(3)
  v_mfma_f32_32x32x16_bf16 v[64:79], a[96:99], v[96:99], v[64:79]
  v_mfma_f32_32x32x16_bf16 v[80:95], a[100:103], v[96:99], v[80:95]
  v_cvt_pk_bf16_f32 v125, v53, v61
  ds_read_b128 v[96:99], v12 offset:37376
  s_waitcnt lgkmcnt(3)
  v_mfma_f32_32x32x16_bf16 v[64:79], a[104:107], v[100:103], v[64:79]
  v_cvt_pk_bf16_f32 v126, v54, v62
  v_mfma_f32_32x32x16_bf16 v[80:95], a[108:111], v[100:103], v[80:95]
  ds_read_b128 v[100:103], v13 offset:37376
  v_cvt_pk_bf16_f32 v127, v55, v63
  s_waitcnt lgkmcnt(3)
  v_mfma_f32_32x32x16_bf16 v[64:79], a[112:115], v[104:107], v[64:79]
  v_mfma_f32_32x32x16_bf16 v[80:95], a[116:119], v[104:107], v[80:95]
  buffer_store_dwordx4 v[120:123], v25, s[28:31], s56 offen offset:2048 sc1
  ds_read_b128 v[104:107], v14 offset:37376
  s_waitcnt lgkmcnt(3)
  v_mfma_f32_32x32x16_bf16 v[64:79], a[120:123], v[108:111], v[64:79]
  buffer_store_dwordx4 v[124:127], v25, s[28:31], s56 offen offset:2560 sc1
  v_mfma_f32_32x32x16_bf16 v[80:95], a[124:127], v[108:111], v[80:95]
  ds_read_b128 v[108:111], v15 offset:37376
  s_min_u32 s59, s54, 2322432
  s_waitcnt lgkmcnt(3)
  v_mfma_f32_32x32x16_bf16 v[64:79], a[128:131], v[96:99], v[64:79]
  v_mfma_f32_32x32x16_bf16 v[80:95], a[132:135], v[96:99], v[80:95]
  s_add_u32 m0, s49, 73728
  ds_read_b128 v[96:99], v12 offset:37504
  s_waitcnt lgkmcnt(3)
  v_mfma_f32_32x32x16_bf16 v[64:79], a[136:139], v[100:103], v[64:79]
  buffer_load_dwordx4 v16, s[12:15], s59 offen lds
  v_mfma_f32_32x32x16_bf16 v[80:95], a[140:143], v[100:103], v[80:95]
  ds_read_b128 v[100:103], v13 offset:37504
  s_add_u32 m0, s49, 74752
  s_waitcnt lgkmcnt(3)
  v_mfma_f32_32x32x16_bf16 v[64:79], a[144:147], v[104:107], v[64:79]
  v_mfma_f32_32x32x16_bf16 v[80:95], a[148:151], v[104:107], v[80:95]
  buffer_load_dwordx4 v17, s[12:15], s59 offen lds
  ds_read_b128 v[104:107], v14 offset:37504
  s_waitcnt lgkmcnt(3)
  v_mfma_f32_32x32x16_bf16 v[64:79], a[152:155], v[108:111], v[64:79]
  s_add_u32 m0, s49, 75776
  v_mfma_f32_32x32x16_bf16 v[80:95], a[156:159], v[108:111], v[80:95]
  ds_read_b128 v[108:111], v15 offset:37504
  buffer_load_dwordx4 v18, s[12:15], s59 offen lds
  s_waitcnt lgkmcnt(3)
  v_mfma_f32_32x32x16_bf16 v[64:79], a[160:163], v[96:99], v[64:79]
  v_mfma_f32_32x32x16_bf16 v[80:95], a[164:167], v[96:99], v[80:95]
  s_add_u32 m0, s49, 76800
  ds_read_b128 v[96:99], v12 offset:37632
  s_waitcnt lgkmcnt(3)
  v_mfma_f32_32x32x16_bf16 v[64:79], a[168:171], v[100:103], v[64:79]
  buffer_load_dwordx4 v19, s[12:15], s59 offen lds
  v_mfma_f32_32x32x16_bf16 v[80:95], a[172:175], v[100:103], v[80:95]
  ds_read_b128 v[100:103], v13 offset:37632
  s_add_u32 m0, s49, 77824
  s_waitcnt lgkmcnt(3)
  v_mfma_f32_32x32x16_bf16 v[64:79], a[176:179], v[104:107], v[64:79]
  v_mfma_f32_32x32x16_bf16 v[80:95], a[180:183], v[104:107], v[80:95]
  buffer_load_dwordx4 v20, s[12:15], s59 offen lds
  ds_read_b128 v[104:107], v14 offset:37632
  s_waitcnt lgkmcnt(3)
  v_mfma_f32_32x32x16_bf16 v[64:79], a[184:187], v[108:111], v[64:79]
  s_add_u32 m0, s49, 78848
  v_mfma_f32_32x32x16_bf16 v[80:95], a[188:191], v[108:111], v[80:95]
  ds_read_b128 v[108:111], v15 offset:37632
  buffer_load_dwordx4 v21, s[12:15], s59 offen lds
  s_waitcnt lgkmcnt(3)
  v_mfma_f32_32x32x16_bf16 v[64:79], a[192:195], v[96:99], v[64:79]
  v_mfma_f32_32x32x16_bf16 v[80:95], a[196:199], v[96:99], v[80:95]
  s_add_u32 m0, s49, 79872
  ds_read_b128 v[96:99], v12 offset:37760
  s_waitcnt lgkmcnt(3)
  v_mfma_f32_32x32x16_bf16 v[64:79], a[200:203], v[100:103], v[64:79]
  buffer_load_dwordx4 v22, s[12:15], s59 offen lds
  v_mfma_f32_32x32x16_bf16 v[80:95], a[204:207], v[100:103], v[80:95]
  ds_read_b128 v[100:103], v13 offset:37760
  s_add_u32 m0, s49, 80896
  s_waitcnt lgkmcnt(3)
  v_mfma_f32_32x32x16_bf16 v[64:79], a[208:211], v[104:107], v[64:79]
  v_mfma_f32_32x32x16_bf16 v[80:95], a[212:215], v[104:107], v[80:95]
  buffer_load_dwordx4 v23, s[12:15], s59 offen lds
  ds_read_b128 v[104:107], v14 offset:37760
  s_waitcnt lgkmcnt(3)
  v_mfma_f32_32x32x16_bf16 v[64:79], a[216:219], v[108:111], v[64:79]
  s_add_u32 m0, s49, 81920
  v_mfma_f32_32x32x16_bf16 v[80:95], a[220:223], v[108:111], v[80:95]
  ds_read_b128 v[108:111], v15 offset:37760
  buffer_load_dwordx4 v24, s[12:15], s59 offen lds
  s_waitcnt lgkmcnt(3)
  v_mfma_f32_32x32x16_bf16 v[64:79], a[224:227], v[96:99], v[64:79]
  v_mfma_f32_32x32x16_bf16 v[80:95], a[228:231], v[96:99], v[80:95]
  s_add_u32 s54, s54, 147456
  ds_read_b128 v[96:99], v12 offset:37888
  s_waitcnt lgkmcnt(3)
  v_mfma_f32_32x32x16_bf16 v[64:79], a[232:235], v[100:103], v[64:79]
  v_mfma_f32_32x32x16_bf16 v[80:95], a[236:239], v[100:103], v[80:95]
  ds_read_b128 v[100:103], v13 offset:37888
  s_waitcnt lgkmcnt(3)
  v_mfma_f32_32x32x16_bf16 v[64:79], a[240:243], v[104:107], v[64:79]
  v_mfma_f32_32x32x16_bf16 v[80:95], a[244:247], v[104:107], v[80:95]
  ds_read_b128 v[104:107], v14 offset:37888
  s_waitcnt lgkmcnt(3)
  v_mfma_f32_32x32x16_bf16 v[64:79], a[248:251], v[108:111], v[64:79]
  v_mfma_f32_32x32x16_bf16 v[80:95], a[252:255], v[108:111], v[80:95]
  ds_read_b128 v[108:111], v15 offset:37888
  s_waitcnt lgkmcnt(3)
  v_mfma_f32_32x32x16_bf16 v[64:79], v[224:227], v[96:99], v[64:79]
  v_mfma_f32_32x32x16_bf16 v[80:95], v[228:231], v[96:99], v[80:95]
  s_waitcnt lgkmcnt(2)
  v_mfma_f32_32x32x16_bf16 v[64:79], v[232:235], v[100:103], v[64:79]
  v_mfma_f32_32x32x16_bf16 v[80:95], v[236:239], v[100:103], v[80:95]
  s_waitcnt lgkmcnt(1)
  v_mfma_f32_32x32x16_bf16 v[64:79], v[240:243], v[104:107], v[64:79]
  v_mfma_f32_32x32x16_bf16 v[80:95], v[244:247], v[104:107], v[80:95]
  s_waitcnt lgkmcnt(0)
  v_mfma_f32_32x32x16_bf16 v[64:79], v[248:251], v[108:111], v[64:79]
  v_mfma_f32_32x32x16_bf16 v[80:95], v[252:255], v[108:111], v[80:95]
  s_mov_b32 s56, s55
  s_add_u32 s55, s55, 1048576
  s_add_u32 s57, s57, 1
  s_cmp_lt_u32 s57, 4
  s_nop 7
  s_cbranch_scc1 P_LQ_23
  v_cvt_pk_bf16_f32 v112, v64, v72
  v_cvt_pk_bf16_f32 v113, v65, v73
  v_cvt_pk_bf16_f32 v114, v66, v74
  v_cvt_pk_bf16_f32 v115, v67, v75
  v_cvt_pk_bf16_f32 v116, v68, v76
  v_cvt_pk_bf16_f32 v117, v69, v77
  v_cvt_pk_bf16_f32 v118, v70, v78
  v_cvt_pk_bf16_f32 v119, v71, v79
  buffer_store_dwordx4 v[112:115], v25, s[28:31], s56 offen offset:0 sc1
  buffer_store_dwordx4 v[116:119], v25, s[28:31], s56 offen offset:512 sc1
  v_cvt_pk_bf16_f32 v120, v80, v88
  v_cvt_pk_bf16_f32 v121, v81, v89
  v_cvt_pk_bf16_f32 v122, v82, v90
  v_cvt_pk_bf16_f32 v123, v83, v91
  v_cvt_pk_bf16_f32 v124, v84, v92
  v_cvt_pk_bf16_f32 v125, v85, v93
  v_cvt_pk_bf16_f32 v126, v86, v94
  v_cvt_pk_bf16_f32 v127, v87, v95
  buffer_store_dwordx4 v[120:123], v25, s[28:31], s56 offen offset:2048 sc1
  buffer_store_dwordx4 v[124:127], v25, s[28:31], s56 offen offset:2560 sc1
  s_waitcnt vmcnt(0)
  s_barrier
  s_cmp_lg_u32 s3, 0
  s_cbranch_scc1 P_sg_28
  s_mov_b32 s60, 14
  s_lshl_b32 s60, s60, 2
  s_add_u32 s60, s60, 128
  v_mov_b32 v26, s60
  s_mov_b64 exec, 1
  s_nop 0
  buffer_atomic_add v27, v26, s[16:19], 0 offen offset:0 sc1
  buffer_atomic_add v27, v26, s[16:19], 0 offen offset:4 sc1
  s_mov_b64 exec, -1
P_sg_28:
  s_waitcnt vmcnt(0)
  s_branch P_E_22
P_V_21:
  s_mov_b32 s56, 0
  s_mov_b32 s58, 1
  s_mov_b32 s28, s24
  s_mov_b32 s29, s25
  s_mov_b32 s30, s26
  s_mov_b32 s31, s27
P_LV_29:
  s_waitcnt vmcnt(9)
  s_barrier
  s_cmp_lg_u32 s3, 0
  s_cbranch_scc1 P_sg_30
  s_lshl_b32 s60, s57, 2
  s_add_u32 s60, s60, 0
  s_cmp_lt_u32 s60, 2
  s_cbranch_scc1 P_sg_30
  s_sub_u32 s60, s60, 2
  s_lshl_b32 s60, s60, 2
  s_add_u32 s60, s60, 128
  v_mov_b32 v26, s60
  s_mov_b64 exec, 1
  s_nop 0
  buffer_atomic_add v27, v26, s[16:19], 0 offen offset:0 sc1
  s_mov_b64 exec, -1
P_sg_30:
  ds_read_b128 v[96:99], v8 offset:0
  ds_read_b128 v[100:103], v9 offset:0
  ds_read_b128 v[104:107], v10 offset:0
  ds_read_b128 v[108:111], v11 offset:0
  s_waitcnt lgkmcnt(3)
  v_mfma_f32_32x32x16_bf16 v[32:47], v[96:99], a[0:3], 0
  v_mfma_f32_32x32x16_bf16 v[48:63], v[96:99], a[4:7], 0
  ds_read_b128 v[96:99], v8 offset:128
  s_waitcnt lgkmcnt(3)
  v_mfma_f32_32x32x16_bf16 v[32:47], v[100:103], a[8:11], v[32:47]
  v_mfma_f32_32x32x16_bf16 v[48:63], v[100:103], a[12:15], v[48:63]
  ds_read_b128 v[100:103], v9 offset:128
  s_waitcnt lgkmcnt(3)
  v_mfma_f32_32x32x16_bf16 v[32:47], v[104:107], a[16:19], v[32:47]
  v_mfma_f32_32x32x16_bf16 v[48:63], v[104:107], a[20:23], v[48:63]
  v_cvt_pk_bf16_f32 v112, v64, v65
  ds_read_b128 v[104:107], v10 offset:128
  s_waitcnt lgkmcnt(3)
  v_mfma_f32_32x32x16_bf16 v[32:47], v[108:111], a[24:27], v[32:47]
  v_cvt_pk_bf16_f32 v113, v66, v67
  v_mfma_f32_32x32x16_bf16 v[48:63], v[108:111], a[28:31], v[48:63]
  ds_read_b128 v[108:111], v11 offset:128
  v_cvt_pk_bf16_f32 v114, v72, v73
  s_waitcnt lgkmcnt(3)
  v_mfma_f32_32x32x16_bf16 v[32:47], v[96:99], a[32:35], v[32:47]
  v_mfma_f32_32x32x16_bf16 v[48:63], v[96:99], a[36:39], v[48:63]
  v_cvt_pk_bf16_f32 v115, v74, v75
  ds_read_b128 v[96:99], v8 offset:256
  s_waitcnt lgkmcnt(3)
  v_mfma_f32_32x32x16_bf16 v[32:47], v[100:103], a[40:43], v[32:47]
  v_cvt_pk_bf16_f32 v116, v68, v69
  v_mfma_f32_32x32x16_bf16 v[48:63], v[100:103], a[44:47], v[48:63]
  ds_read_b128 v[100:103], v9 offset:256
  v_cvt_pk_bf16_f32 v117, v70, v71
  s_waitcnt lgkmcnt(3)
  v_mfma_f32_32x32x16_bf16 v[32:47], v[104:107], a[48:51], v[32:47]
  v_mfma_f32_32x32x16_bf16 v[48:63], v[104:107], a[52:55], v[48:63]
  v_cvt_pk_bf16_f32 v118, v76, v77
  ds_read_b128 v[104:107], v10 offset:256
  s_waitcnt lgkmcnt(3)
  v_mfma_f32_32x32x16_bf16 v[32:47], v[108:111], a[56:59], v[32:47]
  v_cvt_pk_bf16_f32 v119, v78, v79
  v_mfma_f32_32x32x16_bf16 v[48:63], v[108:111], a[60:63], v[48:63]
  ds_read_b128 v[108:111], v11 offset:256
  buffer_store_dwordx4 v[112:115], v25, s[28:31], s56 offen offset:0 sc1
  s_waitcnt lgkmcnt(3)
  v_mfma_f32_32x32x16_bf16 v[32:47], v[96:99], a[64:67], v[32:47]
  v_mfma_f32_32x32x16_bf16 v[48:63], v[96:99], a[68:71], v[48:63]
  buffer_store_dwordx4 v[116:119], v25, s[28:31], s56 offen offset:512 sc1
  ds_read_b128 v[96:99], v8 offset:384
  s_waitcnt lgkmcnt(3)
  v_mfma_f32_32x32x16_bf16 v[32:47], v[100:103], a[72:75], v[32:47]
  v_cvt_pk_bf16_f32 v120, v80, v81
  v_mfma_f32_32x32x16_bf16 v[48:63], v[100:103], a[76:79], v[48:63]
  ds_read_b128 v[100:103], v9 offset:384
  v_cvt_pk_bf16_f32 v121, v82, v83
  s_waitcnt lgkmcnt(3)
  v_mfma_f32_32x32x16_bf16 v[32:47], v[104:107], a[80:83], v[32:47]
  v_mfma_f32_32x32x16_bf16 v[48:63], v[104:107], a[84:87], v[48:63]
  v_cvt_pk_bf16_f32 v122, v88, v89
  ds_read_b128 v[104:107], v10 offset:384
  s_waitcnt lgkmcnt(3)
  v_mfma_f32_32x32x16_bf16 v[32:47], v[108:111], a[88:91], v[32:47]
  v_cvt_pk_bf16_f32 v123, v90, v91
  v_mfma_f32_32x32x16_bf16 v[48:63], v[108:111], a[92:95], v[48:63]
  ds_read_b128 v[108:111], v11 offset:384
  v_cvt_pk_bf16_f32 v124, v84, v85
  s_waitcnt lgkmcnt(3)
  v_mfma_f32_32x32x16_bf16 v[32:47], v[96:99], a[96:99], v[32:47]
  v_mfma_f32_32x32x16_bf16 v[48:63], v[96:99], a[100:103], v[48:63]
  v_cvt_pk_bf16_f32 v125, v86, v87
  ds_read_b128 v[96:99], v8 offset:512
  s_waitcnt lgkmcnt(3)
  v_mfma_f32_32x32x16_bf16 v[32:47], v[100:103], a[104:107], v[32:47]
  v_cvt_pk_bf16_f32 v126, v92, v93
  v_mfma_f32_32x32x16_bf16 v[48:63], v[100:103], a[108:111], v[48:63]
  ds_read_b128 v[100:103], v9 offset:512
  v_cvt_pk_bf16_f32 v127, v94, v95
  s_waitcnt lgkmcnt(3)
  v_mfma_f32_32x32x16_bf16 v[32:47], v[104:107], a[112:115], v[32:47]
  v_mfma_f32_32x32x16_bf16 v[48:63], v[104:107], a[116:119], v[48:63]
  buffer_store_dwordx4 v[120:123], v25, s[28:31], s56 offen offset:2048 sc1
  ds_read_b128 v[104:107], v10 offset:512
  s_waitcnt lgkmcnt(3)
  v_mfma_f32_32x32x16_bf16 v[32:47], v[108:111], a[120:123], v[32:47]
  buffer_store_dwordx4 v[124:127], v25, s[28:31], s56 offen offset:2560 sc1
  v_mfma_f32_32x32x16_bf16 v[48:63], v[108:111], a[124:127], v[48:63]
  ds_read_b128 v[108:111], v11 offset:512
  s_min_u32 s59, s54, 2322432
  s_waitcnt lgkmcnt(3)
  v_mfma_f32_32x32x16_bf16 v[32:47], v[96:99], a[128:131], v[32:47]
  v_mfma_f32_32x32x16_bf16 v[48:63], v[96:99], a[132:135], v[48:63]
  s_add_u32 m0, s49, 110592
  ds_read_b128 v[96:99], v8 offset:640
  s_waitcnt lgkmcnt(3)
  v_mfma_f32_32x32x16_bf16 v[32:47], v[100:103], a[136:139], v[32:47]
  buffer_load_dwordx4 v16, s[12:15], s59 offen lds
  v_mfma_f32_32x32x16_bf16 v[48:63], v[100:103], a[140:143], v[48:63]
  ds_read_b128 v[100:103], v9 offset:640
  s_add_u32 m0, s49, 111616
  s_waitcnt lgkmcnt(3)
  v_mfma_f32_32x32x16_bf16 v[32:47], v[104:107], a[144:147], v[32:47]
  v_mfma_f32_32x32x16_bf16 v[48:63], v[104:107], a[148:151], v[48:63]
  buffer_load_dwordx4 v17, s[12:15], s59 offen lds
  ds_read_b128 v[104:107], v10 offset:640
  s_waitcnt lgkmcnt(3)
  v_mfma_f32_32x32x16_bf16 v[32:47], v[108:111], a[152:155], v[32:47]
  s_add_u32 m0, s49, 112640
  v_mfma_f32_32x32x16_bf16 v[48:63], v[108:111], a[156:159], v[48:63]
  ds_read_b128 v[108:111], v11 offset:640
  buffer_load_dwordx4 v18, s[12:15], s59 offen lds
  s_waitcnt lgkmcnt(3)
  v_mfma_f32_32x32x16_bf16 v[32:47], v[96:99], a[160:163], v[32:47]
  v_mfma_f32_32x32x16_bf16 v[48:63], v[96:99], a[164:167], v[48:63]
  s_add_u32 m0, s49, 113664
  ds_read_b128 v[96:99], v8 offset:768
  s_waitcnt lgkmcnt(3)
  v_mfma_f32_32x32x16_bf16 v[32:47], v[100:103], a[168:171], v[32:47]
  buffer_load_dwordx4 v19, s[12:15], s59 offen lds
  v_mfma_f32_32x32x16_bf16 v[48:63], v[100:103], a[172:175], v[48:63]
  ds_read_b128 v[100:103], v9 offset:768
  s_add_u32 m0, s49, 114688
  s_waitcnt lgkmcnt(3)
  v_mfma_f32_32x32x16_bf16 v[32:47], v[104:107], a[176:179], v[32:47]
  v_mfma_f32_32x32x16_bf16 v[48:63], v[104:107], a[180:183], v[48:63]
  buffer_load_dwordx4 v20, s[12:15], s59 offen lds
  ds_read_b128 v[104:107], v10 offset:768
  s_waitcnt lgkmcnt(3)
  v_mfma_f32_32x32x16_bf16 v[32:47], v[108:111], a[184:187], v[32:47]
  s_add_u32 m0, s49, 115712
  v_mfma_f32_32x32x16_bf16 v[48:63], v[108:111], a[188:191], v[48:63]
  ds_read_b128 v[108:111], v11 offset:768
  buffer_load_dwordx4 v21, s[12:15], s59 offen lds
  s_waitcnt lgkmcnt(3)
  v_mfma_f32_32x32x16_bf16 v[32:47], v[96:99], a[192:195], v[32:47]
  v_mfma_f32_32x32x16_bf16 v[48:63], v[96:99], a[196:199], v[48:63]
  s_add_u32 m0, s49, 116736
  ds_read_b128 v[96:99], v8 offset:896
  s_waitcnt lgkmcnt(3)
  v_mfma_f32_32x32x16_bf16 v[32:47], v[100:103], a[200:203], v[32:47]
  buffer_load_dwordx4 v22, s[12:15], s59 offen lds
  v_mfma_f32_32x32x16_bf16 v[48:63], v[100:103], a[204:207], v[48:63]
  ds_read_b128 v[100:103], v9 offset:896
  s_add_u32 m0, s49, 117760
  s_waitcnt lgkmcnt(3)
  v_mfma_f32_32x32x16_bf16 v[32:47], v[104:107], a[208:211], v[32:47]
  v_mfma_f32_32x32x16_bf16 v[48:63], v[104:107], a[212:215], v[48:63]
  buffer_load_dwordx4 v23, s[12:15], s59 offen lds
  ds_read_b128 v[104:107], v10 offset:896
  s_waitcnt lgkmcnt(3)
  v_mfma_f32_32x32x16_bf16 v[32:47], v[108:111], a[216:219], v[32:47]
  s_add_u32 m0, s49, 118784
  v_mfma_f32_32x32x16_bf16 v[48:63], v[108:111], a[220:223], v[48:63]
  ds_read_b128 v[108:111], v11 offset:896
  buffer_load_dwordx4 v24, s[12:15], s59 offen lds
  s_waitcnt lgkmcnt(3)
  v_mfma_f32_32x32x16_bf16 v[32:47], v[96:99], a[224:227], v[32:47]
  v_mfma_f32_32x32x16_bf16 v[48:63], v[96:99], a[228:231], v[48:63]
  s_add_u32 s54, s54, 147456
  ds_read_b128 v[96:99], v8 offset:1024
  s_waitcnt lgkmcnt(3)
  v_mfma_f32_32x32x16_bf16 v[32:47], v[100:103], a[232:235], v[32:47]
  v_mfma_f32_32x32x16_bf16 v[48:63], v[100:103], a[236:239], v[48:63]
  ds_read_b128 v[100:103], v9 offset:1024
  s_waitcnt lgkmcnt(3)
  v_mfma_f32_32x32x16_bf16 v[32:47], v[104:107], a[240:243], v[32:47]
  v_mfma_f32_32x32x16_bf16 v[48:63], v[104:107], a[244:247], v[48:63]
  ds_read_b128 v[104:107], v10 offset:1024
  s_waitcnt lgkmcnt(3)
  v_mfma_f32_32x32x16_bf16 v[32:47], v[108:111], a[248:251], v[32:47]
  v_mfma_f32_32x32x16_bf16 v[48:63], v[108:111], a[252:255], v[48:63]
  ds_read_b128 v[108:111], v11 offset:1024
  s_waitcnt lgkmcnt(3)
  v_mfma_f32_32x32x16_bf16 v[32:47], v[96:99], v[224:227], v[32:47]
  v_mfma_f32_32x32x16_bf16 v[48:63], v[96:99], v[228:231], v[48:63]
  s_waitcnt lgkmcnt(2)
  v_mfma_f32_32x32x16_bf16 v[32:47], v[100:103], v[232:235], v[32:47]
  v_mfma_f32_32x32x16_bf16 v[48:63], v[100:103], v[236:239], v[48:63]
  s_waitcnt lgkmcnt(1)
  v_mfma_f32_32x32x16_bf16 v[32:47], v[104:107], v[240:243], v[32:47]
  v_mfma_f32_32x32x16_bf16 v[48:63], v[104:107], v[244:247], v[48:63]
  s_waitcnt lgkmcnt(0)
  v_mfma_f32_32x32x16_bf16 v[32:47], v[108:111], v[248:251], v[32:47]
  v_mfma_f32_32x32x16_bf16 v[48:63], v[108:111], v[252:255], v[48:63]
  s_mov_b32 s56, s55
  s_add_u32 s55, s55, 1048576
  s_mov_b32 s28, s20
  s_mov_b32 s29, s21
  s_mov_b32 s30, s22
  s_mov_b32 s31, s23
  s_waitcnt vmcnt(9)
  s_barrier
  s_cmp_lg_u32 s3, 0
  s_nop 2
  s_cbranch_scc1 P_sg_31
  s_lshl_b32 s60, s57, 2
  s_add_u32 s60, s60, 1
  s_cmp_lt_u32 s60, 2
  s_cbranch_scc1 P_sg_31
  s_sub_u32 s60, s60, 2
  s_lshl_b32 s60, s60, 2
  s_add_u32 s60, s60, 128
  v_mov_b32 v26, s60
  s_mov_b64 exec, 1
  s_nop 0
  buffer_atomic_add v27, v26, s[16:19], 0 offen offset:0 sc1
  s_mov_b64 exec, -1
P_sg_31:
  ds_read_b128 v[96:99], v8 offset:36864
  ds_read_b128 v[100:103], v9 offset:36864
  ds_read_b128 v[104:107], v10 offset:36864
  ds_read_b128 v[108:111], v11 offset:36864
  s_waitcnt lgkmcnt(3)
  v_mfma_f32_32x32x16_bf16 v[64:79], v[96:99], a[0:3], 0
  v_mfma_f32_32x32x16_bf16 v[80:95], v[96:99], a[4:7], 0
  ds_read_b128 v[96:99], v8 offset:36992
  s_waitcnt lgkmcnt(3)
  v_mfma_f32_32x32x16_bf16 v[64:79], v[100:103], a[8:11], v[64:79]
  v_mfma_f32_32x32x16_bf16 v[80:95], v[100:103], a[12:15], v[80:95]
  ds_read_b128 v[100:103], v9 offset:36992
  s_waitcnt lgkmcnt(3)
  v_mfma_f32_32x32x16_bf16 v[64:79], v[104:107], a[16:19], v[64:79]
  v_mfma_f32_32x32x16_bf16 v[80:95], v[104:107], a[20:23], v[80:95]
  v_cvt_pk_bf16_f32 v112, v32, v33
  ds_read_b128 v[104:107], v10 offset:36992
  s_waitcnt lgkmcnt(3)
  v_mfma_f32_32x32x16_bf16 v[64:79], v[108:111], a[24:27], v[64:79]
  v_cvt_pk_bf16_f32 v113, v34, v35
  v_mfma_f32_32x32x16_bf16 v[80:95], v[108:111], a[28:31], v[80:95]
  ds_read_b128 v[108:111], v11 offset:36992
  v_cvt_pk_bf16_f32 v114, v40, v41
  s_waitcnt lgkmcnt(3)
  v_mfma_f32_32x32x16_bf16 v[64:79], v[96:99], a[32:35], v[64:79]
  v_mfma_f32_32x32x16_bf16 v[80:95], v[96:99], a[36:39], v[80:95]
  v_cvt_pk_bf16_f32 v115, v42, v43
  ds_read_b128 v[96:99], v8 offset:37120
  s_waitcnt lgkmcnt(3)
  v_mfma_f32_32x32x16_bf16 v[64:79], v[100:103], a[40:43], v[64:79]
  v_cvt_pk_bf16_f32 v116, v36, v37
  v_mfma_f32_32x32x16_bf16 v[80:95], v[100:103], a[44:47], v[80:95]
  ds_read_b128 v[100:103], v9 offset:37120
  v_cvt_pk_bf16_f32 v117, v38, v39
  s_waitcnt lgkmcnt(3)
  v_mfma_f32_32x32x16_bf16 v[64:79], v[104:107], a[48:51], v[64:79]
  v_mfma_f32_32x32x16_bf16 v[80:95], v[104:107], a[52:55], v[80:95]
  v_cvt_pk_bf16_f32 v118, v44, v45
  ds_read_b128 v[104:107], v10 offset:37120
  s_waitcnt lgkmcnt(3)
  v_mfma_f32_32x32x16_bf16 v[64:79], v[108:111], a[56:59], v[64:79]
  v_cvt_pk_bf16_f32 v119, v46, v47
  v_mfma_f32_32x32x16_bf16 v[80:95], v[108:111], a[60:63], v[80:95]
  ds_read_b128 v[108:111], v11 offset:37120
  buffer_store_dwordx4 v[112:115], v25, s[28:31], s56 offen offset:0 sc1
  s_waitcnt lgkmcnt(3)
  v_mfma_f32_32x32x16_bf16 v[64:79], v[96:99], a[64:67], v[64:79]
  v_mfma_f32_32x32x16_bf16 v[80:95], v[96:99], a[68:71], v[80:95]
  buffer_store_dwordx4 v[116:119], v25, s[28:31], s56 offen offset:512 sc1
  ds_read_b128 v[96:99], v8 offset:37248
  s_waitcnt lgkmcnt(3)
  v_mfma_f32_32x32x16_bf16 v[64:79], v[100:103], a[72:75], v[64:79]
  v_cvt_pk_bf16_f32 v120, v48, v49
  v_mfma_f32_32x32x16_bf16 v[80:95], v[100:103], a[76:79], v[80:95]
  ds_read_b128 v[100:103], v9 offset:37248
  v_cvt_pk_bf16_f32 v121, v50, v51
  s_waitcnt lgkmcnt(3)
  v_mfma_f32_32x32x16_bf16 v[64:79], v[104:107], a[80:83], v[64:79]
  v_mfma_f32_32x32x16_bf16 v[80:95], v[104:107], a[84:87], v[80:95]
  v_cvt_pk_bf16_f32 v122, v56, v57
  ds_read_b128 v[104:107], v10 offset:37248
  s_waitcnt lgkmcnt(3)
  v_mfma_f32_32x32x16_bf16 v[64:79], v[108:111], a[88:91], v[64:79]
  v_cvt_pk_bf16_f32 v123, v58, v59
  v_mfma_f32_32x32x16_bf16 v[80:95], v[108:111], a[92:95], v[80:95]
  ds_read_b128 v[108:111], v11 offset:37248
  v_cvt_pk_bf16_f32 v124, v52, v53
  s_waitcnt lgkmcnt(3)
  v_mfma_f32_32x32x16_bf16 v[64:79], v[96:99], a[96:99], v[64:79]
  v_mfma_f32_32x32x16_bf16 v[80:95], v[96:99], a[100:103], v[80:95]
  v_cvt_pk_bf16_f32 v125, v54, v55
  ds_read_b128 v[96:99], v8 offset:37376
  s_waitcnt lgkmcnt(3)
  v_mfma_f32_32x32x16_bf16 v[64:79], v[100:103], a[104:107], v[64:79]
  v_cvt_pk_bf16_f32 v126, v60, v61
  v_mfma_f32_32x32x16_bf16 v[80:95], v[100:103], a[108:111], v[80:95]
  ds_read_b128 v[100:103], v9 offset:37376
  v_cvt_pk_bf16_f32 v127, v62, v63
  s_waitcnt lgkmcnt(3)
  v_mfma_f32_32x32x16_bf16 v[64:79], v[104:107], a[112:115], v[64:79]
  v_mfma_f32_32x32x16_bf16 v[80:95], v[104:107], a[116:119], v[80:95]
  buffer_store_dwordx4 v[120:123], v25, s[28:31], s56 offen offset:2048 sc1
  ds_read_b128 v[104:107], v10 offset:37376
  s_waitcnt lgkmcnt(3)
  v_mfma_f32_32x32x16_bf16 v[64:79], v[108:111], a[120:123], v[64:79]
  buffer_store_dwordx4 v[124:127], v25, s[28:31], s56 offen offset:2560 sc1
  v_mfma_f32_32x32x16_bf16 v[80:95], v[108:111], a[124:127], v[80:95]
  ds_read_b128 v[108:111], v11 offset:37376
  s_min_u32 s59, s54, 2322432
  s_waitcnt lgkmcnt(3)
  v_mfma_f32_32x32x16_bf16 v[64:79], v[96:99], a[128:131], v[64:79]
  v_mfma_f32_32x32x16_bf16 v[80:95], v[96:99], a[132:135], v[80:95]
  s_add_u32 m0, s49, 0
  ds_read_b128 v[96:99], v8 offset:37504
  s_waitcnt lgkmcnt(3)
  v_mfma_f32_32x32x16_bf16 v[64:79], v[100:103], a[136:139], v[64:79]
  buffer_load_dwordx4 v16, s[12:15], s59 offen lds
  v_mfma_f32_32x32x16_bf16 v[80:95], v[100:103], a[140:143], v[80:95]
  ds_read_b128 v[100:103], v9 offset:37504
  s_add_u32 m0, s49, 1024
  s_waitcnt lgkmcnt(3)
  v_mfma_f32_32x32x16_bf16 v[64:79], v[104:107], a[144:147], v[64:79]
  v_mfma_f32_32x32x16_bf16 v[80:95], v[104:107], a[148:151], v[80:95]
  buffer_load_dwordx4 v17, s[12:15], s59 offen lds
  ds_read_b128 v[104:107], v10 offset:37504
  s_waitcnt lgkmcnt(3)
  v_mfma_f32_32x32x16_bf16 v[64:79], v[108:111], a[152:155], v[64:79]
  s_add_u32 m0, s49, 2048
  v_mfma_f32_32x32x16_bf16 v[80:95], v[108:111], a[156:159], v[80:95]
  ds_read_b128 v[108:111], v11 offset:37504
  buffer_load_dwordx4 v18, s[12:15], s59 offen lds
  s_waitcnt lgkmcnt(3)
  v_mfma_f32_32x32x16_bf16 v[64:79], v[96:99], a[160:163], v[64:79]
  v_mfma_f32_32x32x16_bf16 v[80:95], v[96:99], a[164:167], v[80:95]
  s_add_u32 m0, s49, 3072
  ds_read_b128 v[96:99], v8 offset:37632
  s_waitcnt lgkmcnt(3)
  v_mfma_f32_32x32x16_bf16 v[64:79], v[100:103], a[168:171], v[64:79]
  buffer_load_dwordx4 v19, s[12:15], s59 offen lds
  v_mfma_f32_32x32x16_bf16 v[80:95], v[100:103], a[172:175], v[80:95]
  ds_read_b128 v[100:103], v9 offset:37632
  s_add_u32 m0, s49, 4096
  s_waitcnt lgkmcnt(3)
  v_mfma_f32_32x32x16_bf16 v[64:79], v[104:107], a[176:179], v[64:79]
  v_mfma_f32_32x32x16_bf16 v[80:95], v[104:107], a[180:183], v[80:95]
  buffer_load_dwordx4 v20, s[12:15], s59 offen lds
  ds_read_b128 v[104:107], v10 offset:37632
  s_waitcnt lgkmcnt(3)
  v_mfma_f32_32x32x16_bf16 v[64:79], v[108:111], a[184:187], v[64:79]
  s_add_u32 m0, s49, 5120
  v_mfma_f32_32x32x16_bf16 v[80:95], v[108:111], a[188:191], v[80:95]
  ds_read_b128 v[108:111], v11 offset:37632
  buffer_load_dwordx4 v21, s[12:15], s59 offen lds
  s_waitcnt lgkmcnt(3)
  v_mfma_f32_32x32x16_bf16 v[64:79], v[96:99], a[192:195], v[64:79]
  v_mfma_f32_32x32x16_bf16 v[80:95], v[96:99], a[196:199], v[80:95]
  s_add_u32 m0, s49, 6144
  ds_read_b128 v[96:99], v8 offset:37760
  s_waitcnt lgkmcnt(3)
  v_mfma_f32_32x32x16_bf16 v[64:79], v[100:103], a[200:203], v[64:79]
  buffer_load_dwordx4 v22, s[12:15], s59 offen lds
  v_mfma_f32_32x32x16_bf16 v[80:95], v[100:103], a[204:207], v[80:95]
  ds_read_b128 v[100:103], v9 offset:37760
  s_add_u32 m0, s49, 7168
  s_waitcnt lgkmcnt(3)
  v_mfma_f32_32x32x16_bf16 v[64:79], v[104:107], a[208:211], v[64:79]
  v_mfma_f32_32x32x16_bf16 v[80:95], v[104:107], a[212:215], v[80:95]
  buffer_load_dwordx4 v23, s[12:15], s59 offen lds
  ds_read_b128 v[104:107], v10 offset:37760
  s_waitcnt lgkmcnt(3)
  v_mfma_f32_32x32x16_bf16 v[64:79], v[108:111], a[216:219], v[64:79]
  s_add_u32 m0, s49, 8192
  v_mfma_f32_32x32x16_bf16 v[80:95], v[108:111], a[220:223], v[80:95]
  ds_read_b128 v[108:111], v11 offset:37760
  buffer_load_dwordx4 v24, s[12:15], s59 offen lds
  s_waitcnt lgkmcnt(3)
  v_mfma_f32_32x32x16_bf16 v[64:79], v[96:99], a[224:227], v[64:79]
  v_mfma_f32_32x32x16_bf16 v[80:95], v[96:99], a[228:231], v[80:95]
  s_add_u32 s54, s54, 147456
  ds_read_b128 v[96:99], v8 offset:37888
  s_waitcnt lgkmcnt(3)
  v_mfma_f32_32x32x16_bf16 v[64:79], v[100:103], a[232:235], v[64:79]
  v_mfma_f32_32x32x16_bf16 v[80:95], v[100:103], a[236:239], v[80:95]
  ds_read_b128 v[100:103], v9 offset:37888
  s_waitcnt lgkmcnt(3)
  v_mfma_f32_32x32x16_bf16 v[64:79], v[104:107], a[240:243], v[64:79]
  v_mfma_f32_32x32x16_bf16 v[80:95], v[104:107], a[244:247], v[80:95]
  ds_read_b128 v[104:107], v10 offset:37888
  s_waitcnt lgkmcnt(3)
  v_mfma_f32_32x32x16_bf16 v[64:79], v[108:111], a[248:251], v[64:79]
  v_mfma_f32_32x32x16_bf16 v[80:95], v[108:111], a[252:255], v[80:95]
  ds_read_b128 v[108:111], v11 offset:37888
  s_waitcnt lgkmcnt(3)
  v_mfma_f32_32x32x16_bf16 v[64:79], v[96:99], v[224:227], v[64:79]
  v_mfma_f32_32x32x16_bf16 v[80:95], v[96:99], v[228:231], v[80:95]
  s_waitcnt lgkmcnt(2)
  v_mfma_f32_32x32x16_bf16 v[64:79], v[100:103], v[232:235], v[64:79]
  v_mfma_f32_32x32x16_bf16 v[80:95], v[100:103], v[236:239], v[80:95]
  s_waitcnt lgkmcnt(1)
  v_mfma_f32_32x32x16_bf16 v[64:79], v[104:107], v[240:243], v[64:79]
  v_mfma_f32_32x32x16_bf16 v[80:95], v[104:107], v[244:247], v[80:95]
  s_waitcnt lgkmcnt(0)
  v_mfma_f32_32x32x16_bf16 v[64:79], v[108:111], v[248:251], v[64:79]
  v_mfma_f32_32x32x16_bf16 v[80:95], v[108:111], v[252:255], v[80:95]
  s_mov_b32 s56, s55
  s_add_u32 s55, s55, 1048576
  s_waitcnt vmcnt(9)
  s_barrier
  s_cmp_lg_u32 s3, 0
  s_nop 6
  s_cbranch_scc1 P_sg_32
  s_lshl_b32 s60, s57, 2
  s_add_u32 s60, s60, 2
  s_cmp_lt_u32 s60, 2
  s_cbranch_scc1 P_sg_32
  s_sub_u32 s60, s60, 2
  s_lshl_b32 s60, s60, 2
  s_add_u32 s60, s60, 128
  v_mov_b32 v26, s60
  s_mov_b64 exec, 1
  s_nop 0
  buffer_atomic_add v27, v26, s[16:19], 0 offen offset:0 sc1
  s_mov_b64 exec, -1
P_sg_32:
  ds_read_b128 v[96:99], v12 offset:0
  ds_read_b128 v[100:103], v13 offset:0
  ds_read_b128 v[104:107], v14 offset:0
  ds_read_b128 v[108:111], v15 offset:0
  s_waitcnt lgkmcnt(3)
  v_mfma_f32_32x32x16_bf16 v[32:47], v[96:99], a[0:3], 0
  v_mfma_f32_32x32x16_bf16 v[48:63], v[96:99], a[4:7], 0
  ds_read_b128 v[96:99], v12 offset:128
  s_waitcnt lgkmcnt(3)
  v_mfma_f32_32x32x16_bf16 v[32:47], v[100:103], a[8:11], v[32:47]
  v_mfma_f32_32x32x16_bf16 v[48:63], v[100:103], a[12:15], v[48:63]
  ds_read_b128 v[100:103], v13 offset:128
  s_waitcnt lgkmcnt(3)
  v_mfma_f32_32x32x16_bf16 v[32:47], v[104:107], a[16:19], v[32:47]
  v_mfma_f32_32x32x16_bf16 v[48:63], v[104:107], a[20:23], v[48:63]
  v_cvt_pk_bf16_f32 v112, v64, v65
  ds_read_b128 v[104:107], v14 offset:128
  s_waitcnt lgkmcnt(3)
  v_mfma_f32_32x32x16_bf16 v[32:47], v[108:111], a[24:27], v[32:47]
  v_cvt_pk_bf16_f32 v113, v66, v67
  v_mfma_f32_32x32x16_bf16 v[48:63], v[108:111], a[28:31], v[48:63]
  ds_read_b128 v[108:111], v15 offset:128
  v_cvt_pk_bf16_f32 v114, v72, v73
  s_waitcnt lgkmcnt(3)
  v_mfma_f32_32x32x16_bf16 v[32:47], v[96:99], a[32:35], v[32:47]
  v_mfma_f32_32x32x16_bf16 v[48:63], v[96:99], a[36:39], v[48:63]
  v_cvt_pk_bf16_f32 v115, v74, v75
  ds_read_b128 v[96:99], v12 offset:256
  s_waitcnt lgkmcnt(3)
  v_mfma_f32_32x32x16_bf16 v[32:47], v[100:103], a[40:43], v[32:47]
  v_cvt_pk_bf16_f32 v116, v68, v69
  v_mfma_f32_32x32x16_bf16 v[48:63], v[100:103], a[44:47], v[48:63]
  ds_read_b128 v[100:103], v13 offset:256
  v_cvt_pk_bf16_f32 v117, v70, v71
  s_waitcnt lgkmcnt(3)
  v_mfma_f32_32x32x16_bf16 v[32:47], v[104:107], a[48:51], v[32:47]
  v_mfma_f32_32x32x16_bf16 v[48:63], v[104:107], a[52:55], v[48:63]
  v_cvt_pk_bf16_f32 v118, v76, v77
  ds_read_b128 v[104:107], v14 offset:256
  s_waitcnt lgkmcnt(3)
  v_mfma_f32_32x32x16_bf16 v[32:47], v[108:111], a[56:59], v[32:47]
  v_cvt_pk_bf16_f32 v119, v78, v79
  v_mfma_f32_32x32x16_bf16 v[48:63], v[108:111], a[60:63], v[48:63]
  ds_read_b128 v[108:111], v15 offset:256
  buffer_store_dwordx4 v[112:115], v25, s[28:31], s56 offen offset:0 sc1
  s_waitcnt lgkmcnt(3)
  v_mfma_f32_32x32x16_bf16 v[32:47], v[96:99], a[64:67], v[32:47]
  v_mfma_f32_32x32x16_bf16 v[48:63], v[96:99], a[68:71], v[48:63]
  buffer_store_dwordx4 v[116:119], v25, s[28:31], s56 offen offset:512 sc1
  ds_read_b128 v[96:99], v12 offset:384
  s_waitcnt lgkmcnt(3)
  v_mfma_f32_32x32x16_bf16 v[32:47], v[100:103], a[72:75], v[32:47]
  v_cvt_pk_bf16_f32 v120, v80, v81
  v_mfma_f32_32x32x16_bf16 v[48:63], v[100:103], a[76:79], v[48:63]
  ds_read_b128 v[100:103], v13 offset:384
  v_cvt_pk_bf16_f32 v121, v82, v83
  s_waitcnt lgkmcnt(3)
  v_mfma_f32_32x32x16_bf16 v[32:47], v[104:107], a[80:83], v[32:47]
  v_mfma_f32_32x32x16_bf16 v[48:63], v[104:107], a[84:87], v[48:63]
  v_cvt_pk_bf16_f32 v122, v88, v89
  ds_read_b128 v[104:107], v14 offset:384
  s_waitcnt lgkmcnt(3)
  v_mfma_f32_32x32x16_bf16 v[32:47], v[108:111], a[88:91], v[32:47]
  v_cvt_pk_bf16_f32 v123, v90, v91
  v_mfma_f32_32x32x16_bf16 v[48:63], v[108:111], a[92:95], v[48:63]
  ds_read_b128 v[108:111], v15 offset:384
  v_cvt_pk_bf16_f32 v124, v84, v85
  s_waitcnt lgkmcnt(3)
  v_mfma_f32_32x32x16_bf16 v[32:47], v[96:99], a[96:99], v[32:47]
  v_mfma_f32_32x32x16_bf16 v[48:63], v[96:99], a[100:103], v[48:63]
  v_cvt_pk_bf16_f32 v125, v86, v87
  ds_read_b128 v[96:99], v12 offset:512
  s_waitcnt lgkmcnt(3)
  v_mfma_f32_32x32x16_bf16 v[32:47], v[100:103], a[104:107], v[32:47]
  v_cvt_pk_bf16_f32 v126, v92, v93
  v_mfma_f32_32x32x16_bf16 v[48:63], v[100:103], a[108:111], v[48:63]
  ds_read_b128 v[100:103], v13 offset:512
  v_cvt_pk_bf16_f32 v127, v94, v95
  s_waitcnt lgkmcnt(3)
  v_mfma_f32_32x32x16_bf16 v[32:47], v[104:107], a[112:115], v[32:47]
  v_mfma_f32_32x32x16_bf16 v[48:63], v[104:107], a[116:119], v[48:63]
  buffer_store_dwordx4 v[120:123], v25, s[28:31], s56 offen offset:2048 sc1
  ds_read_b128 v[104:107], v14 offset:512
  s_waitcnt lgkmcnt(3)
  v_mfma_f32_32x32x16_bf16 v[32:47], v[108:111], a[120:123], v[32:47]
  buffer_store_dwordx4 v[124:127], v25, s[28:31], s56 offen offset:2560 sc1
  v_mfma_f32_32x32x16_bf16 v[48:63], v[108:111], a[124:127], v[48:63]
  ds_read_b128 v[108:111], v15 offset:512
  s_min_u32 s59, s54, 2322432
  s_waitcnt lgkmcnt(3)
  v_mfma_f32_32x32x16_bf16 v[32:47], v[96:99], a[128:131], v[32:47]
  v_mfma_f32_32x32x16_bf16 v[48:63], v[96:99], a[132:135], v[48:63]
  s_add_u32 m0, s49, 36864
  ds_read_b128 v[96:99], v12 offset:640
  s_waitcnt lgkmcnt(3)
  v_mfma_f32_32x32x16_bf16 v[32:47], v[100:103], a[136:139], v[32:47]
  buffer_load_dwordx4 v16, s[12:15], s59 offen lds
  v_mfma_f32_32x32x16_bf16 v[48:63], v[100:103], a[140:143], v[48:63]
  ds_read_b128 v[100:103], v13 offset:640
  s_add_u32 m0, s49, 37888
  s_waitcnt lgkmcnt(3)
  v_mfma_f32_32x32x16_bf16 v[32:47], v[104:107], a[144:147], v[32:47]
  v_mfma_f32_32x32x16_bf16 v[48:63], v[104:107], a[148:151], v[48:63]
  buffer_load_dwordx4 v17, s[12:15], s59 offen lds
  ds_read_b128 v[104:107], v14 offset:640
  s_waitcnt lgkmcnt(3)
  v_mfma_f32_32x32x16_bf16 v[32:47], v[108:111], a[152:155], v[32:47]
  s_add_u32 m0, s49, 38912
  v_mfma_f32_32x32x16_bf16 v[48:63], v[108:111], a[156:159], v[48:63]
  ds_read_b128 v[108:111], v15 offset:640
  buffer_load_dwordx4 v18, s[12:15], s59 offen lds
  s_waitcnt lgkmcnt(3)
  v_mfma_f32_32x32x16_bf16 v[32:47], v[96:99], a[160:163], v[32:47]
  v_mfma_f32_32x32x16_bf16 v[48:63], v[96:99], a[164:167], v[48:63]
  s_add_u32 m0, s49, 39936
  ds_read_b128 v[96:99], v12 offset:768
  s_waitcnt lgkmcnt(3)
  v_mfma_f32_32x32x16_bf16 v[32:47], v[100:103], a[168:171], v[32:47]
  buffer_load_dwordx4 v19, s[12:15], s59 offen lds
  v_mfma_f32_32x32x16_bf16 v[48:63], v[100:103], a[172:175], v[48:63]
  ds_read_b128 v[100:103], v13 offset:768
  s_add_u32 m0, s49, 40960
  s_waitcnt lgkmcnt(3)
  v_mfma_f32_32x32x16_bf16 v[32:47], v[104:107], a[176:179], v[32:47]
  v_mfma_f32_32x32x16_bf16 v[48:63], v[104:107], a[180:183], v[48:63]
  buffer_load_dwordx4 v20, s[12:15], s59 offen lds
  ds_read_b128 v[104:107], v14 offset:768
  s_waitcnt lgkmcnt(3)
  v_mfma_f32_32x32x16_bf16 v[32:47], v[108:111], a[184:187], v[32:47]
  s_add_u32 m0, s49, 41984
  v_mfma_f32_32x32x16_bf16 v[48:63], v[108:111], a[188:191], v[48:63]
  ds_read_b128 v[108:111], v15 offset:768
  buffer_load_dwordx4 v21, s[12:15], s59 offen lds
  s_waitcnt lgkmcnt(3)
  v_mfma_f32_32x32x16_bf16 v[32:47], v[96:99], a[192:195], v[32:47]
  v_mfma_f32_32x32x16_bf16 v[48:63], v[96:99], a[196:199], v[48:63]
  s_add_u32 m0, s49, 43008
  ds_read_b128 v[96:99], v12 offset:896
  s_waitcnt lgkmcnt(3)
  v_mfma_f32_32x32x16_bf16 v[32:47], v[100:103], a[200:203], v[32:47]
  buffer_load_dwordx4 v22, s[12:15], s59 offen lds
  v_mfma_f32_32x32x16_bf16 v[48:63], v[100:103], a[204:207], v[48:63]
  ds_read_b128 v[100:103], v13 offset:896
  s_add_u32 m0, s49, 44032
  s_waitcnt lgkmcnt(3)
  v_mfma_f32_32x32x16_bf16 v[32:47], v[104:107], a[208:211], v[32:47]
  v_mfma_f32_32x32x16_bf16 v[48:63], v[104:107], a[212:215], v[48:63]
  buffer_load_dwordx4 v23, s[12:15], s59 offen lds
  ds_read_b128 v[104:107], v14 offset:896
  s_waitcnt lgkmcnt(3)
  v_mfma_f32_32x32x16_bf16 v[32:47], v[108:111], a[216:219], v[32:47]
  s_add_u32 m0, s49, 45056
  v_mfma_f32_32x32x16_bf16 v[48:63], v[108:111], a[220:223], v[48:63]
  ds_read_b128 v[108:111], v15 offset:896
  buffer_load_dwordx4 v24, s[12:15], s59 offen lds
  s_waitcnt lgkmcnt(3)
  v_mfma_f32_32x32x16_bf16 v[32:47], v[96:99], a[224:227], v[32:47]
  v_mfma_f32_32x32x16_bf16 v[48:63], v[96:99], a[228:231], v[48:63]
  s_add_u32 s54, s54, 147456
  ds_read_b128 v[96:99], v12 offset:1024
  s_waitcnt lgkmcnt(3)
  v_mfma_f32_32x32x16_bf16 v[32:47], v[100:103], a[232:235], v[32:47]
  v_mfma_f32_32x32x16_bf16 v[48:63], v[100:103], a[236:239], v[48:63]
  ds_read_b128 v[100:103], v13 offset:1024
  s_waitcnt lgkmcnt(3)
  v_mfma_f32_32x32x16_bf16 v[32:47], v[104:107], a[240:243], v[32:47]
  v_mfma_f32_32x32x16_bf16 v[48:63], v[104:107], a[244:247], v[48:63]
  ds_read_b128 v[104:107], v14 offset:1024
  s_waitcnt lgkmcnt(3)
  v_mfma_f32_32x32x16_bf16 v[32:47], v[108:111], a[248:251], v[32:47]
  v_mfma_f32_32x32x16_bf16 v[48:63], v[108:111], a[252:255], v[48:63]
  ds_read_b128 v[108:111], v15 offset:1024
  s_waitcnt lgkmcnt(3)
  v_mfma_f32_32x32x16_bf16 v[32:47], v[96:99], v[224:227], v[32:47]
  v_mfma_f32_32x32x16_bf16 v[48:63], v[96:99], v[228:231], v[48:63]
  s_waitcnt lgkmcnt(2)
  v_mfma_f32_32x32x16_bf16 v[32:47], v[100:103], v[232:235], v[32:47]
  v_mfma_f32_32x32x16_bf16 v[48:63], v[100:103], v[236:239], v[48:63]
  s_waitcnt lgkmcnt(1)
  v_mfma_f32_32x32x16_bf16 v[32:47], v[104:107], v[240:243], v[32:47]
  v_mfma_f32_32x32x16_bf16 v[48:63], v[104:107], v[244:247], v[48:63]
  s_waitcnt lgkmcnt(0)
  v_mfma_f32_32x32x16_bf16 v[32:47], v[108:111], v[248:251], v[32:47]
  v_mfma_f32_32x32x16_bf16 v[48:63], v[108:111], v[252:255], v[48:63]
  s_mov_b32 s56, s55
  s_add_u32 s55, s55, 1048576
  s_waitcnt vmcnt(9)
  s_barrier
  s_cmp_lg_u32 s3, 0
  s_nop 6
  s_cbranch_scc1 P_sg_33
  s_lshl_b32 s60, s57, 2
  s_add_u32 s60, s60, 3
  s_cmp_lt_u32 s60, 2
  s_cbranch_scc1 P_sg_33
  s_sub_u32 s60, s60, 2
  s_lshl_b32 s60, s60, 2
  s_add_u32 s60, s60, 128
  v_mov_b32 v26, s60
  s_mov_b64 exec, 1
  s_nop 0
  buffer_atomic_add v27, v26, s[16:19], 0 offen offset:0 sc1
  s_mov_b64 exec, -1
P_sg_33:
  ds_read_b128 v[96:99], v12 offset:36864
  ds_read_b128 v[100:103], v13 offset:36864
  ds_read_b128 v[104:107], v14 offset:36864
  ds_read_b128 v[108:111], v15 offset:36864
  s_waitcnt lgkmcnt(3)
  v_mfma_f32_32x32x16_bf16 v[64:79], v[96:99], a[0:3], 0
  v_mfma_f32_32x32x16_bf16 v[80:95], v[96:99], a[4:7], 0
  ds_read_b128 v[96:99], v12 offset:36992
  s_waitcnt lgkmcnt(3)
  v_mfma_f32_32x32x16_bf16 v[64:79], v[100:103], a[8:11], v[64:79]
  v_mfma_f32_32x32x16_bf16 v[80:95], v[100:103], a[12:15], v[80:95]
  ds_read_b128 v[100:103], v13 offset:36992
  s_waitcnt lgkmcnt(3)
  v_mfma_f32_32x32x16_bf16 v[64:79], v[104:107], a[16:19], v[64:79]
  v_mfma_f32_32x32x16_bf16 v[80:95], v[104:107], a[20:23], v[80:95]
  v_cvt_pk_bf16_f32 v112, v32, v33
  ds_read_b128 v[104:107], v14 offset:36992
  s_waitcnt lgkmcnt(3)
  v_mfma_f32_32x32x16_bf16 v[64:79], v[108:111], a[24:27], v[64:79]
  v_cvt_pk_bf16_f32 v113, v34, v35
  v_mfma_f32_32x32x16_bf16 v[80:95], v[108:111], a[28:31], v[80:95]
  ds_read_b128 v[108:111], v15 offset:36992
  v_cvt_pk_bf16_f32 v114, v40, v41
  s_waitcnt lgkmcnt(3)
  v_mfma_f32_32x32x16_bf16 v[64:79], v[96:99], a[32:35], v[64:79]
  v_mfma_f32_32x32x16_bf16 v[80:95], v[96:99], a[36:39], v[80:95]
  v_cvt_pk_bf16_f32 v115, v42, v43
  ds_read_b128 v[96:99], v12 offset:37120
  s_waitcnt lgkmcnt(3)
  v_mfma_f32_32x32x16_bf16 v[64:79], v[100:103], a[40:43], v[64:79]
  v_cvt_pk_bf16_f32 v116, v36, v37
  v_mfma_f32_32x32x16_bf16 v[80:95], v[100:103], a[44:47], v[80:95]
  ds_read_b128 v[100:103], v13 offset:37120
  v_cvt_pk_bf16_f32 v117, v38, v39
  s_waitcnt lgkmcnt(3)
  v_mfma_f32_32x32x16_bf16 v[64:79], v[104:107], a[48:51], v[64:79]
  v_mfma_f32_32x32x16_bf16 v[80:95], v[104:107], a[52:55], v[80:95]
  v_cvt_pk_bf16_f32 v118, v44, v45
  ds_read_b128 v[104:107], v14 offset:37120
  s_waitcnt lgkmcnt(3)
  v_mfma_f32_32x32x16_bf16 v[64:79], v[108:111], a[56:59], v[64:79]
  v_cvt_pk_bf16_f32 v119, v46, v47
  v_mfma_f32_32x32x16_bf16 v[80:95], v[108:111], a[60:63], v[80:95]
  ds_read_b128 v[108:111], v15 offset:37120
  buffer_store_dwordx4 v[112:115], v25, s[28:31], s56 offen offset:0 sc1
  s_waitcnt lgkmcnt(3)
  v_mfma_f32_32x32x16_bf16 v[64:79], v[96:99], a[64:67], v[64:79]
  v_mfma_f32_32x32x16_bf16 v[80:95], v[96:99], a[68:71], v[80:95]
  buffer_store_dwordx4 v[116:119], v25, s[28:31], s56 offen offset:512 sc1
  ds_read_b128 v[96:99], v12 offset:37248
  s_waitcnt lgkmcnt(3)
  v_mfma_f32_32x32x16_bf16 v[64:79], v[100:103], a[72:75], v[64:79]
  v_cvt_pk_bf16_f32 v120, v48, v49
  v_mfma_f32_32x32x16_bf16 v[80:95], v[100:103], a[76:79], v[80:95]
  ds_read_b128 v[100:103], v13 offset:37248
  v_cvt_pk_bf16_f32 v121, v50, v51
  s_waitcnt lgkmcnt(3)
  v_mfma_f32_32x32x16_bf16 v[64:79], v[104:107], a[80:83], v[64:79]
  v_mfma_f32_32x32x16_bf16 v[80:95], v[104:107], a[84:87], v[80:95]
  v_cvt_pk_bf16_f32 v122, v56, v57
  ds_read_b128 v[104:107], v14 offset:37248
  s_waitcnt lgkmcnt(3)
  v_mfma_f32_32x32x16_bf16 v[64:79], v[108:111], a[88:91], v[64:79]
  v_cvt_pk_bf16_f32 v123, v58, v59
  v_mfma_f32_32x32x16_bf16 v[80:95], v[108:111], a[92:95], v[80:95]
  ds_read_b128 v[108:111], v15 offset:37248
  v_cvt_pk_bf16_f32 v124, v52, v53
  s_waitcnt lgkmcnt(3)
  v_mfma_f32_32x32x16_bf16 v[64:79], v[96:99], a[96:99], v[64:79]
  v_mfma_f32_32x32x16_bf16 v[80:95], v[96:99], a[100:103], v[80:95]
  v_cvt_pk_bf16_f32 v125, v54, v55
  ds_read_b128 v[96:99], v12 offset:37376
  s_waitcnt lgkmcnt(3)
  v_mfma_f32_32x32x16_bf16 v[64:79], v[100:103], a[104:107], v[64:79]
  v_cvt_pk_bf16_f32 v126, v60, v61
  v_mfma_f32_32x32x16_bf16 v[80:95], v[100:103], a[108:111], v[80:95]
  ds_read_b128 v[100:103], v13 offset:37376
  v_cvt_pk_bf16_f32 v127, v62, v63
  s_waitcnt lgkmcnt(3)
  v_mfma_f32_32x32x16_bf16 v[64:79], v[104:107], a[112:115], v[64:79]
  v_mfma_f32_32x32x16_bf16 v[80:95], v[104:107], a[116:119], v[80:95]
  buffer_store_dwordx4 v[120:123], v25, s[28:31], s56 offen offset:2048 sc1
  ds_read_b128 v[104:107], v14 offset:37376
  s_waitcnt lgkmcnt(3)
  v_mfma_f32_32x32x16_bf16 v[64:79], v[108:111], a[120:123], v[64:79]
  buffer_store_dwordx4 v[124:127], v25, s[28:31], s56 offen offset:2560 sc1
  v_mfma_f32_32x32x16_bf16 v[80:95], v[108:111], a[124:127], v[80:95]
  ds_read_b128 v[108:111], v15 offset:37376
  s_min_u32 s59, s54, 2322432
  s_waitcnt lgkmcnt(3)
  v_mfma_f32_32x32x16_bf16 v[64:79], v[96:99], a[128:131], v[64:79]
  v_mfma_f32_32x32x16_bf16 v[80:95], v[96:99], a[132:135], v[80:95]
  s_add_u32 m0, s49, 73728
  ds_read_b128 v[96:99], v12 offset:37504
  s_waitcnt lgkmcnt(3)
  v_mfma_f32_32x32x16_bf16 v[64:79], v[100:103], a[136:139], v[64:79]
  buffer_load_dwordx4 v16, s[12:15], s59 offen lds
  v_mfma_f32_32x32x16_bf16 v[80:95], v[100:103], a[140:143], v[80:95]
  ds_read_b128 v[100:103], v13 offset:37504
  s_add_u32 m0, s49, 74752
  s_waitcnt lgkmcnt(3)
  v_mfma_f32_32x32x16_bf16 v[64:79], v[104:107], a[144:147], v[64:79]
  v_mfma_f32_32x32x16_bf16 v[80:95], v[104:107], a[148:151], v[80:95]
  buffer_load_dwordx4 v17, s[12:15], s59 offen lds
  ds_read_b128 v[104:107], v14 offset:37504
  s_waitcnt lgkmcnt(3)
  v_mfma_f32_32x32x16_bf16 v[64:79], v[108:111], a[152:155], v[64:79]
  s_add_u32 m0, s49, 75776
  v_mfma_f32_32x32x16_bf16 v[80:95], v[108:111], a[156:159], v[80:95]
  ds_read_b128 v[108:111], v15 offset:37504
  buffer_load_dwordx4 v18, s[12:15], s59 offen lds
  s_waitcnt lgkmcnt(3)
  v_mfma_f32_32x32x16_bf16 v[64:79], v[96:99], a[160:163], v[64:79]
  v_mfma_f32_32x32x16_bf16 v[80:95], v[96:99], a[164:167], v[80:95]
  s_add_u32 m0, s49, 76800
  ds_read_b128 v[96:99], v12 offset:37632
  s_waitcnt lgkmcnt(3)
  v_mfma_f32_32x32x16_bf16 v[64:79], v[100:103], a[168:171], v[64:79]
  buffer_load_dwordx4 v19, s[12:15], s59 offen lds
  v_mfma_f32_32x32x16_bf16 v[80:95], v[100:103], a[172:175], v[80:95]
  ds_read_b128 v[100:103], v13 offset:37632
  s_add_u32 m0, s49, 77824
  s_waitcnt lgkmcnt(3)
  v_mfma_f32_32x32x16_bf16 v[64:79], v[104:107], a[176:179], v[64:79]
  v_mfma_f32_32x32x16_bf16 v[80:95], v[104:107], a[180:183], v[80:95]
  buffer_load_dwordx4 v20, s[12:15], s59 offen lds
  ds_read_b128 v[104:107], v14 offset:37632
  s_waitcnt lgkmcnt(3)
  v_mfma_f32_32x32x16_bf16 v[64:79], v[108:111], a[184:187], v[64:79]
  s_add_u32 m0, s49, 78848
  v_mfma_f32_32x32x16_bf16 v[80:95], v[108:111], a[188:191], v[80:95]
  ds_read_b128 v[108:111], v15 offset:37632
  buffer_load_dwordx4 v21, s[12:15], s59 offen lds
  s_waitcnt lgkmcnt(3)
  v_mfma_f32_32x32x16_bf16 v[64:79], v[96:99], a[192:195], v[64:79]
  v_mfma_f32_32x32x16_bf16 v[80:95], v[96:99], a[196:199], v[80:95]
  s_add_u32 m0, s49, 79872
  ds_read_b128 v[96:99], v12 offset:37760
  s_waitcnt lgkmcnt(3)
  v_mfma_f32_32x32x16_bf16 v[64:79], v[100:103], a[200:203], v[64:79]
  buffer_load_dwordx4 v22, s[12:15], s59 offen lds
  v_mfma_f32_32x32x16_bf16 v[80:95], v[100:103], a[204:207], v[80:95]
  ds_read_b128 v[100:103], v13 offset:37760
  s_add_u32 m0, s49, 80896
  s_waitcnt lgkmcnt(3)
  v_mfma_f32_32x32x16_bf16 v[64:79], v[104:107], a[208:211], v[64:79]
  v_mfma_f32_32x32x16_bf16 v[80:95], v[104:107], a[212:215], v[80:95]
  buffer_load_dwordx4 v23, s[12:15], s59 offen lds
  ds_read_b128 v[104:107], v14 offset:37760
  s_waitcnt lgkmcnt(3)
  v_mfma_f32_32x32x16_bf16 v[64:79], v[108:111], a[216:219], v[64:79]
  s_add_u32 m0, s49, 81920
  v_mfma_f32_32x32x16_bf16 v[80:95], v[108:111], a[220:223], v[80:95]
  ds_read_b128 v[108:111], v15 offset:37760
  buffer_load_dwordx4 v24, s[12:15], s59 offen lds
  s_waitcnt lgkmcnt(3)
  v_mfma_f32_32x32x16_bf16 v[64:79], v[96:99], a[224:227], v[64:79]
  v_mfma_f32_32x32x16_bf16 v[80:95], v[96:99], a[228:231], v[80:95]
  s_add_u32 s54, s54, 147456
  ds_read_b128 v[96:99], v12 offset:37888
  s_waitcnt lgkmcnt(3)
  v_mfma_f32_32x32x16_bf16 v[64:79], v[100:103], a[232:235], v[64:79]
  v_mfma_f32_32x32x16_bf16 v[80:95], v[100:103], a[236:239], v[80:95]
  ds_read_b128 v[100:103], v13 offset:37888
  s_waitcnt lgkmcnt(3)
  v_mfma_f32_32x32x16_bf16 v[64:79], v[104:107], a[240:243], v[64:79]
  v_mfma_f32_32x32x16_bf16 v[80:95], v[104:107], a[244:247], v[80:95]
  ds_read_b128 v[104:107], v14 offset:37888
  s_waitcnt lgkmcnt(3)
  v_mfma_f32_32x32x16_bf16 v[64:79], v[108:111], a[248:251], v[64:79]
  v_mfma_f32_32x32x16_bf16 v[80:95], v[108:111], a[252:255], v[80:95]
  ds_read_b128 v[108:111], v15 offset:37888
  s_waitcnt lgkmcnt(3)
  v_mfma_f32_32x32x16_bf16 v[64:79], v[96:99], v[224:227], v[64:79]
  v_mfma_f32_32x32x16_bf16 v[80:95], v[96:99], v[228:231], v[80:95]
  s_waitcnt lgkmcnt(2)
  v_mfma_f32_32x32x16_bf16 v[64:79], v[100:103], v[232:235], v[64:79]
  v_mfma_f32_32x32x16_bf16 v[80:95], v[100:103], v[236:239], v[80:95]
  s_waitcnt lgkmcnt(1)
  v_mfma_f32_32x32x16_bf16 v[64:79], v[104:107], v[240:243], v[64:79]
  v_mfma_f32_32x32x16_bf16 v[80:95], v[104:107], v[244:247], v[80:95]
  s_waitcnt lgkmcnt(0)
  v_mfma_f32_32x32x16_bf16 v[64:79], v[108:111], v[248:251], v[64:79]
  v_mfma_f32_32x32x16_bf16 v[80:95], v[108:111], v[252:255], v[80:95]
  s_mov_b32 s56, s55
  s_add_u32 s55, s55, 1048576
  s_add_u32 s57, s57, 1
  s_cmp_lt_u32 s57, 4
  s_nop 7
  s_cbranch_scc1 P_LV_29
  v_cvt_pk_bf16_f32 v112, v64, v65
  v_cvt_pk_bf16_f32 v113, v66, v67
  v_cvt_pk_bf16_f32 v114, v72, v73
  v_cvt_pk_bf16_f32 v115, v74, v75
  v_cvt_pk_bf16_f32 v116, v68, v69
  v_cvt_pk_bf16_f32 v117, v70, v71
  v_cvt_pk_bf16_f32 v118, v76, v77
  v_cvt_pk_bf16_f32 v119, v78, v79
  buffer_store_dwordx4 v[112:115], v25, s[28:31], s56 offen offset:0 sc1
  buffer_store_dwordx4 v[116:119], v25, s[28:31], s56 offen offset:512 sc1
  v_cvt_pk_bf16_f32 v120, v80, v81
  v_cvt_pk_bf16_f32 v121, v82, v83
  v_cvt_pk_bf16_f32 v122, v88, v89
  v_cvt_pk_bf16_f32 v123, v90, v91
  v_cvt_pk_bf16_f32 v124, v84, v85
  v_cvt_pk_bf16_f32 v125, v86, v87
  v_cvt_pk_bf16_f32 v126, v92, v93
  v_cvt_pk_bf16_f32 v127, v94, v95
  buffer_store_dwordx4 v[120:123], v25, s[28:31], s56 offen offset:2048 sc1
  buffer_store_dwordx4 v[124:127], v25, s[28:31], s56 offen offset:2560 sc1
  s_waitcnt vmcnt(0)
  s_barrier
  s_cmp_lg_u32 s3, 0
  s_cbranch_scc1 P_sg_34
  s_mov_b32 s60, 14
  s_lshl_b32 s60, s60, 2
  s_add_u32 s60, s60, 128
  v_mov_b32 v26, s60
  s_mov_b64 exec, 1
  s_nop 0
  buffer_atomic_add v27, v26, s[16:19], 0 offen offset:0 sc1
  buffer_atomic_add v27, v26, s[16:19], 0 offen offset:4 sc1
  s_mov_b64 exec, -1
P_sg_34:
  s_waitcnt vmcnt(0)
P_E_22:
  s_branch WK_S
WK_T:
  s_sub_u32 s40, s40, 192
  s_load_dwordx2 s[4:5], s[0:1], 40
  s_load_dwordx2 s[8:9], s[0:1], 144
  s_waitcnt lgkmcnt(0)
  s_mov_b32 s12, s4
  s_mov_b32 s13, s5
  s_mov_b32 s14, 4718592
  s_mov_b32 s15, 0x00020000
  s_add_u32 s16, s8, 0x5000000
  s_addc_u32 s17, s9, 0
  s_mov_b32 s18, 0x480000
  s_mov_b32 s19, 0x00020000
  v_and_b32 v3, 63, v0
  v_lshlrev_b32 v1, 4, v3
  s_lshl_b32 s41, s40, 2
  s_add_u32 s41, s41, s3
  s_mul_i32 s42, s41, 36864
  s_mul_i32 s43, s3, 36864
  s_add_u32 m0, s43, 0
  s_add_u32 s44, s42, 0
  buffer_load_dwordx4 v1, s[12:15], s44 offen lds
  s_add_u32 m0, s43, 1024
  s_add_u32 s44, s42, 1024
  buffer_load_dwordx4 v1, s[12:15], s44 offen lds
  s_add_u32 m0, s43, 2048
  s_add_u32 s44, s42, 2048
  buffer_load_dwordx4 v1, s[12:15], s44 offen lds
  s_add_u32 m0, s43, 3072
  s_add_u32 s44, s42, 3072
  buffer_load_dwordx4 v1, s[12:15], s44 offen lds
  s_add_u32 m0, s43, 4096
  s_add_u32 s44, s42, 4096
  buffer_load_dwordx4 v1, s[12:15], s44 offen lds
  s_add_u32 m0, s43, 5120
  s_add_u32 s44, s42, 5120
  buffer_load_dwordx4 v1, s[12:15], s44 offen lds
  s_add_u32 m0, s43, 6144
  s_add_u32 s44, s42, 6144
  buffer_load_dwordx4 v1, s[12:15], s44 offen lds
  s_add_u32 m0, s43, 7168
  s_add_u32 s44, s42, 7168
  buffer_load_dwordx4 v1, s[12:15], s44 offen lds
  s_add_u32 m0, s43, 8192
  s_add_u32 s44, s42, 8192
  buffer_load_dwordx4 v1, s[12:15], s44 offen lds
  s_add_u32 m0, s43, 9216
  s_add_u32 s44, s42, 9216
  buffer_load_dwordx4 v1, s[12:15], s44 offen lds
  s_add_u32 m0, s43, 10240
  s_add_u32 s44, s42, 10240
  buffer_load_dwordx4 v1, s[12:15], s44 offen lds
  s_add_u32 m0, s43, 11264
  s_add_u32 s44, s42, 11264
  buffer_load_dwordx4 v1, s[12:15], s44 offen lds
  s_add_u32 m0, s43, 12288
  s_add_u32 s44, s42, 12288
  buffer_load_dwordx4 v1, s[12:15], s44 offen lds
  s_add_u32 m0, s43, 13312
  s_add_u32 s44, s42, 13312
  buffer_load_dwordx4 v1, s[12:15], s44 offen lds
  s_add_u32 m0, s43, 14336
  s_add_u32 s44, s42, 14336
  buffer_load_dwordx4 v1, s[12:15], s44 offen lds
  s_add_u32 m0, s43, 15360
  s_add_u32 s44, s42, 15360
  buffer_load_dwordx4 v1, s[12:15], s44 offen lds
  s_add_u32 m0, s43, 16384
  s_add_u32 s44, s42, 16384
  buffer_load_dwordx4 v1, s[12:15], s44 offen lds
  s_add_u32 m0, s43, 17408
  s_add_u32 s44, s42, 17408
  buffer_load_dwordx4 v1, s[12:15], s44 offen lds
  s_add_u32 m0, s43, 18432
  s_add_u32 s44, s42, 18432
  buffer_load_dwordx4 v1, s[12:15], s44 offen lds
  s_add_u32 m0, s43, 19456
  s_add_u32 s44, s42, 19456
  buffer_load_dwordx4 v1, s[12:15], s44 offen lds
  s_add_u32 m0, s43, 20480
  s_add_u32 s44, s42, 20480
  buffer_load_dwordx4 v1, s[12:15], s44 offen lds
  s_add_u32 m0, s43, 21504
  s_add_u32 s44, s42, 21504
  buffer_load_dwordx4 v1, s[12:15], s44 offen lds
  s_add_u32 m0, s43, 22528
  s_add_u32 s44, s42, 22528
  buffer_load_dwordx4 v1, s[12:15], s44 offen lds
  s_add_u32 m0, s43, 23552
  s_add_u32 s44, s42, 23552
  buffer_load_dwordx4 v1, s[12:15], s44 offen lds
  s_add_u32 m0, s43, 24576
  s_add_u32 s44, s42, 24576
  buffer_load_dwordx4 v1, s[12:15], s44 offen lds
  s_add_u32 m0, s43, 25600
  s_add_u32 s44, s42, 25600
  buffer_load_dwordx4 v1, s[12:15], s44 offen lds
  s_add_u32 m0, s43, 26624
  s_add_u32 s44, s42, 26624
  buffer_load_dwordx4 v1, s[12:15], s44 offen lds
  s_add_u32 m0, s43, 27648
  s_add_u32 s44, s42, 27648
  buffer_load_dwordx4 v1, s[12:15], s44 offen lds
  s_add_u32 m0, s43, 28672
  s_add_u32 s44, s42, 28672
  buffer_load_dwordx4 v1, s[12:15], s44 offen lds
  s_add_u32 m0, s43, 29696
  s_add_u32 s44, s42, 29696
  buffer_load_dwordx4 v1, s[12:15], s44 offen lds
  s_add_u32 m0, s43, 30720
  s_add_u32 s44, s42, 30720
  buffer_load_dwordx4 v1, s[12:15], s44 offen lds
  s_add_u32 m0, s43, 31744
  s_add_u32 s44, s42, 31744
  buffer_load_dwordx4 v1, s[12:15], s44 offen lds
  s_add_u32 m0, s43, 32768
  s_add_u32 s44, s42, 32768
  buffer_load_dwordx4 v1, s[12:15], s44 offen lds
  s_add_u32 m0, s43, 33792
  s_add_u32 s44, s42, 33792
  buffer_load_dwordx4 v1, s[12:15], s44 offen lds
  s_add_u32 m0, s43, 34816
  s_add_u32 s44, s42, 34816
  buffer_load_dwordx4 v1, s[12:15], s44 offen lds
  s_add_u32 m0, s43, 35840
  s_add_u32 s44, s42, 35840
  buffer_load_dwordx4 v1, s[12:15], s44 offen lds
  v_and_b32 v4, 15, v3
  v_lshrrev_b32 v4, 2, v4
  v_lshrrev_b32 v5, 5, v3
  v_lshlrev_b32 v5, 2, v5
  v_add_u32 v4, v4, v5
  v_mul_u32_u24 v4, 1152, v4
  v_lshrrev_b32 v5, 4, v3
  v_and_b32 v5, 1, v5
  v_lshlrev_b32 v5, 5, v5
  v_and_b32 v6, 3, v3
  v_lshlrev_b32 v6, 3, v6
  v_add_u32 v4, v4, v5
  v_add_u32 v4, v4, v6
  v_add_u32 v4, s43, v4
  s_lshl_b32 s45, s41, 11
  s_waitcnt vmcnt(0)
  ds_read_b64_tr_b16 v[16:17], v4 offset:0
  ds_read_b64_tr_b16 v[18:19], v4 offset:18432
  s_add_u32 s46, s45, 0
  s_waitcnt lgkmcnt(0)
  buffer_store_dwordx4 v[16:19], v1, s[16:19], s46 offen sc1
  ds_read_b64_tr_b16 v[20:21], v4 offset:9216
  ds_read_b64_tr_b16 v[22:23], v4 offset:27648
  s_add_u32 s46, s45, 1024
  s_waitcnt lgkmcnt(0)
  buffer_store_dwordx4 v[20:23], v1, s[16:19], s46 offen sc1
  ds_read_b64_tr_b16 v[24:25], v4 offset:64
  ds_read_b64_tr_b16 v[26:27], v4 offset:18496
  s_add_u32 s46, s45, 262144
  s_waitcnt lgkmcnt(0)
  buffer_store_dwordx4 v[24:27], v1, s[16:19], s46 offen sc1
  ds_read_b64_tr_b16 v[28:29], v4 offset:9280
  ds_read_b64_tr_b16 v[30:31], v4 offset:27712
  s_add_u32 s46, s45, 263168
  s_waitcnt lgkmcnt(0)
  buffer_store_dwordx4 v[28:31], v1, s[16:19], s46 offen sc1
  ds_read_b64_tr_b16 v[32:33], v4 offset:128
  ds_read_b64_tr_b16 v[34:35], v4 offset:18560
  s_add_u32 s46, s45, 524288
  s_waitcnt lgkmcnt(0)
  buffer_store_dwordx4 v[32:35], v1, s[16:19], s46 offen sc1
  ds_read_b64_tr_b16 v[36:37], v4 offset:9344
  ds_read_b64_tr_b16 v[38:39], v4 offset:27776
  s_add_u32 s46, s45, 525312
  s_waitcnt lgkmcnt(0)
  buffer_store_dwordx4 v[36:39], v1, s[16:19], s46 offen sc1
  ds_read_b64_tr_b16 v[40:41], v4 offset:192
  ds_read_b64_tr_b16 v[42:43], v4 offset:18624
  s_add_u32 s46, s45, 786432
  s_waitcnt lgkmcnt(0)
  buffer_store_dwordx4 v[40:43], v1, s[16:19], s46 offen sc1
  ds_read_b64_tr_b16 v[44:45], v4 offset:9408
  ds_read_b64_tr_b16 v[46:47], v4 offset:27840
  s_add_u32 s46, s45, 787456
  s_waitcnt lgkmcnt(0)
  buffer_store_dwordx4 v[44:47], v1, s[16:19], s46 offen sc1
  ds_read_b64_tr_b16 v[16:17], v4 offset:256
  ds_read_b64_tr_b16 v[18:19], v4 offset:18688
  s_add_u32 s46, s45, 1048576
  s_waitcnt lgkmcnt(0)
  buffer_store_dwordx4 v[16:19], v1, s[16:19], s46 offen sc1
  ds_read_b64_tr_b16 v[20:21], v4 offset:9472
  ds_read_b64_tr_b16 v[22:23], v4 offset:27904
  s_add_u32 s46, s45, 1049600
  s_waitcnt lgkmcnt(0)
  buffer_store_dwordx4 v[20:23], v1, s[16:19], s46 offen sc1
  ds_read_b64_tr_b16 v[24:25], v4 offset:320
  ds_read_b64_tr_b16 v[26:27], v4 offset:18752
  s_add_u32 s46, s45, 1310720
  s_waitcnt lgkmcnt(0)
  buffer_store_dwordx4 v[24:27], v1, s[16:19], s46 offen sc1
  ds_read_b64_tr_b16 v[28:29], v4 offset:9536
  ds_read_b64_tr_b16 v[30:31], v4 offset:27968
  s_add_u32 s46, s45, 1311744
  s_waitcnt lgkmcnt(0)
  buffer_store_dwordx4 v[28:31], v1, s[16:19], s46 offen sc1
  ds_read_b64_tr_b16 v[32:33], v4 offset:384
  ds_read_b64_tr_b16 v[34:35], v4 offset:18816
  s_add_u32 s46, s45, 1572864
  s_waitcnt lgkmcnt(0)
  buffer_store_dwordx4 v[32:35], v1, s[16:19], s46 offen sc1
  ds_read_b64_tr_b16 v[36:37], v4 offset:9600
  ds_read_b64_tr_b16 v[38:39], v4 offset:28032
  s_add_u32 s46, s45, 1573888
  s_waitcnt lgkmcnt(0)
  buffer_store_dwordx4 v[36:39], v1, s[16:19], s46 offen sc1
  ds_read_b64_tr_b16 v[40:41], v4 offset:448
  ds_read_b64_tr_b16 v[42:43], v4 offset:18880
  s_add_u32 s46, s45, 1835008
  s_waitcnt lgkmcnt(0)
  buffer_store_dwordx4 v[40:43], v1, s[16:19], s46 offen sc1
  ds_read_b64_tr_b16 v[44:45], v4 offset:9664
  ds_read_b64_tr_b16 v[46:47], v4 offset:28096
  s_add_u32 s46, s45, 1836032
  s_waitcnt lgkmcnt(0)
  buffer_store_dwordx4 v[44:47], v1, s[16:19], s46 offen sc1
  ds_read_b64_tr_b16 v[16:17], v4 offset:512
  ds_read_b64_tr_b16 v[18:19], v4 offset:18944
  s_add_u32 s46, s45, 2097152
  s_waitcnt lgkmcnt(0)
  buffer_store_dwordx4 v[16:19], v1, s[16:19], s46 offen sc1
  ds_read_b64_tr_b16 v[20:21], v4 offset:9728
  ds_read_b64_tr_b16 v[22:23], v4 offset:28160
  s_add_u32 s46, s45, 2098176
  s_waitcnt lgkmcnt(0)
  buffer_store_dwordx4 v[20:23], v1, s[16:19], s46 offen sc1
  ds_read_b64_tr_b16 v[24:25], v4 offset:576
  ds_read_b64_tr_b16 v[26:27], v4 offset:19008
  s_add_u32 s46, s45, 2359296
  s_waitcnt lgkmcnt(0)
  buffer_store_dwordx4 v[24:27], v1, s[16:19], s46 offen sc1
  ds_read_b64_tr_b16 v[28:29], v4 offset:9792
  ds_read_b64_tr_b16 v[30:31], v4 offset:28224
  s_add_u32 s46, s45, 2360320
  s_waitcnt lgkmcnt(0)
  buffer_store_dwordx4 v[28:31], v1, s[16:19], s46 offen sc1
  ds_read_b64_tr_b16 v[32:33], v4 offset:640
  ds_read_b64_tr_b16 v[34:35], v4 offset:19072
  s_add_u32 s46, s45, 2621440
  s_waitcnt lgkmcnt(0)
  buffer_store_dwordx4 v[32:35], v1, s[16:19], s46 offen sc1
  ds_read_b64_tr_b16 v[36:37], v4 offset:9856
  ds_read_b64_tr_b16 v[38:39], v4 offset:28288
  s_add_u32 s46, s45, 2622464
  s_waitcnt lgkmcnt(0)
  buffer_store_dwordx4 v[36:39], v1, s[16:19], s46 offen sc1
  ds_read_b64_tr_b16 v[40:41], v4 offset:704
  ds_read_b64_tr_b16 v[42:43], v4 offset:19136
  s_add_u32 s46, s45, 2883584
  s_waitcnt lgkmcnt(0)
  buffer_store_dwordx4 v[40:43], v1, s[16:19], s46 offen sc1
  ds_read_b64_tr_b16 v[44:45], v4 offset:9920
  ds_read_b64_tr_b16 v[46:47], v4 offset:28352
  s_add_u32 s46, s45, 2884608
  s_waitcnt lgkmcnt(0)
  buffer_store_dwordx4 v[44:47], v1, s[16:19], s46 offen sc1
  ds_read_b64_tr_b16 v[16:17], v4 offset:768
  ds_read_b64_tr_b16 v[18:19], v4 offset:19200
  s_add_u32 s46, s45, 3145728
  s_waitcnt lgkmcnt(0)
  buffer_store_dwordx4 v[16:19], v1, s[16:19], s46 offen sc1
  ds_read_b64_tr_b16 v[20:21], v4 offset:9984
  ds_read_b64_tr_b16 v[22:23], v4 offset:28416
  s_add_u32 s46, s45, 3146752
  s_waitcnt lgkmcnt(0)
  buffer_store_dwordx4 v[20:23], v1, s[16:19], s46 offen sc1
  ds_read_b64_tr_b16 v[24:25], v4 offset:832
  ds_read_b64_tr_b16 v[26:27], v4 offset:19264
  s_add_u32 s46, s45, 3407872
  s_waitcnt lgkmcnt(0)
  buffer_store_dwordx4 v[24:27], v1, s[16:19], s46 offen sc1
  ds_read_b64_tr_b16 v[28:29], v4 offset:10048
  ds_read_b64_tr_b16 v[30:31], v4 offset:28480
  s_add_u32 s46, s45, 3408896
  s_waitcnt lgkmcnt(0)
  buffer_store_dwordx4 v[28:31], v1, s[16:19], s46 offen sc1
  ds_read_b64_tr_b16 v[32:33], v4 offset:896
  ds_read_b64_tr_b16 v[34:35], v4 offset:19328
  s_add_u32 s46, s45, 3670016
  s_waitcnt lgkmcnt(0)
  buffer_store_dwordx4 v[32:35], v1, s[16:19], s46 offen sc1
  ds_read_b64_tr_b16 v[36:37], v4 offset:10112
  ds_read_b64_tr_b16 v[38:39], v4 offset:28544
  s_add_u32 s46, s45, 3671040
  s_waitcnt lgkmcnt(0)
  buffer_store_dwordx4 v[36:39], v1, s[16:19], s46 offen sc1
  ds_read_b64_tr_b16 v[40:41], v4 offset:960
  ds_read_b64_tr_b16 v[42:43], v4 offset:19392
  s_add_u32 s46, s45, 3932160
  s_waitcnt lgkmcnt(0)
  buffer_store_dwordx4 v[40:43], v1, s[16:19], s46 offen sc1
  ds_read_b64_tr_b16 v[44:45], v4 offset:10176
  ds_read_b64_tr_b16 v[46:47], v4 offset:28608
  s_add_u32 s46, s45, 3933184
  s_waitcnt lgkmcnt(0)
  buffer_store_dwordx4 v[44:47], v1, s[16:19], s46 offen sc1
  ds_read_b64_tr_b16 v[16:17], v4 offset:1024
  ds_read_b64_tr_b16 v[18:19], v4 offset:19456
  s_add_u32 s46, s45, 4194304
  s_waitcnt lgkmcnt(0)
  buffer_store_dwordx4 v[16:19], v1, s[16:19], s46 offen sc1
  ds_read_b64_tr_b16 v[20:21], v4 offset:10240
  ds_read_b64_tr_b16 v[22:23], v4 offset:28672
  s_add_u32 s46, s45, 4195328
  s_waitcnt lgkmcnt(0)
  buffer_store_dwordx4 v[20:23], v1, s[16:19], s46 offen sc1
  ds_read_b64_tr_b16 v[24:25], v4 offset:1088
  ds_read_b64_tr_b16 v[26:27], v4 offset:19520
  s_add_u32 s46, s45, 4456448
  s_waitcnt lgkmcnt(0)
  buffer_store_dwordx4 v[24:27], v1, s[16:19], s46 offen sc1
  ds_read_b64_tr_b16 v[28:29], v4 offset:10304
  ds_read_b64_tr_b16 v[30:31], v4 offset:28736
  s_add_u32 s46, s45, 4457472
  s_waitcnt lgkmcnt(0)
  buffer_store_dwordx4 v[28:31], v1, s[16:19], s46 offen sc1
  s_waitcnt vmcnt(0)
  s_load_dwordx2 s[4:5], s[0:1], 136
  s_waitcnt lgkmcnt(0)
  s_mov_b32 s16, s4
  s_mov_b32 s17, s5
  s_mov_b32 s18, 256
  s_mov_b32 s19, 0x00020000
  v_mov_b32 v4, 1
  v_mov_b32 v3, 88
  s_mov_b64 exec, 1
  buffer_atomic_add v4, v3, s[16:19], 0 offen sc1
  s_mov_b64 exec, -1
  s_waitcnt vmcnt(0)
  s_barrier
WK_S:
  s_load_dwordx2 s[4:5], s[0:1], 136
  s_waitcnt lgkmcnt(0)
  s_mov_b32 s16, s4
  s_mov_b32 s17, s5
  s_mov_b32 s18, 256
  s_mov_b32 s19, 0x00020000
  s_cmp_lg_u32 s3, 0
  s_cbranch_scc1 WK_W1
  s_mov_b64 exec, 1
  v_mov_b32 v4, 1
  v_mov_b32 v3, 80
  buffer_atomic_add v4, v3, s[16:19], 0 offen sc0 sc1
  v_mov_b32 v3, 0
  s_waitcnt vmcnt(0)
  ds_write_b32 v3, v4
  s_waitcnt lgkmcnt(0)
  s_mov_b64 exec, -1
WK_W1:
  s_barrier
  v_mov_b32 v3, 0
  ds_read_b32 v4, v3
  s_waitcnt lgkmcnt(0)
  v_readfirstlane_b32 s40, v4
  s_waitcnt lgkmcnt(0)
  s_barrier
  s_cmp_ge_u32 s40, 144
  s_nop 1
  s_cbranch_scc1 WK_E
  s_load_dwordx2 s[44:45], s[0:1], 64
  s_load_dwordx2 s[46:47], s[0:1], 72
  s_load_dwordx2 s[48:49], s[0:1], 80
  s_load_dwordx2 s[50:51], s[0:1], 88
  s_load_dwordx2 s[52:53], s[0:1], 96
  s_load_dwordx2 s[54:55], s[0:1], 104
  s_load_dwordx2 s[56:57], s[0:1], 112
  s_load_dwordx2 s[58:59], s[0:1], 120
  s_load_dwordx2 s[60:61], s[0:1], 56
  s_load_dwordx2 s[62:63], s[0:1], 128
  s_waitcnt lgkmcnt(0)
  s_lshl_b32 s41, s40, 2
  s_add_u32 s41, s41, s3
  s_mul_i32 s42, s3, 39552
  v_and_b32 v1, 63, v0
  s_lshl_b32 s43, s41, 8
  v_lshlrev_b32 v2, 1, v1
  s_mov_b32 s4, s44
  s_mov_b32 s5, s45
  s_mov_b32 s6, 147456
  s_mov_b32 s7, 0x00020000
  buffer_load_ushort v10, v2, s[4:7], s43 offen
  buffer_load_ushort v11, v2, s[4:7], s43 offen offset:128
  s_mov_b32 s4, s46
  s_mov_b32 s5, s47
  s_mov_b32 s6, 147456
  s_mov_b32 s7, 0x00020000
  buffer_load_ushort v12, v2, s[4:7], s43 offen
  buffer_load_ushort v13, v2, s[4:7], s43 offen offset:128
  s_mov_b32 s4, s48
  s_mov_b32 s5, s49
  s_mov_b32 s6, 147456
  s_mov_b32 s7, 0x00020000
  buffer_load_ushort v14, v2, s[4:7], s43 offen
  buffer_load_ushort v15, v2, s[4:7], s43 offen offset:128
  s_mov_b32 s4, s50
  s_mov_b32 s5, s51
  s_mov_b32 s6, 147456
  s_mov_b32 s7, 0x00020000
  buffer_load_ushort v16, v2, s[4:7], s43 offen
  buffer_load_ushort v17, v2, s[4:7], s43 offen offset:128
  s_mov_b32 s4, s52
  s_mov_b32 s5, s53
  s_mov_b32 s6, 147456
  s_mov_b32 s7, 0x00020000
  buffer_load_ushort v18, v2, s[4:7], s43 offen
  buffer_load_ushort v19, v2, s[4:7], s43 offen offset:128
  s_mov_b32 s4, s54
  s_mov_b32 s5, s55
  s_mov_b32 s6, 147456
  s_mov_b32 s7, 0x00020000
  buffer_load_ushort v20, v2, s[4:7], s43 offen
  buffer_load_ushort v21, v2, s[4:7], s43 offen offset:128
  s_mov_b32 s4, s56
  s_mov_b32 s5, s57
  s_mov_b32 s6, 1152
  s_mov_b32 s7, 0x00020000
  s_lshl_b32 s43, s41, 1
  v_mov_b32 v3, s43
  buffer_load_ushort v8, v3, s[4:7], 0 offen
  s_mov_b32 s64, 0x3fb8aa3b
  s_mov_b32 s65, 0x3e22f983
  s_waitcnt vmcnt(0)
  v_lshlrev_b32 v8, 16, v8
  v_mul_f32 v8, s64, v8
  v_exp_f32 v8, v8
  s_nop 0
  v_cvt_pk_bf16_f32 v8, v8, v8
  v_lshlrev_b32 v8, 16, v8
  v_lshlrev_b32 v10, 16, v10
  v_lshlrev_b32 v11, 16, v11
  v_lshlrev_b32 v12, 16, v12
  v_lshlrev_b32 v13, 16, v13
  v_lshlrev_b32 v14, 16, v14
  v_lshlrev_b32 v15, 16, v15
  v_lshlrev_b32 v16, 16, v16
  v_lshlrev_b32 v17, 16, v17
  v_lshlrev_b32 v18, 16, v18
  v_lshlrev_b32 v19, 16, v19
  v_lshlrev_b32 v20, 16, v20
  v_lshlrev_b32 v21, 16, v21
  v_mul_u32_u24 v4, 96, v1
  v_add_u32 v4, s42, v4
  v_mul_f32 v10, v8, v10
  v_mul_f32 v12, v8, v12
  v_mul_f32 v14, v8, v14
  v_mul_f32 v16, v8, v16
  v_mul_f32 v24, v18, v14
  v_fma_f32 v24, -v20, v16, v24
  v_mul_f32 v25, v18, v16
  v_fma_f32 v25, v20, v14, v25
  v_mul_f32 v32, s64, v10
  v_mul_f32 v33, s65, v12
  v_mov_b32 v34, v24
  v_mov_b32 v35, v25
  v_mul_f32 v26, 0x42800000, v32
  v_exp_f32 v26, v26
  v_mul_f32 v27, 0x42800000, v33
  v_fract_f32 v27, v27
  v_cos_f32 v28, v27
  v_sin_f32 v29, v27
  v_mul_f32 v28, v28, v26
  v_mul_f32 v29, v29, v26
  v_mul_f32 v36, v24, v28
  v_fma_f32 v36, -v25, v29, v36
  v_mul_f32 v37, v24, v29
  v_fma_f32 v37, v25, v28, v37
  v_mul_f32 v26, 0x43000000, v32
  v_exp_f32 v26, v26
  v_mul_f32 v27, 0x43000000, v33
  v_fract_f32 v27, v27
  v_cos_f32 v28, v27
  v_sin_f32 v29, v27
  v_mul_f32 v28, v28, v26
  v_mul_f32 v29, v29, v26
  v_mul_f32 v38, v24, v28
  v_fma_f32 v38, -v25, v29, v38
  v_mul_f32 v39, v24, v29
  v_fma_f32 v39, v25, v28, v39
  v_mul_f32 v26, 0x43400000, v32
  v_exp_f32 v26, v26
  v_mul_f32 v27, 0x43400000, v33
  v_fract_f32 v27, v27
  v_cos_f32 v28, v27
  v_sin_f32 v29, v27
  v_mul_f32 v28, v28, v26
  v_mul_f32 v29, v29, v26
  v_mul_f32 v40, v24, v28
  v_fma_f32 v40, -v25, v29, v40
  v_mul_f32 v41, v24, v29
  v_fma_f32 v41, v25, v28, v41
  v_mul_f32 v26, 0x43800000, v32
  v_exp_f32 v26, v26
  v_mul_f32 v27, 0x43800000, v33
  v_fract_f32 v27, v27
  v_cos_f32 v28, v27
  v_sin_f32 v29, v27
  v_mul_f32 v28, v28, v26
  v_mul_f32 v29, v29, v26
  v_mul_f32 v42, v24, v28
  v_fma_f32 v42, -v25, v29, v42
  v_mul_f32 v43, v24, v29
  v_fma_f32 v43, v25, v28, v43
  v_mul_f32 v26, 0x43c00000, v32
  v_exp_f32 v26, v26
  v_mul_f32 v27, 0x43c00000, v33
  v_fract_f32 v27, v27
  v_cos_f32 v28, v27
  v_sin_f32 v29, v27
  v_mul_f32 v28, v28, v26
  v_mul_f32 v29, v29, v26
  v_mul_f32 v44, v24, v28
  v_fma_f32 v44, -v25, v29, v44
  v_mul_f32 v45, v24, v29
  v_fma_f32 v45, v25, v28, v45
  v_mul_f32 v26, 0x44000000, v32
  v_exp_f32 v26, v26
  v_mul_f32 v27, 0x44000000, v33
  v_fract_f32 v27, v27
  v_cos_f32 v28, v27
  v_sin_f32 v29, v27
  v_mul_f32 v28, v28, v26
  v_mul_f32 v29, v29, v26
  v_mul_f32 v46, v24, v28
  v_fma_f32 v46, -v25, v29, v46
  v_mul_f32 v47, v24, v29
  v_fma_f32 v47, v25, v28, v47
  v_mul_f32 v26, 0x44400000, v32
  v_exp_f32 v26, v26
  v_mul_f32 v27, 0x44400000, v33
  v_fract_f32 v27, v27
  v_cos_f32 v28, v27
  v_sin_f32 v29, v27
  v_mul_f32 v28, v28, v26
  v_mul_f32 v29, v29, v26
  v_mul_f32 v48, v24, v28
  v_fma_f32 v48, -v25, v29, v48
  v_mul_f32 v49, v24, v29
  v_fma_f32 v49, v25, v28, v49
  v_mul_f32 v26, 0x44800000, v32
  v_exp_f32 v26, v26
  v_mul_f32 v27, 0x44800000, v33
  v_fract_f32 v27, v27
  v_cos_f32 v28, v27
  v_sin_f32 v29, v27
  v_mul_f32 v28, v28, v26
  v_mul_f32 v29, v29, v26
  v_mul_f32 v50, v24, v28
  v_fma_f32 v50, -v25, v29, v50
  v_mul_f32 v51, v24, v29
  v_fma_f32 v51, v25, v28, v51
  v_mul_f32 v26, 0x44c00000, v32
  v_exp_f32 v26, v26
  v_mul_f32 v27, 0x44c00000, v33
  v_fract_f32 v27, v27
  v_cos_f32 v28, v27
  v_sin_f32 v29, v27
  v_mul_f32 v28, v28, v26
  v_mul_f32 v29, v29, v26
  v_mul_f32 v52, v24, v28
  v_fma_f32 v52, -v25, v29, v52
  v_mul_f32 v53, v24, v29
  v_fma_f32 v53, v25, v28, v53
  v_mul_f32 v26, 0x45000000, v32
  v_exp_f32 v26, v26
  v_mul_f32 v27, 0x45000000, v33
  v_fract_f32 v27, v27
  v_cos_f32 v28, v27
  v_sin_f32 v29, v27
  v_mul_f32 v28, v28, v26
  v_mul_f32 v29, v29, v26
  v_mul_f32 v54, v24, v28
  v_fma_f32 v54, -v25, v29, v54
  v_mul_f32 v55, v24, v29
  v_fma_f32 v55, v25, v28, v55
  ds_write_b128 v4, v[32:35] offset:0
  ds_write_b128 v4, v[36:39] offset:16
  ds_write_b128 v4, v[40:43] offset:32
  ds_write_b128 v4, v[44:47] offset:48
  ds_write_b128 v4, v[48:51] offset:64
  ds_write_b128 v4, v[52:55] offset:80
  v_mul_f32 v11, v8, v11
  v_mul_f32 v13, v8, v13
  v_mul_f32 v15, v8, v15
  v_mul_f32 v17, v8, v17
  v_mul_f32 v24, v19, v15
  v_fma_f32 v24, -v21, v17, v24
  v_mul_f32 v25, v19, v17
  v_fma_f32 v25, v21, v15, v25
  v_mul_f32 v32, s64, v11
  v_mul_f32 v33, s65, v13
  v_mov_b32 v34, v24
  v_mov_b32 v35, v25
  v_mul_f32 v26, 0x42800000, v32
  v_exp_f32 v26, v26
  v_mul_f32 v27, 0x42800000, v33
  v_fract_f32 v27, v27
  v_cos_f32 v28, v27
  v_sin_f32 v29, v27
  v_mul_f32 v28, v28, v26
  v_mul_f32 v29, v29, v26
  v_mul_f32 v36, v24, v28
  v_fma_f32 v36, -v25, v29, v36
  v_mul_f32 v37, v24, v29
  v_fma_f32 v37, v25, v28, v37
  v_mul_f32 v26, 0x43000000, v32
  v_exp_f32 v26, v26
  v_mul_f32 v27, 0x43000000, v33
  v_fract_f32 v27, v27
  v_cos_f32 v28, v27
  v_sin_f32 v29, v27
  v_mul_f32 v28, v28, v26
  v_mul_f32 v29, v29, v26
  v_mul_f32 v38, v24, v28
  v_fma_f32 v38, -v25, v29, v38
  v_mul_f32 v39, v24, v29
  v_fma_f32 v39, v25, v28, v39
  v_mul_f32 v26, 0x43400000, v32
  v_exp_f32 v26, v26
  v_mul_f32 v27, 0x43400000, v33
  v_fract_f32 v27, v27
  v_cos_f32 v28, v27
  v_sin_f32 v29, v27
  v_mul_f32 v28, v28, v26
  v_mul_f32 v29, v29, v26
  v_mul_f32 v40, v24, v28
  v_fma_f32 v40, -v25, v29, v40
  v_mul_f32 v41, v24, v29
  v_fma_f32 v41, v25, v28, v41
  v_mul_f32 v26, 0x43800000, v32
  v_exp_f32 v26, v26
  v_mul_f32 v27, 0x43800000, v33
  v_fract_f32 v27, v27
  v_cos_f32 v28, v27
  v_sin_f32 v29, v27
  v_mul_f32 v28, v28, v26
  v_mul_f32 v29, v29, v26
  v_mul_f32 v42, v24, v28
  v_fma_f32 v42, -v25, v29, v42
  v_mul_f32 v43, v24, v29
  v_fma_f32 v43, v25, v28, v43
  v_mul_f32 v26, 0x43c00000, v32
  v_exp_f32 v26, v26
  v_mul_f32 v27, 0x43c00000, v33
  v_fract_f32 v27, v27
  v_cos_f32 v28, v27
  v_sin_f32 v29, v27
  v_mul_f32 v28, v28, v26
  v_mul_f32 v29, v29, v26
  v_mul_f32 v44, v24, v28
  v_fma_f32 v44, -v25, v29, v44
  v_mul_f32 v45, v24, v29
  v_fma_f32 v45, v25, v28, v45
  v_mul_f32 v26, 0x44000000, v32
  v_exp_f32 v26, v26
  v_mul_f32 v27, 0x44000000, v33
  v_fract_f32 v27, v27
  v_cos_f32 v28, v27
  v_sin_f32 v29, v27
  v_mul_f32 v28, v28, v26
  v_mul_f32 v29, v29, v26
  v_mul_f32 v46, v24, v28
  v_fma_f32 v46, -v25, v29, v46
  v_mul_f32 v47, v24, v29
  v_fma_f32 v47, v25, v28, v47
  v_mul_f32 v26, 0x44400000, v32
  v_exp_f32 v26, v26
  v_mul_f32 v27, 0x44400000, v33
  v_fract_f32 v27, v27
  v_cos_f32 v28, v27
  v_sin_f32 v29, v27
  v_mul_f32 v28, v28, v26
  v_mul_f32 v29, v29, v26
  v_mul_f32 v48, v24, v28
  v_fma_f32 v48, -v25, v29, v48
  v_mul_f32 v49, v24, v29
  v_fma_f32 v49, v25, v28, v49
  v_mul_f32 v26, 0x44800000, v32
  v_exp_f32 v26, v26
  v_mul_f32 v27, 0x44800000, v33
  v_fract_f32 v27, v27
  v_cos_f32 v28, v27
  v_sin_f32 v29, v27
  v_mul_f32 v28, v28, v26
  v_mul_f32 v29, v29, v26
  v_mul_f32 v50, v24, v28
  v_fma_f32 v50, -v25, v29, v50
  v_mul_f32 v51, v24, v29
  v_fma_f32 v51, v25, v28, v51
  v_mul_f32 v26, 0x44c00000, v32
  v_exp_f32 v26, v26
  v_mul_f32 v27, 0x44c00000, v33
  v_fract_f32 v27, v27
  v_cos_f32 v28, v27
  v_sin_f32 v29, v27
  v_mul_f32 v28, v28, v26
  v_mul_f32 v29, v29, v26
  v_mul_f32 v52, v24, v28
  v_fma_f32 v52, -v25, v29, v52
  v_mul_f32 v53, v24, v29
  v_fma_f32 v53, v25, v28, v53
  v_mul_f32 v26, 0x45000000, v32
  v_exp_f32 v26, v26
  v_mul_f32 v27, 0x45000000, v33
  v_fract_f32 v27, v27
  v_cos_f32 v28, v27
  v_sin_f32 v29, v27
  v_mul_f32 v28, v28, v26
  v_mul_f32 v29, v29, v26
  v_mul_f32 v54, v24, v28
  v_fma_f32 v54, -v25, v29, v54
  v_mul_f32 v55, v24, v29
  v_fma_f32 v55, v25, v28, v55
  ds_write_b128 v4, v[32:35] offset:6144
  ds_write_b128 v4, v[36:39] offset:6160
  ds_write_b128 v4, v[40:43] offset:6176
  ds_write_b128 v4, v[44:47] offset:6192
  ds_write_b128 v4, v[48:51] offset:6208
  ds_write_b128 v4, v[52:55] offset:6224
  s_waitcnt lgkmcnt(0)
  v_cvt_f32_u32 v5, v1
  v_mov_b32 v6, s42
  v_mov_b32 v60, 0
  v_mov_b32 v61, 0
  v_mov_b32 v62, 0
  v_mov_b32 v63, 0
  v_mov_b32 v64, 0
  v_mov_b32 v65, 0
  v_mov_b32 v66, 0
  v_mov_b32 v67, 0
  v_mov_b32 v68, 0
  v_mov_b32 v69, 0
  v_mov_b32 v70, 0
  ds_read_b128 v[80:83], v6 offset:0
  ds_read_b128 v[84:87], v6 offset:16
  ds_read_b128 v[88:91], v6 offset:32
  ds_read_b128 v[92:95], v6 offset:48
  ds_read_b128 v[96:99], v6 offset:64
  ds_read_b128 v[100:103], v6 offset:80
  s_mov_b32 s66, 0
S_M_35:
  ds_read_b128 v[104:107], v6 offset:96
  ds_read_b128 v[108:111], v6 offset:112
  ds_read_b128 v[112:115], v6 offset:128
  ds_read_b128 v[116:119], v6 offset:144
  ds_read_b128 v[120:123], v6 offset:160
  ds_read_b128 v[124:127], v6 offset:176
  s_waitcnt lgkmcnt(11)
  v_mul_f32 v26, v80, v5
  v_mul_f32 v27, v81, v5
  v_exp_f32 v26, v26
  v_fract_f32 v27, v27
  v_cos_f32 v28, v27
  v_sin_f32 v29, v27
  v_mul_f32 v28, v28, v26
  v_mul_f32 v29, v29, v26
  v_fma_f32 v60, v82, v28, v60
  v_fma_f32 v60, -v83, v29, v60
  s_waitcnt lgkmcnt(10)
  v_fma_f32 v61, v84, v28, v61
  v_fma_f32 v61, -v85, v29, v61
  v_fma_f32 v62, v86, v28, v62
  v_fma_f32 v62, -v87, v29, v62
  s_waitcnt lgkmcnt(9)
  v_fma_f32 v63, v88, v28, v63
  v_fma_f32 v63, -v89, v29, v63
  v_mul_f32 v30, v29, v29
  v_mul_f32 v31, v28, v29
  v_fma_f32 v28, v28, v28, -v30
  v_add_f32 v29, v31, v31
  v_fma_f32 v64, v90, v28, v64
  v_fma_f32 v64, -v91, v29, v64
  s_waitcnt lgkmcnt(8)
  v_fma_f32 v65, v92, v28, v65
  v_fma_f32 v65, -v93, v29, v65
  v_mul_f32 v30, v29, v29
  v_mul_f32 v31, v28, v29
  v_fma_f32 v28, v28, v28, -v30
  v_add_f32 v29, v31, v31
  v_fma_f32 v66, v94, v28, v66
  v_fma_f32 v66, -v95, v29, v66
  s_waitcnt lgkmcnt(7)
  v_fma_f32 v67, v96, v28, v67
  v_fma_f32 v67, -v97, v29, v67
  v_mul_f32 v30, v29, v29
  v_mul_f32 v31, v28, v29
  v_fma_f32 v28, v28, v28, -v30
  v_add_f32 v29, v31, v31
  v_fma_f32 v68, v98, v28, v68
  v_fma_f32 v68, -v99, v29, v68
  s_waitcnt lgkmcnt(6)
  v_fma_f32 v69, v100, v28, v69
  v_fma_f32 v69, -v101, v29, v69
  v_fma_f32 v70, v102, v28, v70
  v_fma_f32 v70, -v103, v29, v70
  ds_read_b128 v[80:83], v6 offset:192
  ds_read_b128 v[84:87], v6 offset:208
  ds_read_b128 v[88:91], v6 offset:224
  ds_read_b128 v[92:95], v6 offset:240
  ds_read_b128 v[96:99], v6 offset:256
  ds_read_b128 v[100:103], v6 offset:272
  s_waitcnt lgkmcnt(11)
  v_mul_f32 v26, v104, v5
  v_mul_f32 v27, v105, v5
  v_exp_f32 v26, v26
  v_fract_f32 v27, v27
  v_cos_f32 v28, v27
  v_sin_f32 v29, v27
  v_mul_f32 v28, v28, v26
  v_mul_f32 v29, v29, v26
  v_fma_f32 v60, v106, v28, v60
  v_fma_f32 v60, -v107, v29, v60
  s_waitcnt lgkmcnt(10)
  v_fma_f32 v61, v108, v28, v61
  v_fma_f32 v61, -v109, v29, v61
  v_fma_f32 v62, v110, v28, v62
  v_fma_f32 v62, -v111, v29, v62
  s_waitcnt lgkmcnt(9)
  v_fma_f32 v63, v112, v28, v63
  v_fma_f32 v63, -v113, v29, v63
  v_mul_f32 v30, v29, v29
  v_mul_f32 v31, v28, v29
  v_fma_f32 v28, v28, v28, -v30
  v_add_f32 v29, v31, v31
  v_fma_f32 v64, v114, v28, v64
  v_fma_f32 v64, -v115, v29, v64
  s_waitcnt lgkmcnt(8)
  v_fma_f32 v65, v116, v28, v65
  v_fma_f32 v65, -v117, v29, v65
  v_mul_f32 v30, v29, v29
  v_mul_f32 v31, v28, v29
  v_fma_f32 v28, v28, v28, -v30
  v_add_f32 v29, v31, v31
  v_fma_f32 v66, v118, v28, v66
  v_fma_f32 v66, -v119, v29, v66
  s_waitcnt lgkmcnt(7)
  v_fma_f32 v67, v120, v28, v67
  v_fma_f32 v67, -v121, v29, v67
  v_mul_f32 v30, v29, v29
  v_mul_f32 v31, v28, v29
  v_fma_f32 v28, v28, v28, -v30
  v_add_f32 v29, v31, v31
  v_fma_f32 v68, v122, v28, v68
  v_fma_f32 v68, -v123, v29, v68
  s_waitcnt lgkmcnt(6)
  v_fma_f32 v69, v124, v28, v69
  v_fma_f32 v69, -v125, v29, v69
  v_fma_f32 v70, v126, v28, v70
  v_fma_f32 v70, -v127, v29, v70
  v_add_u32 v6, 192, v6
  s_add_u32 s66, s66, 2
  s_cmp_lt_u32 s66, 128
  s_cbranch_scc1 S_M_35
  s_waitcnt lgkmcnt(0)
  v_lshlrev_b32 v7, 2, v1
  v_add_u32 v7, s42, v7
  ds_write_b32 v7, v60 offset:33408
  ds_write_b32 v7, v61 offset:33664
  ds_write_b32 v7, v62 offset:33920
  ds_write_b32 v7, v63 offset:34176
  ds_write_b32 v7, v64 offset:34432
  ds_write_b32 v7, v65 offset:34688
  ds_write_b32 v7, v66 offset:34944
  ds_write_b32 v7, v67 offset:35200
  ds_write_b32 v7, v68 offset:35456
  ds_write_b32 v7, v69 offset:35712
  ds_write_b32 v7, v70 offset:35968
  v_mov_b32 v9, 0
  s_mov_b64 exec, 0xffffff
  ds_write_b32 v7, v9 offset:4080
  ds_write_b32 v7, v9 offset:8256
  ds_write_b32 v7, v9 offset:12432
  ds_write_b32 v7, v9 offset:16608
  ds_write_b32 v7, v9 offset:20784
  ds_write_b32 v7, v9 offset:24960
  ds_write_b32 v7, v9 offset:29136
  ds_write_b32 v7, v9 offset:33312
  s_mov_b64 exec, -1
  s_waitcnt lgkmcnt(0)
  v_lshlrev_b32 v10, 1, v1
  v_sub_u32 v10, s42, v10
  ds_read_b32 v20, v7 offset:33408
  s_waitcnt lgkmcnt(0)
  v_cvt_pk_bf16_f32 v24, v20, v20
  v_lshlrev_b32 v12, 16, v24
  v_sub_f32 v12, v20, v12
  v_cvt_pk_bf16_f32 v25, v12, v12
  v_add_u32 v13, 4096, v10
  ds_write_b16 v13, v24 offset:0
  ds_write_b16 v13, v25 offset:16704
  ds_write_b16 v13, v24 offset:4174
  ds_write_b16 v13, v25 offset:20878
  ds_write_b16 v13, v24 offset:8348
  ds_write_b16 v13, v25 offset:25052
  ds_write_b16 v13, v24 offset:12522
  ds_write_b16 v13, v25 offset:29226
  ds_read_b32 v21, v7 offset:33664
  s_waitcnt lgkmcnt(0)
  v_cvt_pk_bf16_f32 v26, v21, v21
  v_lshlrev_b32 v12, 16, v26
  v_sub_f32 v12, v21, v12
  v_cvt_pk_bf16_f32 v27, v12, v12
  v_add_u32 v13, 3968, v10
  ds_write_b16 v13, v26 offset:0
  ds_write_b16 v13, v27 offset:16704
  ds_write_b16 v13, v26 offset:4174
  ds_write_b16 v13, v27 offset:20878
  ds_write_b16 v13, v26 offset:8348
  ds_write_b16 v13, v27 offset:25052
  ds_write_b16 v13, v26 offset:12522
  ds_write_b16 v13, v27 offset:29226
  ds_read_b32 v22, v7 offset:33920
  s_waitcnt lgkmcnt(0)
  v_cvt_pk_bf16_f32 v24, v22, v22
  v_lshlrev_b32 v12, 16, v24
  v_sub_f32 v12, v22, v12
  v_cvt_pk_bf16_f32 v25, v12, v12
  v_add_u32 v13, 3840, v10
  ds_write_b16 v13, v24 offset:0
  ds_write_b16 v13, v25 offset:16704
  ds_write_b16 v13, v24 offset:4174
  ds_write_b16 v13, v25 offset:20878
  ds_write_b16 v13, v24 offset:8348
  ds_write_b16 v13, v25 offset:25052
  ds_write_b16 v13, v24 offset:12522
  ds_write_b16 v13, v25 offset:29226
  ds_read_b32 v23, v7 offset:34176
  s_waitcnt lgkmcnt(0)
  v_cvt_pk_bf16_f32 v26, v23, v23
  v_lshlrev_b32 v12, 16, v26
  v_sub_f32 v12, v23, v12
  v_cvt_pk_bf16_f32 v27, v12, v12
  v_add_u32 v13, 3712, v10
  ds_write_b16 v13, v26 offset:0
  ds_write_b16 v13, v27 offset:16704
  ds_write_b16 v13, v26 offset:4174
  ds_write_b16 v13, v27 offset:20878
  ds_write_b16 v13, v26 offset:8348
  ds_write_b16 v13, v27 offset:25052
  ds_write_b16 v13, v26 offset:12522
  ds_write_b16 v13, v27 offset:29226
  v_add_u32 v11, 256, v1
  v_cvt_f32_u32 v11, v11
  v_cvt_pk_bf16_f32 v11, v11, v11
  v_lshlrev_b32 v11, 16, v11
  v_cvt_u32_f32 v11, v11
  v_subrev_u32 v11, 256, v11
  v_lshrrev_b32 v11, 1, v11
  v_lshlrev_b32 v11, 2, v11
  v_add_u32 v11, s42, v11
  ds_read_b32 v20, v11 offset:34432
  s_waitcnt lgkmcnt(0)
  v_cvt_pk_bf16_f32 v24, v20, v20
  v_lshlrev_b32 v12, 16, v24
  v_sub_f32 v12, v20, v12
  v_cvt_pk_bf16_f32 v25, v12, v12
  v_add_u32 v13, 3584, v10
  ds_write_b16 v13, v24 offset:0
  ds_write_b16 v13, v25 offset:16704
  ds_write_b16 v13, v24 offset:4174
  ds_write_b16 v13, v25 offset:20878
  ds_write_b16 v13, v24 offset:8348
  ds_write_b16 v13, v25 offset:25052
  ds_write_b16 v13, v24 offset:12522
  ds_write_b16 v13, v25 offset:29226
  v_add_u32 v11, 320, v1
  v_cvt_f32_u32 v11, v11
  v_cvt_pk_bf16_f32 v11, v11, v11
  v_lshlrev_b32 v11, 16, v11
  v_cvt_u32_f32 v11, v11
  v_subrev_u32 v11, 256, v11
  v_lshrrev_b32 v11, 1, v11
  v_lshlrev_b32 v11, 2, v11
  v_add_u32 v11, s42, v11
  ds_read_b32 v21, v11 offset:34432
  s_waitcnt lgkmcnt(0)
  v_cvt_pk_bf16_f32 v26, v21, v21
  v_lshlrev_b32 v12, 16, v26
  v_sub_f32 v12, v21, v12
  v_cvt_pk_bf16_f32 v27, v12, v12
  v_add_u32 v13, 3456, v10
  ds_write_b16 v13, v26 offset:0
  ds_write_b16 v13, v27 offset:16704
  ds_write_b16 v13, v26 offset:4174
  ds_write_b16 v13, v27 offset:20878
  ds_write_b16 v13, v26 offset:8348
  ds_write_b16 v13, v27 offset:25052
  ds_write_b16 v13, v26 offset:12522
  ds_write_b16 v13, v27 offset:29226
  v_add_u32 v11, 384, v1
  v_cvt_f32_u32 v11, v11
  v_cvt_pk_bf16_f32 v11, v11, v11
  v_lshlrev_b32 v11, 16, v11
  v_cvt_u32_f32 v11, v11
  v_subrev_u32 v11, 256, v11
  v_lshrrev_b32 v11, 1, v11
  v_lshlrev_b32 v11, 2, v11
  v_add_u32 v11, s42, v11
  ds_read_b32 v22, v11 offset:34432
  s_waitcnt lgkmcnt(0)
  v_cvt_pk_bf16_f32 v24, v22, v22
  v_lshlrev_b32 v12, 16, v24
  v_sub_f32 v12, v22, v12
  v_cvt_pk_bf16_f32 v25, v12, v12
  v_add_u32 v13, 3328, v10
  ds_write_b16 v13, v24 offset:0
  ds_write_b16 v13, v25 offset:16704
  ds_write_b16 v13, v24 offset:4174
  ds_write_b16 v13, v25 offset:20878
  ds_write_b16 v13, v24 offset:8348
  ds_write_b16 v13, v25 offset:25052
  ds_write_b16 v13, v24 offset:12522
  ds_write_b16 v13, v25 offset:29226
  v_add_u32 v11, 448, v1
  v_cvt_f32_u32 v11, v11
  v_cvt_pk_bf16_f32 v11, v11, v11
  v_lshlrev_b32 v11, 16, v11
  v_cvt_u32_f32 v11, v11
  v_subrev_u32 v11, 256, v11
  v_lshrrev_b32 v11, 1, v11
  v_lshlrev_b32 v11, 2, v11
  v_add_u32 v11, s42, v11
  ds_read_b32 v23, v11 offset:34432
  s_waitcnt lgkmcnt(0)
  v_cvt_pk_bf16_f32 v26, v23, v23
  v_lshlrev_b32 v12, 16, v26
  v_sub_f32 v12, v23, v12
  v_cvt_pk_bf16_f32 v27, v12, v12
  v_add_u32 v13, 3200, v10
  ds_write_b16 v13, v26 offset:0
  ds_write_b16 v13, v27 offset:16704
  ds_write_b16 v13, v26 offset:4174
  ds_write_b16 v13, v27 offset:20878
  ds_write_b16 v13, v26 offset:8348
  ds_write_b16 v13, v27 offset:25052
  ds_write_b16 v13, v26 offset:12522
  ds_write_b16 v13, v27 offset:29226
  v_add_u32 v11, 512, v1
  v_cvt_f32_u32 v11, v11
  v_cvt_pk_bf16_f32 v11, v11, v11
  v_lshlrev_b32 v11, 16, v11
  v_cvt_u32_f32 v11, v11
  v_subrev_u32 v11, 512, v11
  v_lshrrev_b32 v11, 2, v11
  v_lshlrev_b32 v11, 2, v11
  v_add_u32 v11, s42, v11
  ds_read_b32 v20, v11 offset:34944
  s_waitcnt lgkmcnt(0)
  v_cvt_pk_bf16_f32 v24, v20, v20
  v_lshlrev_b32 v12, 16, v24
  v_sub_f32 v12, v20, v12
  v_cvt_pk_bf16_f32 v25, v12, v12
  v_add_u32 v13, 3072, v10
  ds_write_b16 v13, v24 offset:0
  ds_write_b16 v13, v25 offset:16704
  ds_write_b16 v13, v24 offset:4174
  ds_write_b16 v13, v25 offset:20878
  ds_write_b16 v13, v24 offset:8348
  ds_write_b16 v13, v25 offset:25052
  ds_write_b16 v13, v24 offset:12522
  ds_write_b16 v13, v25 offset:29226
  v_add_u32 v11, 576, v1
  v_cvt_f32_u32 v11, v11
  v_cvt_pk_bf16_f32 v11, v11, v11
  v_lshlrev_b32 v11, 16, v11
  v_cvt_u32_f32 v11, v11
  v_subrev_u32 v11, 512, v11
  v_lshrrev_b32 v11, 2, v11
  v_lshlrev_b32 v11, 2, v11
  v_add_u32 v11, s42, v11
  ds_read_b32 v21, v11 offset:34944
  s_waitcnt lgkmcnt(0)
  v_cvt_pk_bf16_f32 v26, v21, v21
  v_lshlrev_b32 v12, 16, v26
  v_sub_f32 v12, v21, v12
  v_cvt_pk_bf16_f32 v27, v12, v12
  v_add_u32 v13, 2944, v10
  ds_write_b16 v13, v26 offset:0
  ds_write_b16 v13, v27 offset:16704
  ds_write_b16 v13, v26 offset:4174
  ds_write_b16 v13, v27 offset:20878
  ds_write_b16 v13, v26 offset:8348
  ds_write_b16 v13, v27 offset:25052
  ds_write_b16 v13, v26 offset:12522
  ds_write_b16 v13, v27 offset:29226
  v_add_u32 v11, 640, v1
  v_cvt_f32_u32 v11, v11
  v_cvt_pk_bf16_f32 v11, v11, v11
  v_lshlrev_b32 v11, 16, v11
  v_cvt_u32_f32 v11, v11
  v_subrev_u32 v11, 512, v11
  v_lshrrev_b32 v11, 2, v11
  v_lshlrev_b32 v11, 2, v11
  v_add_u32 v11, s42, v11
  ds_read_b32 v22, v11 offset:34944
  s_waitcnt lgkmcnt(0)
  v_cvt_pk_bf16_f32 v24, v22, v22
  v_lshlrev_b32 v12, 16, v24
  v_sub_f32 v12, v22, v12
  v_cvt_pk_bf16_f32 v25, v12, v12
  v_add_u32 v13, 2816, v10
  ds_write_b16 v13, v24 offset:0
  ds_write_b16 v13, v25 offset:16704
  ds_write_b16 v13, v24 offset:4174
  ds_write_b16 v13, v25 offset:20878
  ds_write_b16 v13, v24 offset:8348
  ds_write_b16 v13, v25 offset:25052
  ds_write_b16 v13, v24 offset:12522
  ds_write_b16 v13, v25 offset:29226
  v_add_u32 v11, 704, v1
  v_cvt_f32_u32 v11, v11
  v_cvt_pk_bf16_f32 v11, v11, v11
  v_lshlrev_b32 v11, 16, v11
  v_cvt_u32_f32 v11, v11
  v_subrev_u32 v11, 512, v11
  v_lshrrev_b32 v11, 2, v11
  v_lshlrev_b32 v11, 2, v11
  v_add_u32 v11, s42, v11
  ds_read_b32 v23, v11 offset:34944
  s_waitcnt lgkmcnt(0)
  v_cvt_pk_bf16_f32 v26, v23, v23
  v_lshlrev_b32 v12, 16, v26
  v_sub_f32 v12, v23, v12
  v_cvt_pk_bf16_f32 v27, v12, v12
  v_add_u32 v13, 2688, v10
  ds_write_b16 v13, v26 offset:0
  ds_write_b16 v13, v27 offset:16704
  ds_write_b16 v13, v26 offset:4174
  ds_write_b16 v13, v27 offset:20878
  ds_write_b16 v13, v26 offset:8348
  ds_write_b16 v13, v27 offset:25052
  ds_write_b16 v13, v26 offset:12522
  ds_write_b16 v13, v27 offset:29226
  v_add_u32 v11, 768, v1
  v_cvt_f32_u32 v11, v11
  v_cvt_pk_bf16_f32 v11, v11, v11
  v_lshlrev_b32 v11, 16, v11
  v_cvt_u32_f32 v11, v11
  v_subrev_u32 v11, 512, v11
  v_lshrrev_b32 v11, 2, v11
  v_lshlrev_b32 v11, 2, v11
  v_add_u32 v11, s42, v11
  ds_read_b32 v20, v11 offset:34944
  s_waitcnt lgkmcnt(0)
  v_cvt_pk_bf16_f32 v24, v20, v20
  v_lshlrev_b32 v12, 16, v24
  v_sub_f32 v12, v20, v12
  v_cvt_pk_bf16_f32 v25, v12, v12
  v_add_u32 v13, 2560, v10
  ds_write_b16 v13, v24 offset:0
  ds_write_b16 v13, v25 offset:16704
  ds_write_b16 v13, v24 offset:4174
  ds_write_b16 v13, v25 offset:20878
  ds_write_b16 v13, v24 offset:8348
  ds_write_b16 v13, v25 offset:25052
  ds_write_b16 v13, v24 offset:12522
  ds_write_b16 v13, v25 offset:29226
  v_add_u32 v11, 832, v1
  v_cvt_f32_u32 v11, v11
  v_cvt_pk_bf16_f32 v11, v11, v11
  v_lshlrev_b32 v11, 16, v11
  v_cvt_u32_f32 v11, v11
  v_subrev_u32 v11, 512, v11
  v_lshrrev_b32 v11, 2, v11
  v_lshlrev_b32 v11, 2, v11
  v_add_u32 v11, s42, v11
  ds_read_b32 v21, v11 offset:34944
  s_waitcnt lgkmcnt(0)
  v_cvt_pk_bf16_f32 v26, v21, v21
  v_lshlrev_b32 v12, 16, v26
  v_sub_f32 v12, v21, v12
  v_cvt_pk_bf16_f32 v27, v12, v12
  v_add_u32 v13, 2432, v10
  ds_write_b16 v13, v26 offset:0
  ds_write_b16 v13, v27 offset:16704
  ds_write_b16 v13, v26 offset:4174
  ds_write_b16 v13, v27 offset:20878
  ds_write_b16 v13, v26 offset:8348
  ds_write_b16 v13, v27 offset:25052
  ds_write_b16 v13, v26 offset:12522
  ds_write_b16 v13, v27 offset:29226
  v_add_u32 v11, 896, v1
  v_cvt_f32_u32 v11, v11
  v_cvt_pk_bf16_f32 v11, v11, v11
  v_lshlrev_b32 v11, 16, v11
  v_cvt_u32_f32 v11, v11
  v_subrev_u32 v11, 512, v11
  v_lshrrev_b32 v11, 2, v11
  v_lshlrev_b32 v11, 2, v11
  v_add_u32 v11, s42, v11
  ds_read_b32 v22, v11 offset:34944
  s_waitcnt lgkmcnt(0)
  v_cvt_pk_bf16_f32 v24, v22, v22
  v_lshlrev_b32 v12, 16, v24
  v_sub_f32 v12, v22, v12
  v_cvt_pk_bf16_f32 v25, v12, v12
  v_add_u32 v13, 2304, v10
  ds_write_b16 v13, v24 offset:0
  ds_write_b16 v13, v25 offset:16704
  ds_write_b16 v13, v24 offset:4174
  ds_write_b16 v13, v25 offset:20878
  ds_write_b16 v13, v24 offset:8348
  ds_write_b16 v13, v25 offset:25052
  ds_write_b16 v13, v24 offset:12522
  ds_write_b16 v13, v25 offset:29226
  v_add_u32 v11, 960, v1
  v_cvt_f32_u32 v11, v11
  v_cvt_pk_bf16_f32 v11, v11, v11
  v_lshlrev_b32 v11, 16, v11
  v_cvt_u32_f32 v11, v11
  v_subrev_u32 v11, 512, v11
  v_lshrrev_b32 v11, 2, v11
  v_lshlrev_b32 v11, 2, v11
  v_add_u32 v11, s42, v11
  ds_read_b32 v23, v11 offset:34944
  s_waitcnt lgkmcnt(0)
  v_cvt_pk_bf16_f32 v26, v23, v23
  v_lshlrev_b32 v12, 16, v26
  v_sub_f32 v12, v23, v12
  v_cvt_pk_bf16_f32 v27, v12, v12
  v_add_u32 v13, 2176, v10
  ds_write_b16 v13, v26 offset:0
  ds_write_b16 v13, v27 offset:16704
  ds_write_b16 v13, v26 offset:4174
  ds_write_b16 v13, v27 offset:20878
  ds_write_b16 v13, v26 offset:8348
  ds_write_b16 v13, v27 offset:25052
  ds_write_b16 v13, v26 offset:12522
  ds_write_b16 v13, v27 offset:29226
  v_add_u32 v11, 1024, v1
  v_cvt_f32_u32 v11, v11
  v_cvt_pk_bf16_f32 v11, v11, v11
  v_lshlrev_b32 v11, 16, v11
  v_cvt_u32_f32 v11, v11
  v_subrev_u32 v11, 1024, v11
  v_lshrrev_b32 v11, 3, v11
  v_lshlrev_b32 v11, 2, v11
  v_add_u32 v11, s42, v11
  ds_read_b32 v20, v11 offset:35456
  s_waitcnt lgkmcnt(0)
  v_cvt_pk_bf16_f32 v24, v20, v20
  v_lshlrev_b32 v12, 16, v24
  v_sub_f32 v12, v20, v12
  v_cvt_pk_bf16_f32 v25, v12, v12
  v_add_u32 v13, 2048, v10
  ds_write_b16 v13, v24 offset:0
  ds_write_b16 v13, v25 offset:16704
  ds_write_b16 v13, v24 offset:4174
  ds_write_b16 v13, v25 offset:20878
  ds_write_b16 v13, v24 offset:8348
  ds_write_b16 v13, v25 offset:25052
  ds_write_b16 v13, v24 offset:12522
  ds_write_b16 v13, v25 offset:29226
  v_add_u32 v11, 1088, v1
  v_cvt_f32_u32 v11, v11
  v_cvt_pk_bf16_f32 v11, v11, v11
  v_lshlrev_b32 v11, 16, v11
  v_cvt_u32_f32 v11, v11
  v_subrev_u32 v11, 1024, v11
  v_lshrrev_b32 v11, 3, v11
  v_lshlrev_b32 v11, 2, v11
  v_add_u32 v11, s42, v11
  ds_read_b32 v21, v11 offset:35456
  s_waitcnt lgkmcnt(0)
  v_cvt_pk_bf16_f32 v26, v21, v21
  v_lshlrev_b32 v12, 16, v26
  v_sub_f32 v12, v21, v12
  v_cvt_pk_bf16_f32 v27, v12, v12
  v_add_u32 v13, 1920, v10
  ds_write_b16 v13, v26 offset:0
  ds_write_b16 v13, v27 offset:16704
  ds_write_b16 v13, v26 offset:4174
  ds_write_b16 v13, v27 offset:20878
  ds_write_b16 v13, v26 offset:8348
  ds_write_b16 v13, v27 offset:25052
  ds_write_b16 v13, v26 offset:12522
  ds_write_b16 v13, v27 offset:29226
  v_add_u32 v11, 1152, v1
  v_cvt_f32_u32 v11, v11
  v_cvt_pk_bf16_f32 v11, v11, v11
  v_lshlrev_b32 v11, 16, v11
  v_cvt_u32_f32 v11, v11
  v_subrev_u32 v11, 1024, v11
  v_lshrrev_b32 v11, 3, v11
  v_lshlrev_b32 v11, 2, v11
  v_add_u32 v11, s42, v11
  ds_read_b32 v22, v11 offset:35456
  s_waitcnt lgkmcnt(0)
  v_cvt_pk_bf16_f32 v24, v22, v22
  v_lshlrev_b32 v12, 16, v24
  v_sub_f32 v12, v22, v12
  v_cvt_pk_bf16_f32 v25, v12, v12
  v_add_u32 v13, 1792, v10
  ds_write_b16 v13, v24 offset:0
  ds_write_b16 v13, v25 offset:16704
  ds_write_b16 v13, v24 offset:4174
  ds_write_b16 v13, v25 offset:20878
  ds_write_b16 v13, v24 offset:8348
  ds_write_b16 v13, v25 offset:25052
  ds_write_b16 v13, v24 offset:12522
  ds_write_b16 v13, v25 offset:29226
  v_add_u32 v11, 1216, v1
  v_cvt_f32_u32 v11, v11
  v_cvt_pk_bf16_f32 v11, v11, v11
  v_lshlrev_b32 v11, 16, v11
  v_cvt_u32_f32 v11, v11
  v_subrev_u32 v11, 1024, v11
  v_lshrrev_b32 v11, 3, v11
  v_lshlrev_b32 v11, 2, v11
  v_add_u32 v11, s42, v11
  ds_read_b32 v23, v11 offset:35456
  s_waitcnt lgkmcnt(0)
  v_cvt_pk_bf16_f32 v26, v23, v23
  v_lshlrev_b32 v12, 16, v26
  v_sub_f32 v12, v23, v12
  v_cvt_pk_bf16_f32 v27, v12, v12
  v_add_u32 v13, 1664, v10
  ds_write_b16 v13, v26 offset:0
  ds_write_b16 v13, v27 offset:16704
  ds_write_b16 v13, v26 offset:4174
  ds_write_b16 v13, v27 offset:20878
  ds_write_b16 v13, v26 offset:8348
  ds_write_b16 v13, v27 offset:25052
  ds_write_b16 v13, v26 offset:12522
  ds_write_b16 v13, v27 offset:29226
  v_add_u32 v11, 1280, v1
  v_cvt_f32_u32 v11, v11
  v_cvt_pk_bf16_f32 v11, v11, v11
  v_lshlrev_b32 v11, 16, v11
  v_cvt_u32_f32 v11, v11
  v_subrev_u32 v11, 1024, v11
  v_lshrrev_b32 v11, 3, v11
  v_lshlrev_b32 v11, 2, v11
  v_add_u32 v11, s42, v11
  ds_read_b32 v20, v11 offset:35456
  s_waitcnt lgkmcnt(0)
  v_cvt_pk_bf16_f32 v24, v20, v20
  v_lshlrev_b32 v12, 16, v24
  v_sub_f32 v12, v20, v12
  v_cvt_pk_bf16_f32 v25, v12, v12
  v_add_u32 v13, 1536, v10
  ds_write_b16 v13, v24 offset:0
  ds_write_b16 v13, v25 offset:16704
  ds_write_b16 v13, v24 offset:4174
  ds_write_b16 v13, v25 offset:20878
  ds_write_b16 v13, v24 offset:8348
  ds_write_b16 v13, v25 offset:25052
  ds_write_b16 v13, v24 offset:12522
  ds_write_b16 v13, v25 offset:29226
  v_add_u32 v11, 1344, v1
  v_cvt_f32_u32 v11, v11
  v_cvt_pk_bf16_f32 v11, v11, v11
  v_lshlrev_b32 v11, 16, v11
  v_cvt_u32_f32 v11, v11
  v_subrev_u32 v11, 1024, v11
  v_lshrrev_b32 v11, 3, v11
  v_lshlrev_b32 v11, 2, v11
  v_add_u32 v11, s42, v11
  ds_read_b32 v21, v11 offset:35456
  s_waitcnt lgkmcnt(0)
  v_cvt_pk_bf16_f32 v26, v21, v21
  v_lshlrev_b32 v12, 16, v26
  v_sub_f32 v12, v21, v12
  v_cvt_pk_bf16_f32 v27, v12, v12
  v_add_u32 v13, 1408, v10
  ds_write_b16 v13, v26 offset:0
  ds_write_b16 v13, v27 offset:16704
  ds_write_b16 v13, v26 offset:4174
  ds_write_b16 v13, v27 offset:20878
  ds_write_b16 v13, v26 offset:8348
  ds_write_b16 v13, v27 offset:25052
  ds_write_b16 v13, v26 offset:12522
  ds_write_b16 v13, v27 offset:29226
  v_add_u32 v11, 1408, v1
  v_cvt_f32_u32 v11, v11
  v_cvt_pk_bf16_f32 v11, v11, v11
  v_lshlrev_b32 v11, 16, v11
  v_cvt_u32_f32 v11, v11
  v_subrev_u32 v11, 1024, v11
  v_lshrrev_b32 v11, 3, v11
  v_lshlrev_b32 v11, 2, v11
  v_add_u32 v11, s42, v11
  ds_read_b32 v22, v11 offset:35456
  s_waitcnt lgkmcnt(0)
  v_cvt_pk_bf16_f32 v24, v22, v22
  v_lshlrev_b32 v12, 16, v24
  v_sub_f32 v12, v22, v12
  v_cvt_pk_bf16_f32 v25, v12, v12
  v_add_u32 v13, 1280, v10
  ds_write_b16 v13, v24 offset:0
  ds_write_b16 v13, v25 offset:16704
  ds_write_b16 v13, v24 offset:4174
  ds_write_b16 v13, v25 offset:20878
  ds_write_b16 v13, v24 offset:8348
  ds_write_b16 v13, v25 offset:25052
  ds_write_b16 v13, v24 offset:12522
  ds_write_b16 v13, v25 offset:29226
  v_add_u32 v11, 1472, v1
  v_cvt_f32_u32 v11, v11
  v_cvt_pk_bf16_f32 v11, v11, v11
  v_lshlrev_b32 v11, 16, v11
  v_cvt_u32_f32 v11, v11
  v_subrev_u32 v11, 1024, v11
  v_lshrrev_b32 v11, 3, v11
  v_lshlrev_b32 v11, 2, v11
  v_add_u32 v11, s42, v11
  ds_read_b32 v23, v11 offset:35456
  s_waitcnt lgkmcnt(0)
  v_cvt_pk_bf16_f32 v26, v23, v23
  v_lshlrev_b32 v12, 16, v26
  v_sub_f32 v12, v23, v12
  v_cvt_pk_bf16_f32 v27, v12, v12
  v_add_u32 v13, 1152, v10
  ds_write_b16 v13, v26 offset:0
  ds_write_b16 v13, v27 offset:16704
  ds_write_b16 v13, v26 offset:4174
  ds_write_b16 v13, v27 offset:20878
  ds_write_b16 v13, v26 offset:8348
  ds_write_b16 v13, v27 offset:25052
  ds_write_b16 v13, v26 offset:12522
  ds_write_b16 v13, v27 offset:29226
  v_add_u32 v11, 1536, v1
  v_cvt_f32_u32 v11, v11
  v_cvt_pk_bf16_f32 v11, v11, v11
  v_lshlrev_b32 v11, 16, v11
  v_cvt_u32_f32 v11, v11
  v_subrev_u32 v11, 1024, v11
  v_lshrrev_b32 v11, 3, v11
  v_lshlrev_b32 v11, 2, v11
  v_add_u32 v11, s42, v11
  ds_read_b32 v20, v11 offset:35456
  s_waitcnt lgkmcnt(0)
  v_cvt_pk_bf16_f32 v24, v20, v20
  v_lshlrev_b32 v12, 16, v24
  v_sub_f32 v12, v20, v12
  v_cvt_pk_bf16_f32 v25, v12, v12
  v_add_u32 v13, 1024, v10
  ds_write_b16 v13, v24 offset:0
  ds_write_b16 v13, v25 offset:16704
  ds_write_b16 v13, v24 offset:4174
  ds_write_b16 v13, v25 offset:20878
  ds_write_b16 v13, v24 offset:8348
  ds_write_b16 v13, v25 offset:25052
  ds_write_b16 v13, v24 offset:12522
  ds_write_b16 v13, v25 offset:29226
  v_add_u32 v11, 1600, v1
  v_cvt_f32_u32 v11, v11
  v_cvt_pk_bf16_f32 v11, v11, v11
  v_lshlrev_b32 v11, 16, v11
  v_cvt_u32_f32 v11, v11
  v_subrev_u32 v11, 1024, v11
  v_lshrrev_b32 v11, 3, v11
  v_lshlrev_b32 v11, 2, v11
  v_add_u32 v11, s42, v11
  ds_read_b32 v21, v11 offset:35456
  s_waitcnt lgkmcnt(0)
  v_cvt_pk_bf16_f32 v26, v21, v21
  v_lshlrev_b32 v12, 16, v26
  v_sub_f32 v12, v21, v12
  v_cvt_pk_bf16_f32 v27, v12, v12
  v_add_u32 v13, 896, v10
  ds_write_b16 v13, v26 offset:0
  ds_write_b16 v13, v27 offset:16704
  ds_write_b16 v13, v26 offset:4174
  ds_write_b16 v13, v27 offset:20878
  ds_write_b16 v13, v26 offset:8348
  ds_write_b16 v13, v27 offset:25052
  ds_write_b16 v13, v26 offset:12522
  ds_write_b16 v13, v27 offset:29226
  v_add_u32 v11, 1664, v1
  v_cvt_f32_u32 v11, v11
  v_cvt_pk_bf16_f32 v11, v11, v11
  v_lshlrev_b32 v11, 16, v11
  v_cvt_u32_f32 v11, v11
  v_subrev_u32 v11, 1024, v11
  v_lshrrev_b32 v11, 3, v11
  v_lshlrev_b32 v11, 2, v11
  v_add_u32 v11, s42, v11
  ds_read_b32 v22, v11 offset:35456
  s_waitcnt lgkmcnt(0)
  v_cvt_pk_bf16_f32 v24, v22, v22
  v_lshlrev_b32 v12, 16, v24
  v_sub_f32 v12, v22, v12
  v_cvt_pk_bf16_f32 v25, v12, v12
  v_add_u32 v13, 768, v10
  ds_write_b16 v13, v24 offset:0
  ds_write_b16 v13, v25 offset:16704
  ds_write_b16 v13, v24 offset:4174
  ds_write_b16 v13, v25 offset:20878
  ds_write_b16 v13, v24 offset:8348
  ds_write_b16 v13, v25 offset:25052
  ds_write_b16 v13, v24 offset:12522
  ds_write_b16 v13, v25 offset:29226
  v_add_u32 v11, 1728, v1
  v_cvt_f32_u32 v11, v11
  v_cvt_pk_bf16_f32 v11, v11, v11
  v_lshlrev_b32 v11, 16, v11
  v_cvt_u32_f32 v11, v11
  v_subrev_u32 v11, 1024, v11
  v_lshrrev_b32 v11, 3, v11
  v_lshlrev_b32 v11, 2, v11
  v_add_u32 v11, s42, v11
  ds_read_b32 v23, v11 offset:35456
  s_waitcnt lgkmcnt(0)
  v_cvt_pk_bf16_f32 v26, v23, v23
  v_lshlrev_b32 v12, 16, v26
  v_sub_f32 v12, v23, v12
  v_cvt_pk_bf16_f32 v27, v12, v12
  v_add_u32 v13, 640, v10
  ds_write_b16 v13, v26 offset:0
  ds_write_b16 v13, v27 offset:16704
  ds_write_b16 v13, v26 offset:4174
  ds_write_b16 v13, v27 offset:20878
  ds_write_b16 v13, v26 offset:8348
  ds_write_b16 v13, v27 offset:25052
  ds_write_b16 v13, v26 offset:12522
  ds_write_b16 v13, v27 offset:29226
  v_add_u32 v11, 1792, v1
  v_cvt_f32_u32 v11, v11
  v_cvt_pk_bf16_f32 v11, v11, v11
  v_lshlrev_b32 v11, 16, v11
  v_cvt_u32_f32 v11, v11
  v_subrev_u32 v11, 1024, v11
  v_lshrrev_b32 v11, 3, v11
  v_lshlrev_b32 v11, 2, v11
  v_add_u32 v11, s42, v11
  ds_read_b32 v20, v11 offset:35456
  s_waitcnt lgkmcnt(0)
  v_cvt_pk_bf16_f32 v24, v20, v20
  v_lshlrev_b32 v12, 16, v24
  v_sub_f32 v12, v20, v12
  v_cvt_pk_bf16_f32 v25, v12, v12
  v_add_u32 v13, 512, v10
  ds_write_b16 v13, v24 offset:0
  ds_write_b16 v13, v25 offset:16704
  ds_write_b16 v13, v24 offset:4174
  ds_write_b16 v13, v25 offset:20878
  ds_write_b16 v13, v24 offset:8348
  ds_write_b16 v13, v25 offset:25052
  ds_write_b16 v13, v24 offset:12522
  ds_write_b16 v13, v25 offset:29226
  v_add_u32 v11, 1856, v1
  v_cvt_f32_u32 v11, v11
  v_cvt_pk_bf16_f32 v11, v11, v11
  v_lshlrev_b32 v11, 16, v11
  v_cvt_u32_f32 v11, v11
  v_subrev_u32 v11, 1024, v11
  v_lshrrev_b32 v11, 3, v11
  v_lshlrev_b32 v11, 2, v11
  v_add_u32 v11, s42, v11
  ds_read_b32 v21, v11 offset:35456
  s_waitcnt lgkmcnt(0)
  v_cvt_pk_bf16_f32 v26, v21, v21
  v_lshlrev_b32 v12, 16, v26
  v_sub_f32 v12, v21, v12
  v_cvt_pk_bf16_f32 v27, v12, v12
  v_add_u32 v13, 384, v10
  ds_write_b16 v13, v26 offset:0
  ds_write_b16 v13, v27 offset:16704
  ds_write_b16 v13, v26 offset:4174
  ds_write_b16 v13, v27 offset:20878
  ds_write_b16 v13, v26 offset:8348
  ds_write_b16 v13, v27 offset:25052
  ds_write_b16 v13, v26 offset:12522
  ds_write_b16 v13, v27 offset:29226
  v_add_u32 v11, 1920, v1
  v_cvt_f32_u32 v11, v11
  v_cvt_pk_bf16_f32 v11, v11, v11
  v_lshlrev_b32 v11, 16, v11
  v_cvt_u32_f32 v11, v11
  v_subrev_u32 v11, 1024, v11
  v_lshrrev_b32 v11, 3, v11
  v_lshlrev_b32 v11, 2, v11
  v_add_u32 v11, s42, v11
  ds_read_b32 v22, v11 offset:35456
  s_waitcnt lgkmcnt(0)
  v_cvt_pk_bf16_f32 v24, v22, v22
  v_lshlrev_b32 v12, 16, v24
  v_sub_f32 v12, v22, v12
  v_cvt_pk_bf16_f32 v25, v12, v12
  v_add_u32 v13, 256, v10
  ds_write_b16 v13, v24 offset:0
  ds_write_b16 v13, v25 offset:16704
  ds_write_b16 v13, v24 offset:4174
  ds_write_b16 v13, v25 offset:20878
  ds_write_b16 v13, v24 offset:8348
  ds_write_b16 v13, v25 offset:25052
  ds_write_b16 v13, v24 offset:12522
  ds_write_b16 v13, v25 offset:29226
  v_add_u32 v11, 1984, v1
  v_cvt_f32_u32 v11, v11
  v_cvt_pk_bf16_f32 v11, v11, v11
  v_lshlrev_b32 v11, 16, v11
  v_cvt_u32_f32 v11, v11
  v_subrev_u32 v11, 1024, v11
  v_lshrrev_b32 v11, 3, v11
  v_lshlrev_b32 v11, 2, v11
  v_add_u32 v11, s42, v11
  ds_read_b32 v23, v11 offset:35456
  s_waitcnt lgkmcnt(0)
  v_cvt_pk_bf16_f32 v26, v23, v23
  v_lshlrev_b32 v12, 16, v26
  v_sub_f32 v12, v23, v12
  v_cvt_pk_bf16_f32 v27, v12, v12
  v_add_u32 v13, 128, v10
  ds_write_b16 v13, v26 offset:0
  ds_write_b16 v13, v27 offset:16704
  ds_write_b16 v13, v26 offset:4174
  ds_write_b16 v13, v27 offset:20878
  ds_write_b16 v13, v26 offset:8348
  ds_write_b16 v13, v27 offset:25052
  ds_write_b16 v13, v26 offset:12522
  ds_write_b16 v13, v27 offset:29226
  s_waitcnt lgkmcnt(0)
  s_barrier
  v_mov_b32 v20, 0
  v_mov_b32 v21, 0
  v_mov_b32 v22, 0
  v_mov_b32 v23, 0
  v_lshlrev_b32 v14, 4, v1
  v_add_u32 v14, s42, v14
  ds_write_b128 v14, v[20:23] offset:33408
  ds_write_b128 v14, v[20:23] offset:34432
  s_mov_b32 s4, s60
  s_mov_b32 s5, s61
  s_mov_b32 s6, 2359296
  s_mov_b32 s7, 0x00020000
  v_mul_u32_u24 v15, 1152, v1
  s_mul_i32 s43, s3, 589824
  s_lshl_b32 s66, s40, 3
  s_add_u32 s43, s43, s66
  s_add_u32 s67, s43, 0
  buffer_load_dwordx2 v[32:33], v15, s[4:7], s67 offen
  s_add_u32 s67, s43, 73728
  buffer_load_dwordx2 v[34:35], v15, s[4:7], s67 offen
  s_add_u32 s67, s43, 147456
  buffer_load_dwordx2 v[36:37], v15, s[4:7], s67 offen
  s_add_u32 s67, s43, 221184
  buffer_load_dwordx2 v[38:39], v15, s[4:7], s67 offen
  s_add_u32 s67, s43, 294912
  buffer_load_dwordx2 v[40:41], v15, s[4:7], s67 offen
  s_add_u32 s67, s43, 368640
  buffer_load_dwordx2 v[42:43], v15, s[4:7], s67 offen
  s_add_u32 s67, s43, 442368
  buffer_load_dwordx2 v[44:45], v15, s[4:7], s67 offen
  s_add_u32 s67, s43, 516096
  buffer_load_dwordx2 v[46:47], v15, s[4:7], s67 offen
  s_lshl_b32 s67, s3, 10
  v_lshlrev_b32 v16, 1, v1
  v_add_u32 v16, s67, v16
  v_add_u32 v16, 35456, v16
  v_add_u32 v17, 79104, v16
  s_waitcnt vmcnt(7)
  ds_write_b16 v16, v32 offset:0
  ds_write_b16_d16_hi v16, v32 offset:39552
  ds_write_b16 v17, v33 offset:0
  ds_write_b16_d16_hi v17, v33 offset:39552
  s_waitcnt vmcnt(6)
  ds_write_b16 v16, v34 offset:128
  ds_write_b16_d16_hi v16, v34 offset:39680
  ds_write_b16 v17, v35 offset:128
  ds_write_b16_d16_hi v17, v35 offset:39680
  s_waitcnt vmcnt(5)
  ds_write_b16 v16, v36 offset:256
  ds_write_b16_d16_hi v16, v36 offset:39808
  ds_write_b16 v17, v37 offset:256
  ds_write_b16_d16_hi v17, v37 offset:39808
  s_waitcnt vmcnt(4)
  ds_write_b16 v16, v38 offset:384
  ds_write_b16_d16_hi v16, v38 offset:39936
  ds_write_b16 v17, v39 offset:384
  ds_write_b16_d16_hi v17, v39 offset:39936
  s_waitcnt vmcnt(3)
  ds_write_b16 v16, v40 offset:512
  ds_write_b16_d16_hi v16, v40 offset:40064
  ds_write_b16 v17, v41 offset:512
  ds_write_b16_d16_hi v17, v41 offset:40064
  s_waitcnt vmcnt(2)
  ds_write_b16 v16, v42 offset:640
  ds_write_b16_d16_hi v16, v42 offset:40192
  ds_write_b16 v17, v43 offset:640
  ds_write_b16_d16_hi v17, v43 offset:40192
  s_waitcnt vmcnt(1)
  ds_write_b16 v16, v44 offset:768
  ds_write_b16_d16_hi v16, v44 offset:40320
  ds_write_b16 v17, v45 offset:768
  ds_write_b16_d16_hi v17, v45 offset:40320
  s_waitcnt vmcnt(0)
  ds_write_b16 v16, v46 offset:896
  ds_write_b16_d16_hi v16, v46 offset:40448
  ds_write_b16 v17, v47 offset:896
  ds_write_b16_d16_hi v17, v47 offset:40448
  s_waitcnt lgkmcnt(0)
  s_barrier
  v_and_b32 v20, 31, v1
  v_lshrrev_b32 v21, 5, v1
  v_sub_u32 v22, 0, v20
  v_and_b32 v22, 3, v22
  v_mul_u32_u24 v23, 4174, v22
  v_lshlrev_b32 v24, 1, v20
  v_sub_u32 v23, v23, v24
  v_lshlrev_b32 v24, 4, v21
  v_add_u32 v23, v23, v24
  v_add_u32 v23, 3648, v23
  v_add_u32 v18, s42, v23
  v_add_u32 v19, 16704, v18
  v_lshlrev_b32 v23, 6, v20
  v_add_u32 v23, v23, v24
  v_add_u32 v23, 35008, v23
  v_add_u32 v25, s42, v23
  v_mov_b32 v128, 0
  v_mov_b32 v129, 0
  v_mov_b32 v130, 0
  v_mov_b32 v131, 0
  v_mov_b32 v132, 0
  v_mov_b32 v133, 0
  v_mov_b32 v134, 0
  v_mov_b32 v135, 0
  v_mov_b32 v136, 0
  v_mov_b32 v137, 0
  v_mov_b32 v138, 0
  v_mov_b32 v139, 0
  v_mov_b32 v140, 0
  v_mov_b32 v141, 0
  v_mov_b32 v142, 0
  v_mov_b32 v143, 0
  v_mov_b32 v144, 0
  v_mov_b32 v145, 0
  v_mov_b32 v146, 0
  v_mov_b32 v147, 0
  v_mov_b32 v148, 0
  v_mov_b32 v149, 0
  v_mov_b32 v150, 0
  v_mov_b32 v151, 0
  v_mov_b32 v152, 0
  v_mov_b32 v153, 0
  v_mov_b32 v154, 0
  v_mov_b32 v155, 0
  v_mov_b32 v156, 0
  v_mov_b32 v157, 0
  v_mov_b32 v158, 0
  v_mov_b32 v159, 0
  s_mov_b32 s66, 0
  s_nop 0
S_C_36:
  ds_read2_b64 v[32:35], v18 offset0:60 offset1:61
  ds_read2_b64 v[36:39], v19 offset0:60 offset1:61
  ds_read_b128 v[40:43], v25 offset:2528
  ds_read_b128 v[44:47], v25 offset:480
  ds_read2_b64 v[48:51], v18 offset0:56 offset1:57
  ds_read2_b64 v[52:55], v19 offset0:56 offset1:57
  ds_read_b128 v[56:59], v25 offset:2496
  ds_read_b128 v[60:63], v25 offset:448
  ds_read2_b64 v[64:67], v18 offset0:52 offset1:53
  ds_read2_b64 v[68:71], v19 offset0:52 offset1:53
  ds_read_b128 v[72:75], v25 offset:2464
  ds_read_b128 v[76:79], v25 offset:416
  s_waitcnt lgkmcnt(9)
  v_mfma_f32_32x32x16_bf16 v[144:159], v[32:35], v[40:43], v[144:159]
  s_waitcnt lgkmcnt(8)
  v_mfma_f32_32x32x16_bf16 v[128:143], v[32:35], v[44:47], v[128:143]
  v_mfma_f32_32x32x16_bf16 v[144:159], v[36:39], v[40:43], v[144:159]
  v_mfma_f32_32x32x16_bf16 v[128:143], v[36:39], v[44:47], v[128:143]
  ds_read2_b64 v[80:83], v18 offset0:48 offset1:49
  ds_read2_b64 v[84:87], v19 offset0:48 offset1:49
  ds_read_b128 v[88:91], v25 offset:2432
  ds_read_b128 v[92:95], v25 offset:384
  s_waitcnt lgkmcnt(9)
  v_mfma_f32_32x32x16_bf16 v[144:159], v[48:51], v[56:59], v[144:159]
  s_waitcnt lgkmcnt(8)
  v_mfma_f32_32x32x16_bf16 v[128:143], v[48:51], v[60:63], v[128:143]
  v_mfma_f32_32x32x16_bf16 v[144:159], v[52:55], v[56:59], v[144:159]
  v_mfma_f32_32x32x16_bf16 v[128:143], v[52:55], v[60:63], v[128:143]
  ds_read2_b64 v[32:35], v18 offset0:44 offset1:45
  ds_read2_b64 v[36:39], v19 offset0:44 offset1:45
  ds_read_b128 v[40:43], v25 offset:2400
  ds_read_b128 v[44:47], v25 offset:352
  s_waitcnt lgkmcnt(9)
  v_mfma_f32_32x32x16_bf16 v[144:159], v[64:67], v[72:75], v[144:159]
  s_waitcnt lgkmcnt(8)
  v_mfma_f32_32x32x16_bf16 v[128:143], v[64:67], v[76:79], v[128:143]
  v_mfma_f32_32x32x16_bf16 v[144:159], v[68:71], v[72:75], v[144:159]
  v_mfma_f32_32x32x16_bf16 v[128:143], v[68:71], v[76:79], v[128:143]
  ds_read2_b64 v[48:51], v18 offset0:40 offset1:41
  ds_read2_b64 v[52:55], v19 offset0:40 offset1:41
  ds_read_b128 v[56:59], v25 offset:2368
  ds_read_b128 v[60:63], v25 offset:320
  s_waitcnt lgkmcnt(9)
  v_mfma_f32_32x32x16_bf16 v[144:159], v[80:83], v[88:91], v[144:159]
  s_waitcnt lgkmcnt(8)
  v_mfma_f32_32x32x16_bf16 v[128:143], v[80:83], v[92:95], v[128:143]
  v_mfma_f32_32x32x16_bf16 v[144:159], v[84:87], v[88:91], v[144:159]
  v_mfma_f32_32x32x16_bf16 v[128:143], v[84:87], v[92:95], v[128:143]
  ds_read2_b64 v[64:67], v18 offset0:36 offset1:37
  ds_read2_b64 v[68:71], v19 offset0:36 offset1:37
  ds_read_b128 v[72:75], v25 offset:2336
  ds_read_b128 v[76:79], v25 offset:288
  s_waitcnt lgkmcnt(9)
  v_mfma_f32_32x32x16_bf16 v[144:159], v[32:35], v[40:43], v[144:159]
  s_waitcnt lgkmcnt(8)
  v_mfma_f32_32x32x16_bf16 v[128:143], v[32:35], v[44:47], v[128:143]
  v_mfma_f32_32x32x16_bf16 v[144:159], v[36:39], v[40:43], v[144:159]
  v_mfma_f32_32x32x16_bf16 v[128:143], v[36:39], v[44:47], v[128:143]
  ds_read2_b64 v[80:83], v18 offset0:32 offset1:33
  ds_read2_b64 v[84:87], v19 offset0:32 offset1:33
  ds_read_b128 v[88:91], v25 offset:2304
  ds_read_b128 v[92:95], v25 offset:256
  s_waitcnt lgkmcnt(9)
  v_mfma_f32_32x32x16_bf16 v[144:159], v[48:51], v[56:59], v[144:159]
  s_waitcnt lgkmcnt(8)
  v_mfma_f32_32x32x16_bf16 v[128:143], v[48:51], v[60:63], v[128:143]
  v_mfma_f32_32x32x16_bf16 v[144:159], v[52:55], v[56:59], v[144:159]
  v_mfma_f32_32x32x16_bf16 v[128:143], v[52:55], v[60:63], v[128:143]
  ds_read2_b64 v[32:35], v18 offset0:28 offset1:29
  ds_read2_b64 v[36:39], v19 offset0:28 offset1:29
  ds_read_b128 v[40:43], v25 offset:2272
  ds_read_b128 v[44:47], v25 offset:224
  s_waitcnt lgkmcnt(9)
  v_mfma_f32_32x32x16_bf16 v[144:159], v[64:67], v[72:75], v[144:159]
  s_waitcnt lgkmcnt(8)
  v_mfma_f32_32x32x16_bf16 v[128:143], v[64:67], v[76:79], v[128:143]
  v_mfma_f32_32x32x16_bf16 v[144:159], v[68:71], v[72:75], v[144:159]
  v_mfma_f32_32x32x16_bf16 v[128:143], v[68:71], v[76:79], v[128:143]
  ds_read2_b64 v[48:51], v18 offset0:24 offset1:25
  ds_read2_b64 v[52:55], v19 offset0:24 offset1:25
  ds_read_b128 v[56:59], v25 offset:2240
  ds_read_b128 v[60:63], v25 offset:192
  s_waitcnt lgkmcnt(9)
  v_mfma_f32_32x32x16_bf16 v[144:159], v[80:83], v[88:91], v[144:159]
  s_waitcnt lgkmcnt(8)
  v_mfma_f32_32x32x16_bf16 v[128:143], v[80:83], v[92:95], v[128:143]
  v_mfma_f32_32x32x16_bf16 v[144:159], v[84:87], v[88:91], v[144:159]
  v_mfma_f32_32x32x16_bf16 v[128:143], v[84:87], v[92:95], v[128:143]
  ds_read2_b64 v[64:67], v18 offset0:20 offset1:21
  ds_read2_b64 v[68:71], v19 offset0:20 offset1:21
  ds_read_b128 v[72:75], v25 offset:2208
  ds_read_b128 v[76:79], v25 offset:160
  s_waitcnt lgkmcnt(9)
  v_mfma_f32_32x32x16_bf16 v[144:159], v[32:35], v[40:43], v[144:159]
  s_waitcnt lgkmcnt(8)
  v_mfma_f32_32x32x16_bf16 v[128:143], v[32:35], v[44:47], v[128:143]
  v_mfma_f32_32x32x16_bf16 v[144:159], v[36:39], v[40:43], v[144:159]
  v_mfma_f32_32x32x16_bf16 v[128:143], v[36:39], v[44:47], v[128:143]
  ds_read2_b64 v[80:83], v18 offset0:16 offset1:17
  ds_read2_b64 v[84:87], v19 offset0:16 offset1:17
  ds_read_b128 v[88:91], v25 offset:2176
  ds_read_b128 v[92:95], v25 offset:128
  s_waitcnt lgkmcnt(9)
  v_mfma_f32_32x32x16_bf16 v[144:159], v[48:51], v[56:59], v[144:159]
  s_waitcnt lgkmcnt(8)
  v_mfma_f32_32x32x16_bf16 v[128:143], v[48:51], v[60:63], v[128:143]
  v_mfma_f32_32x32x16_bf16 v[144:159], v[52:55], v[56:59], v[144:159]
  v_mfma_f32_32x32x16_bf16 v[128:143], v[52:55], v[60:63], v[128:143]
  ds_read2_b64 v[32:35], v18 offset0:12 offset1:13
  ds_read2_b64 v[36:39], v19 offset0:12 offset1:13
  ds_read_b128 v[40:43], v25 offset:2144
  ds_read_b128 v[44:47], v25 offset:96
  s_waitcnt lgkmcnt(9)
  v_mfma_f32_32x32x16_bf16 v[144:159], v[64:67], v[72:75], v[144:159]
  s_waitcnt lgkmcnt(8)
  v_mfma_f32_32x32x16_bf16 v[128:143], v[64:67], v[76:79], v[128:143]
  v_mfma_f32_32x32x16_bf16 v[144:159], v[68:71], v[72:75], v[144:159]
  v_mfma_f32_32x32x16_bf16 v[128:143], v[68:71], v[76:79], v[128:143]
  ds_read2_b64 v[48:51], v18 offset0:8 offset1:9
  ds_read2_b64 v[52:55], v19 offset0:8 offset1:9
  ds_read_b128 v[56:59], v25 offset:2112
  ds_read_b128 v[60:63], v25 offset:64
  s_waitcnt lgkmcnt(9)
  v_mfma_f32_32x32x16_bf16 v[144:159], v[80:83], v[88:91], v[144:159]
  s_waitcnt lgkmcnt(8)
  v_mfma_f32_32x32x16_bf16 v[128:143], v[80:83], v[92:95], v[128:143]
  v_mfma_f32_32x32x16_bf16 v[144:159], v[84:87], v[88:91], v[144:159]
  v_mfma_f32_32x32x16_bf16 v[128:143], v[84:87], v[92:95], v[128:143]
  ds_read2_b64 v[64:67], v18 offset0:4 offset1:5
  ds_read2_b64 v[68:71], v19 offset0:4 offset1:5
  ds_read_b128 v[72:75], v25 offset:2080
  ds_read_b128 v[76:79], v25 offset:32
  s_waitcnt lgkmcnt(9)
  v_mfma_f32_32x32x16_bf16 v[144:159], v[32:35], v[40:43], v[144:159]
  s_waitcnt lgkmcnt(8)
  v_mfma_f32_32x32x16_bf16 v[128:143], v[32:35], v[44:47], v[128:143]
  v_mfma_f32_32x32x16_bf16 v[144:159], v[36:39], v[40:43], v[144:159]
  v_mfma_f32_32x32x16_bf16 v[128:143], v[36:39], v[44:47], v[128:143]
  ds_read2_b64 v[80:83], v18 offset0:0 offset1:1
  ds_read2_b64 v[84:87], v19 offset0:0 offset1:1
  ds_read_b128 v[88:91], v25 offset:2048
  ds_read_b128 v[92:95], v25 offset:0
  s_waitcnt lgkmcnt(9)
  v_mfma_f32_32x32x16_bf16 v[144:159], v[48:51], v[56:59], v[144:159]
  s_waitcnt lgkmcnt(8)
  v_mfma_f32_32x32x16_bf16 v[128:143], v[48:51], v[60:63], v[128:143]
  v_mfma_f32_32x32x16_bf16 v[144:159], v[52:55], v[56:59], v[144:159]
  v_mfma_f32_32x32x16_bf16 v[128:143], v[52:55], v[60:63], v[128:143]
  s_waitcnt lgkmcnt(5)
  v_mfma_f32_32x32x16_bf16 v[144:159], v[64:67], v[72:75], v[144:159]
  s_waitcnt lgkmcnt(4)
  v_mfma_f32_32x32x16_bf16 v[128:143], v[64:67], v[76:79], v[128:143]
  v_mfma_f32_32x32x16_bf16 v[144:159], v[68:71], v[72:75], v[144:159]
  v_mfma_f32_32x32x16_bf16 v[128:143], v[68:71], v[76:79], v[128:143]
  s_waitcnt lgkmcnt(1)
  v_mfma_f32_32x32x16_bf16 v[144:159], v[80:83], v[88:91], v[144:159]
  s_waitcnt lgkmcnt(0)
  v_mfma_f32_32x32x16_bf16 v[128:143], v[80:83], v[92:95], v[128:143]
  v_mfma_f32_32x32x16_bf16 v[144:159], v[84:87], v[88:91], v[144:159]
  v_mfma_f32_32x32x16_bf16 v[128:143], v[84:87], v[92:95], v[128:143]
  v_subrev_u32 v18, 512, v18
  v_subrev_u32 v19, 512, v19
  v_subrev_u32 v25, 512, v25
  s_add_u32 s66, s66, 1
  s_cmp_lt_u32 s66, 4
  s_nop 6
  s_cbranch_scc1 S_C_36
  s_mov_b32 s66, 0
S_D_37:
  ds_read2_b64 v[32:35], v18 offset0:60 offset1:61
  ds_read2_b64 v[36:39], v19 offset0:60 offset1:61
  ds_read_b128 v[40:43], v25 offset:2528
  ds_read2_b64 v[48:51], v18 offset0:56 offset1:57
  ds_read2_b64 v[52:55], v19 offset0:56 offset1:57
  ds_read_b128 v[56:59], v25 offset:2496
  ds_read2_b64 v[64:67], v18 offset0:52 offset1:53
  ds_read2_b64 v[68:71], v19 offset0:52 offset1:53
  ds_read_b128 v[72:75], v25 offset:2464
  s_waitcnt lgkmcnt(6)
  v_mfma_f32_32x32x16_bf16 v[144:159], v[32:35], v[40:43], v[144:159]
  v_mfma_f32_32x32x16_bf16 v[144:159], v[36:39], v[40:43], v[144:159]
  ds_read2_b64 v[80:83], v18 offset0:48 offset1:49
  ds_read2_b64 v[84:87], v19 offset0:48 offset1:49
  ds_read_b128 v[88:91], v25 offset:2432
  s_waitcnt lgkmcnt(6)
  v_mfma_f32_32x32x16_bf16 v[144:159], v[48:51], v[56:59], v[144:159]
  v_mfma_f32_32x32x16_bf16 v[144:159], v[52:55], v[56:59], v[144:159]
  ds_read2_b64 v[32:35], v18 offset0:44 offset1:45
  ds_read2_b64 v[36:39], v19 offset0:44 offset1:45
  ds_read_b128 v[40:43], v25 offset:2400
  s_waitcnt lgkmcnt(6)
  v_mfma_f32_32x32x16_bf16 v[144:159], v[64:67], v[72:75], v[144:159]
  v_mfma_f32_32x32x16_bf16 v[144:159], v[68:71], v[72:75], v[144:159]
  ds_read2_b64 v[48:51], v18 offset0:40 offset1:41
  ds_read2_b64 v[52:55], v19 offset0:40 offset1:41
  ds_read_b128 v[56:59], v25 offset:2368
  s_waitcnt lgkmcnt(6)
  v_mfma_f32_32x32x16_bf16 v[144:159], v[80:83], v[88:91], v[144:159]
  v_mfma_f32_32x32x16_bf16 v[144:159], v[84:87], v[88:91], v[144:159]
  ds_read2_b64 v[64:67], v18 offset0:36 offset1:37
  ds_read2_b64 v[68:71], v19 offset0:36 offset1:37
  ds_read_b128 v[72:75], v25 offset:2336
  s_waitcnt lgkmcnt(6)
  v_mfma_f32_32x32x16_bf16 v[144:159], v[32:35], v[40:43], v[144:159]
  v_mfma_f32_32x32x16_bf16 v[144:159], v[36:39], v[40:43], v[144:159]
  ds_read2_b64 v[80:83], v18 offset0:32 offset1:33
  ds_read2_b64 v[84:87], v19 offset0:32 offset1:33
  ds_read_b128 v[88:91], v25 offset:2304
  s_waitcnt lgkmcnt(6)
  v_mfma_f32_32x32x16_bf16 v[144:159], v[48:51], v[56:59], v[144:159]
  v_mfma_f32_32x32x16_bf16 v[144:159], v[52:55], v[56:59], v[144:159]
  ds_read2_b64 v[32:35], v18 offset0:28 offset1:29
  ds_read2_b64 v[36:39], v19 offset0:28 offset1:29
  ds_read_b128 v[40:43], v25 offset:2272
  s_waitcnt lgkmcnt(6)
  v_mfma_f32_32x32x16_bf16 v[144:159], v[64:67], v[72:75], v[144:159]
  v_mfma_f32_32x32x16_bf16 v[144:159], v[68:71], v[72:75], v[144:159]
  ds_read2_b64 v[48:51], v18 offset0:24 offset1:25
  ds_read2_b64 v[52:55], v19 offset0:24 offset1:25
  ds_read_b128 v[56:59], v25 offset:2240
  s_waitcnt lgkmcnt(6)
  v_mfma_f32_32x32x16_bf16 v[144:159], v[80:83], v[88:91], v[144:159]
  v_mfma_f32_32x32x16_bf16 v[144:159], v[84:87], v[88:91], v[144:159]
  ds_read2_b64 v[64:67], v18 offset0:20 offset1:21
  ds_read2_b64 v[68:71], v19 offset0:20 offset1:21
  ds_read_b128 v[72:75], v25 offset:2208
  s_waitcnt lgkmcnt(6)
  v_mfma_f32_32x32x16_bf16 v[144:159], v[32:35], v[40:43], v[144:159]
  v_mfma_f32_32x32x16_bf16 v[144:159], v[36:39], v[40:43], v[144:159]
  ds_read2_b64 v[80:83], v18 offset0:16 offset1:17
  ds_read2_b64 v[84:87], v19 offset0:16 offset1:17
  ds_read_b128 v[88:91], v25 offset:2176
  s_waitcnt lgkmcnt(6)
  v_mfma_f32_32x32x16_bf16 v[144:159], v[48:51], v[56:59], v[144:159]
  v_mfma_f32_32x32x16_bf16 v[144:159], v[52:55], v[56:59], v[144:159]
  ds_read2_b64 v[32:35], v18 offset0:12 offset1:13
  ds_read2_b64 v[36:39], v19 offset0:12 offset1:13
  ds_read_b128 v[40:43], v25 offset:2144
  s_waitcnt lgkmcnt(6)
  v_mfma_f32_32x32x16_bf16 v[144:159], v[64:67], v[72:75], v[144:159]
  v_mfma_f32_32x32x16_bf16 v[144:159], v[68:71], v[72:75], v[144:159]
  ds_read2_b64 v[48:51], v18 offset0:8 offset1:9
  ds_read2_b64 v[52:55], v19 offset0:8 offset1:9
  ds_read_b128 v[56:59], v25 offset:2112
  s_waitcnt lgkmcnt(6)
  v_mfma_f32_32x32x16_bf16 v[144:159], v[80:83], v[88:91], v[144:159]
  v_mfma_f32_32x32x16_bf16 v[144:159], v[84:87], v[88:91], v[144:159]
  ds_read2_b64 v[64:67], v18 offset0:4 offset1:5
  ds_read2_b64 v[68:71], v19 offset0:4 offset1:5
  ds_read_b128 v[72:75], v25 offset:2080
  s_waitcnt lgkmcnt(6)
  v_mfma_f32_32x32x16_bf16 v[144:159], v[32:35], v[40:43], v[144:159]
  v_mfma_f32_32x32x16_bf16 v[144:159], v[36:39], v[40:43], v[144:159]
  ds_read2_b64 v[80:83], v18 offset0:0 offset1:1
  ds_read2_b64 v[84:87], v19 offset0:0 offset1:1
  ds_read_b128 v[88:91], v25 offset:2048
  s_waitcnt lgkmcnt(6)
  v_mfma_f32_32x32x16_bf16 v[144:159], v[48:51], v[56:59], v[144:159]
  v_mfma_f32_32x32x16_bf16 v[144:159], v[52:55], v[56:59], v[144:159]
  s_waitcnt lgkmcnt(3)
  v_mfma_f32_32x32x16_bf16 v[144:159], v[64:67], v[72:75], v[144:159]
  v_mfma_f32_32x32x16_bf16 v[144:159], v[68:71], v[72:75], v[144:159]
  s_waitcnt lgkmcnt(0)
  v_mfma_f32_32x32x16_bf16 v[144:159], v[80:83], v[88:91], v[144:159]
  v_mfma_f32_32x32x16_bf16 v[144:159], v[84:87], v[88:91], v[144:159]
  v_subrev_u32 v18, 512, v18
  v_subrev_u32 v19, 512, v19
  v_subrev_u32 v25, 512, v25
  s_add_u32 s66, s66, 1
  s_cmp_lt_u32 s66, 4
  s_nop 6
  s_cbranch_scc1 S_D_37
  s_barrier
  v_lshlrev_b32 v23, 8, v20
  v_lshlrev_b32 v24, 5, v21
  v_add_u32 v23, v23, v24
  s_lshl_b32 s67, s3, 1
  v_add_u32 v23, s67, v23
  v_cvt_pk_bf16_f32 v32, v128, v128
  ds_write_b16 v23, v32 offset:0
  v_cvt_pk_bf16_f32 v33, v129, v129
  ds_write_b16 v23, v33 offset:8
  v_cvt_pk_bf16_f32 v34, v130, v130
  ds_write_b16 v23, v34 offset:16
  v_cvt_pk_bf16_f32 v35, v131, v131
  ds_write_b16 v23, v35 offset:24
  v_cvt_pk_bf16_f32 v32, v132, v132
  ds_write_b16 v23, v32 offset:64
  v_cvt_pk_bf16_f32 v33, v133, v133
  ds_write_b16 v23, v33 offset:72
  v_cvt_pk_bf16_f32 v34, v134, v134
  ds_write_b16 v23, v34 offset:80
  v_cvt_pk_bf16_f32 v35, v135, v135
  ds_write_b16 v23, v35 offset:88
  v_cvt_pk_bf16_f32 v32, v136, v136
  ds_write_b16 v23, v32 offset:128
  v_cvt_pk_bf16_f32 v33, v137, v137
  ds_write_b16 v23, v33 offset:136
  v_cvt_pk_bf16_f32 v34, v138, v138
  ds_write_b16 v23, v34 offset:144
  v_cvt_pk_bf16_f32 v35, v139, v139
  ds_write_b16 v23, v35 offset:152
  v_cvt_pk_bf16_f32 v32, v140, v140
  ds_write_b16 v23, v32 offset:192
  v_cvt_pk_bf16_f32 v33, v141, v141
  ds_write_b16 v23, v33 offset:200
  v_cvt_pk_bf16_f32 v34, v142, v142
  ds_write_b16 v23, v34 offset:208
  v_cvt_pk_bf16_f32 v35, v143, v143
  ds_write_b16 v23, v35 offset:216
  v_cvt_pk_bf16_f32 v32, v144, v144
  ds_write_b16 v23, v32 offset:8192
  v_cvt_pk_bf16_f32 v33, v145, v145
  ds_write_b16 v23, v33 offset:8200
  v_cvt_pk_bf16_f32 v34, v146, v146
  ds_write_b16 v23, v34 offset:8208
  v_cvt_pk_bf16_f32 v35, v147, v147
  ds_write_b16 v23, v35 offset:8216
  v_cvt_pk_bf16_f32 v32, v148, v148
  ds_write_b16 v23, v32 offset:8256
  v_cvt_pk_bf16_f32 v33, v149, v149
  ds_write_b16 v23, v33 offset:8264
  v_cvt_pk_bf16_f32 v34, v150, v150
  ds_write_b16 v23, v34 offset:8272
  v_cvt_pk_bf16_f32 v35, v151, v151
  ds_write_b16 v23, v35 offset:8280
  v_cvt_pk_bf16_f32 v32, v152, v152
  ds_write_b16 v23, v32 offset:8320
  v_cvt_pk_bf16_f32 v33, v153, v153
  ds_write_b16 v23, v33 offset:8328
  v_cvt_pk_bf16_f32 v34, v154, v154
  ds_write_b16 v23, v34 offset:8336
  v_cvt_pk_bf16_f32 v35, v155, v155
  ds_write_b16 v23, v35 offset:8344
  v_cvt_pk_bf16_f32 v32, v156, v156
  ds_write_b16 v23, v32 offset:8384
  v_cvt_pk_bf16_f32 v33, v157, v157
  ds_write_b16 v23, v33 offset:8392
  v_cvt_pk_bf16_f32 v34, v158, v158
  ds_write_b16 v23, v34 offset:8400
  v_cvt_pk_bf16_f32 v35, v159, v159
  ds_write_b16 v23, v35 offset:8408
  s_waitcnt lgkmcnt(0)
  s_barrier
  s_mov_b32 s8, s58
  s_mov_b32 s9, s59
  s_mov_b32 s10, 1152
  s_mov_b32 s11, 0x00020000
  s_lshl_b32 s66, s40, 3
  v_mov_b32 v3, s66
  buffer_load_dwordx2 v[10:11], v3, s[8:11], 0 offen
  s_add_u32 s67, s43, 0
  buffer_load_dwordx2 v[32:33], v15, s[4:7], s67 offen
  s_add_u32 s67, s43, 73728
  buffer_load_dwordx2 v[34:35], v15, s[4:7], s67 offen
  s_add_u32 s67, s43, 147456
  buffer_load_dwordx2 v[36:37], v15, s[4:7], s67 offen
  s_add_u32 s67, s43, 221184
  buffer_load_dwordx2 v[38:39], v15, s[4:7], s67 offen
  s_add_u32 s67, s43, 294912
  buffer_load_dwordx2 v[40:41], v15, s[4:7], s67 offen
  s_add_u32 s67, s43, 368640
  buffer_load_dwordx2 v[42:43], v15, s[4:7], s67 offen
  s_add_u32 s67, s43, 442368
  buffer_load_dwordx2 v[44:45], v15, s[4:7], s67 offen
  s_add_u32 s67, s43, 516096
  buffer_load_dwordx2 v[46:47], v15, s[4:7], s67 offen
  s_lshl_b32 s67, s3, 12
  v_lshlrev_b32 v16, 3, v1
  v_add_u32 v16, s67, v16
  ds_read_b64 v[48:49], v16 offset:0
  ds_read_b64 v[50:51], v16 offset:512
  ds_read_b64 v[52:53], v16 offset:1024
  ds_read_b64 v[54:55], v16 offset:1536
  ds_read_b64 v[56:57], v16 offset:2048
  ds_read_b64 v[58:59], v16 offset:2560
  ds_read_b64 v[60:61], v16 offset:3072
  ds_read_b64 v[62:63], v16 offset:3584
  s_mov_b32 s8, s62
  s_mov_b32 s9, s63
  s_mov_b32 s10, 4718592
  s_mov_b32 s11, 0x00020000
  s_waitcnt vmcnt(8)
  v_lshlrev_b32 v12, 16, v10
  v_and_b32 v13, 0xffff0000, v10
  v_lshlrev_b32 v20, 16, v11
  v_and_b32 v21, 0xffff0000, v11
  v_mul_u32_u24 v15, 2304, v1
  s_mul_i32 s43, s3, 1179648
  s_add_u32 s43, s43, s66
  s_add_u32 s43, s43, 1152
  s_waitcnt vmcnt(7)
  v_lshlrev_b32 v22, 16, v32
  v_and_b32 v23, 0xffff0000, v32
  v_mul_f32 v22, v22, v12
  v_mul_f32 v23, v23, v13
  v_cvt_pk_bf16_f32 v22, v22, v23
  v_lshlrev_b32 v24, 16, v22
  v_and_b32 v25, 0xffff0000, v22
  s_waitcnt lgkmcnt(7)
  v_lshlrev_b32 v22, 16, v48
  v_and_b32 v23, 0xffff0000, v48
  v_add_f32 v22, v22, v24
  v_add_f32 v23, v23, v25
  v_cvt_pk_bf16_f32 v32, v22, v23
  v_lshlrev_b32 v22, 16, v33
  v_and_b32 v23, 0xffff0000, v33
  v_mul_f32 v22, v22, v20
  v_mul_f32 v23, v23, v21
  v_cvt_pk_bf16_f32 v22, v22, v23
  v_lshlrev_b32 v24, 16, v22
  v_and_b32 v25, 0xffff0000, v22
  v_lshlrev_b32 v22, 16, v49
  v_and_b32 v23, 0xffff0000, v49
  v_add_f32 v22, v22, v24
  v_add_f32 v23, v23, v25
  v_cvt_pk_bf16_f32 v33, v22, v23
  s_add_u32 s67, s43, 0
  buffer_store_dwordx2 v[32:33], v15, s[8:11], s67 offen
  s_waitcnt vmcnt(7)
  v_lshlrev_b32 v22, 16, v34
  v_and_b32 v23, 0xffff0000, v34
  v_mul_f32 v22, v22, v12
  v_mul_f32 v23, v23, v13
  v_cvt_pk_bf16_f32 v22, v22, v23
  v_lshlrev_b32 v24, 16, v22
  v_and_b32 v25, 0xffff0000, v22
  s_waitcnt lgkmcnt(6)
  v_lshlrev_b32 v22, 16, v50
  v_and_b32 v23, 0xffff0000, v50
  v_add_f32 v22, v22, v24
  v_add_f32 v23, v23, v25
  v_cvt_pk_bf16_f32 v34, v22, v23
  v_lshlrev_b32 v22, 16, v35
  v_and_b32 v23, 0xffff0000, v35
  v_mul_f32 v22, v22, v20
  v_mul_f32 v23, v23, v21
  v_cvt_pk_bf16_f32 v22, v22, v23
  v_lshlrev_b32 v24, 16, v22
  v_and_b32 v25, 0xffff0000, v22
  v_lshlrev_b32 v22, 16, v51
  v_and_b32 v23, 0xffff0000, v51
  v_add_f32 v22, v22, v24
  v_add_f32 v23, v23, v25
  v_cvt_pk_bf16_f32 v35, v22, v23
  s_add_u32 s67, s43, 147456
  buffer_store_dwordx2 v[34:35], v15, s[8:11], s67 offen
  s_waitcnt vmcnt(7)
  v_lshlrev_b32 v22, 16, v36
  v_and_b32 v23, 0xffff0000, v36
  v_mul_f32 v22, v22, v12
  v_mul_f32 v23, v23, v13
  v_cvt_pk_bf16_f32 v22, v22, v23
  v_lshlrev_b32 v24, 16, v22
  v_and_b32 v25, 0xffff0000, v22
  s_waitcnt lgkmcnt(5)
  v_lshlrev_b32 v22, 16, v52
  v_and_b32 v23, 0xffff0000, v52
  v_add_f32 v22, v22, v24
  v_add_f32 v23, v23, v25
  v_cvt_pk_bf16_f32 v36, v22, v23
  v_lshlrev_b32 v22, 16, v37
  v_and_b32 v23, 0xffff0000, v37
  v_mul_f32 v22, v22, v20
  v_mul_f32 v23, v23, v21
  v_cvt_pk_bf16_f32 v22, v22, v23
  v_lshlrev_b32 v24, 16, v22
  v_and_b32 v25, 0xffff0000, v22
  v_lshlrev_b32 v22, 16, v53
  v_and_b32 v23, 0xffff0000, v53
  v_add_f32 v22, v22, v24
  v_add_f32 v23, v23, v25
  v_cvt_pk_bf16_f32 v37, v22, v23
  s_add_u32 s67, s43, 294912
  buffer_store_dwordx2 v[36:37], v15, s[8:11], s67 offen
  s_waitcnt vmcnt(7)
  v_lshlrev_b32 v22, 16, v38
  v_and_b32 v23, 0xffff0000, v38
  v_mul_f32 v22, v22, v12
  v_mul_f32 v23, v23, v13
  v_cvt_pk_bf16_f32 v22, v22, v23
  v_lshlrev_b32 v24, 16, v22
  v_and_b32 v25, 0xffff0000, v22
  s_waitcnt lgkmcnt(4)
  v_lshlrev_b32 v22, 16, v54
  v_and_b32 v23, 0xffff0000, v54
  v_add_f32 v22, v22, v24
  v_add_f32 v23, v23, v25
  v_cvt_pk_bf16_f32 v38, v22, v23
  v_lshlrev_b32 v22, 16, v39
  v_and_b32 v23, 0xffff0000, v39
  v_mul_f32 v22, v22, v20
  v_mul_f32 v23, v23, v21
  v_cvt_pk_bf16_f32 v22, v22, v23
  v_lshlrev_b32 v24, 16, v22
  v_and_b32 v25, 0xffff0000, v22
  v_lshlrev_b32 v22, 16, v55
  v_and_b32 v23, 0xffff0000, v55
  v_add_f32 v22, v22, v24
  v_add_f32 v23, v23, v25
  v_cvt_pk_bf16_f32 v39, v22, v23
  s_add_u32 s67, s43, 442368
  buffer_store_dwordx2 v[38:39], v15, s[8:11], s67 offen
  s_waitcnt vmcnt(7)
  v_lshlrev_b32 v22, 16, v40
  v_and_b32 v23, 0xffff0000, v40
  v_mul_f32 v22, v22, v12
  v_mul_f32 v23, v23, v13
  v_cvt_pk_bf16_f32 v22, v22, v23
  v_lshlrev_b32 v24, 16, v22
  v_and_b32 v25, 0xffff0000, v22
  s_waitcnt lgkmcnt(3)
  v_lshlrev_b32 v22, 16, v56
  v_and_b32 v23, 0xffff0000, v56
  v_add_f32 v22, v22, v24
  v_add_f32 v23, v23, v25
  v_cvt_pk_bf16_f32 v40, v22, v23
  v_lshlrev_b32 v22, 16, v41
  v_and_b32 v23, 0xffff0000, v41
  v_mul_f32 v22, v22, v20
  v_mul_f32 v23, v23, v21
  v_cvt_pk_bf16_f32 v22, v22, v23
  v_lshlrev_b32 v24, 16, v22
  v_and_b32 v25, 0xffff0000, v22
  v_lshlrev_b32 v22, 16, v57
  v_and_b32 v23, 0xffff0000, v57
  v_add_f32 v22, v22, v24
  v_add_f32 v23, v23, v25
  v_cvt_pk_bf16_f32 v41, v22, v23
  s_add_u32 s67, s43, 589824
  buffer_store_dwordx2 v[40:41], v15, s[8:11], s67 offen
  s_waitcnt vmcnt(7)
  v_lshlrev_b32 v22, 16, v42
  v_and_b32 v23, 0xffff0000, v42
  v_mul_f32 v22, v22, v12
  v_mul_f32 v23, v23, v13
  v_cvt_pk_bf16_f32 v22, v22, v23
  v_lshlrev_b32 v24, 16, v22
  v_and_b32 v25, 0xffff0000, v22
  s_waitcnt lgkmcnt(2)
  v_lshlrev_b32 v22, 16, v58
  v_and_b32 v23, 0xffff0000, v58
  v_add_f32 v22, v22, v24
  v_add_f32 v23, v23, v25
  v_cvt_pk_bf16_f32 v42, v22, v23
  v_lshlrev_b32 v22, 16, v43
  v_and_b32 v23, 0xffff0000, v43
  v_mul_f32 v22, v22, v20
  v_mul_f32 v23, v23, v21
  v_cvt_pk_bf16_f32 v22, v22, v23
  v_lshlrev_b32 v24, 16, v22
  v_and_b32 v25, 0xffff0000, v22
  v_lshlrev_b32 v22, 16, v59
  v_and_b32 v23, 0xffff0000, v59
  v_add_f32 v22, v22, v24
  v_add_f32 v23, v23, v25
  v_cvt_pk_bf16_f32 v43, v22, v23
  s_add_u32 s67, s43, 737280
  buffer_store_dwordx2 v[42:43], v15, s[8:11], s67 offen
  s_waitcnt vmcnt(7)
  v_lshlrev_b32 v22, 16, v44
  v_and_b32 v23, 0xffff0000, v44
  v_mul_f32 v22, v22, v12
  v_mul_f32 v23, v23, v13
  v_cvt_pk_bf16_f32 v22, v22, v23
  v_lshlrev_b32 v24, 16, v22
  v_and_b32 v25, 0xffff0000, v22
  s_waitcnt lgkmcnt(1)
  v_lshlrev_b32 v22, 16, v60
  v_and_b32 v23, 0xffff0000, v60
  v_add_f32 v22, v22, v24
  v_add_f32 v23, v23, v25
  v_cvt_pk_bf16_f32 v44, v22, v23
  v_lshlrev_b32 v22, 16, v45
  v_and_b32 v23, 0xffff0000, v45
  v_mul_f32 v22, v22, v20
  v_mul_f32 v23, v23, v21
  v_cvt_pk_bf16_f32 v22, v22, v23
  v_lshlrev_b32 v24, 16, v22
  v_and_b32 v25, 0xffff0000, v22
  v_lshlrev_b32 v22, 16, v61
  v_and_b32 v23, 0xffff0000, v61
  v_add_f32 v22, v22, v24
  v_add_f32 v23, v23, v25
  v_cvt_pk_bf16_f32 v45, v22, v23
  s_add_u32 s67, s43, 884736
  buffer_store_dwordx2 v[44:45], v15, s[8:11], s67 offen
  s_waitcnt vmcnt(7)
  v_lshlrev_b32 v22, 16, v46
  v_and_b32 v23, 0xffff0000, v46
  v_mul_f32 v22, v22, v12
  v_mul_f32 v23, v23, v13
  v_cvt_pk_bf16_f32 v22, v22, v23
  v_lshlrev_b32 v24, 16, v22
  v_and_b32 v25, 0xffff0000, v22
  s_waitcnt lgkmcnt(0)
  v_lshlrev_b32 v22, 16, v62
  v_and_b32 v23, 0xffff0000, v62
  v_add_f32 v22, v22, v24
  v_add_f32 v23, v23, v25
  v_cvt_pk_bf16_f32 v46, v22, v23
  v_lshlrev_b32 v22, 16, v47
  v_and_b32 v23, 0xffff0000, v47
  v_mul_f32 v22, v22, v20
  v_mul_f32 v23, v23, v21
  v_cvt_pk_bf16_f32 v22, v22, v23
  v_lshlrev_b32 v24, 16, v22
  v_and_b32 v25, 0xffff0000, v22
  v_lshlrev_b32 v22, 16, v63
  v_and_b32 v23, 0xffff0000, v63
  v_add_f32 v22, v22, v24
  v_add_f32 v23, v23, v25
  v_cvt_pk_bf16_f32 v47, v22, v23
  s_add_u32 s67, s43, 1032192
  buffer_store_dwordx2 v[46:47], v15, s[8:11], s67 offen
  s_waitcnt vmcnt(0)
  s_barrier
WK_E:
  s_load_dwordx2 s[4:5], s[0:1], 136
  s_waitcnt lgkmcnt(0)
  s_mov_b32 s16, s4
  s_mov_b32 s17, s5
  s_mov_b32 s18, 256
  s_mov_b32 s19, 0x00020000
  v_mov_b32 v4, 72
  s_mov_b32 s39, 0
  s_nop 0
  s_cmp_eq_u32 s3, 0
  s_cbranch_scc0 Q0k_39
Q0l_38:
  buffer_load_dword v5, v4, s[16:19], 0 offen sc1
  s_waitcnt vmcnt(0)
  v_readfirstlane_b32 s38, v5
  s_cmp_ge_u32 s38, 32
  s_cbranch_scc1 Q0k_39
  s_add_u32 s39, s39, 1
  s_cmp_lt_u32 s39, 0x100000
  s_cbranch_scc1 Q0l_38
Q0k_39:
  s_waitcnt vmcnt(0)
  s_barrier
Q_TOP:
  s_load_dwordx2 s[4:5], s[0:1], 136
  s_waitcnt lgkmcnt(0)
  s_mov_b32 s16, s4
  s_mov_b32 s17, s5
  s_mov_b32 s18, 256
  s_mov_b32 s19, 0x00020000
  s_cmp_lg_u32 s3, 0
  s_cbranch_scc1 Q_TK
  s_mov_b64 exec, 1
  v_mov_b32 v4, 1
  v_mov_b32 v3, 84
  buffer_atomic_add v4, v3, s[16:19], 0 offen sc0 sc1
  v_mov_b32 v3, 0
  s_waitcnt vmcnt(0)
  ds_write_b32 v3, v4
  s_waitcnt lgkmcnt(0)
  s_mov_b64 exec, -1
Q_TK:
  s_barrier
  v_mov_b32 v3, 0
  ds_read_b32 v4, v3
  s_waitcnt lgkmcnt(0)
  v_readfirstlane_b32 s40, v4
  s_waitcnt lgkmcnt(0)
  s_barrier
  s_add_u32 s40, s40, 6
  s_cmp_ge_u32 s40, 638
  s_nop 0
  s_cbranch_scc1 Q_LATE
  s_mul_i32 s36, s40, 2979
  s_lshr_b32 s36, s36, 16
  s_mul_i32 s37, s36, 22
  s_sub_u32 s37, s40, s37
  s_cmp_lt_u32 s37, 6
  s_cbranch_scc1 Q_W
  s_sub_u32 s37, s37, 6
  s_branch Q_X
Q_LATE:
  s_sub_u32 s40, s40, 638
  s_cmp_ge_u32 s40, 192
  s_cbranch_scc1 Q_END
  s_mul_i32 s36, s40, 1261
  s_lshr_b32 s36, s36, 16
  s_mul_i32 s37, s36, 52
  s_sub_u32 s37, s40, s37
  s_add_u32 s36, s36, 29
  s_cmp_lt_u32 s37, 36
  s_cbranch_scc1 Q_WS
  s_sub_u32 s37, s37, 36
Q_X:
  s_lshl_b32 s40, s36, 4
  s_add_u32 s40, s40, s37
  s_load_dwordx2 s[8:9], s[0:1], 144
  s_waitcnt lgkmcnt(0)
  s_mov_b32 s12, s8
  s_mov_b32 s13, s9
  s_mov_b32 s14, 0x8000000
  s_mov_b32 s15, 0x00020000
  v_and_b32 v3, 63, v0
  v_lshlrev_b32 v1, 4, v3
  v_lshlrev_b32 v2, 2, v3
  v_and_b32 v4, 15, v3
  v_lshrrev_b32 v5, 4, v3
  v_lshlrev_b32 v5, 2, v5
  v_add_u32 v6, 0, v5
  v_cmp_le_u32 s[60:61], v6, v4
  v_add_u32 v6, 1, v5
  v_cmp_le_u32 s[62:63], v6, v4
  v_add_u32 v6, 2, v5
  v_cmp_le_u32 s[64:65], v6, v4
  v_add_u32 v6, 3, v5
  v_cmp_le_u32 s[66:67], v6, v4
  s_mov_b32 s68, 0x3db504f3
  s_mov_b32 s69, 0x3fb8aa3b
  s_lshr_b32 s41, s40, 5
  s_lshl_b32 s41, s41, 2
  s_add_u32 s41, s41, 128
  v_mov_b32 v4, s41
  s_mov_b32 s39, 0
  s_nop 0
  s_cmp_eq_u32 s3, 0
  s_cbranch_scc0 QPk_41
QPl_40:
  buffer_load_dword v5, v4, s[16:19], 0 offen sc1
  s_waitcnt vmcnt(0)
  v_readfirstlane_b32 s38, v5
  s_cmp_eq_u32 s38, 192
  s_cbranch_scc1 QPk_41
  s_add_u32 s39, s39, 1
  s_cmp_lt_u32 s39, 0x100000
  s_cbranch_scc1 QPl_40
QPk_41:
  s_waitcnt vmcnt(0)
  s_barrier
  s_lshr_b32 s41, s40, 3
  s_and_b32 s42, s40, 7
  s_lshl_b32 s42, s42, 2
  s_add_u32 s42, s42, s3
  s_lshl_b32 s43, s41, 5
  s_add_u32 s43, s43, s42
  s_lshl_b32 s44, s43, 13
  s_add_u32 s45, s44, 0x1000000
  s_add_u32 s46, s44, 0x2000000
  s_add_u32 s49, s44, 0x3000000
  s_lshl_b32 s47, s43, 12
  s_add_u32 s47, s47, 0x4000000
  s_lshl_b32 s48, s43, 11
  s_add_u32 s48, s48, 0x4800000
  v_add_u32 v7, 4096, v1
  buffer_load_dwordx4 v[32:35], v1, s[12:15], s46 offen offset:0
  buffer_load_dwordx4 v[36:39], v1, s[12:15], s46 offen offset:1024
  buffer_load_dwordx4 v[40:43], v1, s[12:15], s46 offen offset:2048
  buffer_load_dwordx4 v[44:47], v1, s[12:15], s46 offen offset:3072
  buffer_load_dwordx4 v[48:51], v7, s[12:15], s46 offen offset:0
  buffer_load_dwordx4 v[52:55], v7, s[12:15], s46 offen offset:1024
  buffer_load_dwordx4 v[56:59], v7, s[12:15], s46 offen offset:2048
  buffer_load_dwordx4 v[60:63], v7, s[12:15], s46 offen offset:3072
  buffer_load_dwordx4 v[64:67], v1, s[12:15], s44 offen offset:0
  buffer_load_dwordx4 v[68:71], v1, s[12:15], s44 offen offset:1024
  buffer_load_dwordx4 v[72:75], v1, s[12:15], s44 offen offset:2048
  buffer_load_dwordx4 v[76:79], v1, s[12:15], s44 offen offset:3072
  buffer_load_dwordx4 v[80:83], v7, s[12:15], s44 offen offset:0
  buffer_load_dwordx4 v[84:87], v7, s[12:15], s44 offen offset:1024
  buffer_load_dwordx4 v[88:91], v7, s[12:15], s44 offen offset:2048
  buffer_load_dwordx4 v[92:95], v7, s[12:15], s44 offen offset:3072
  buffer_load_dwordx4 v[96:99], v1, s[12:15], s45 offen offset:0
  buffer_load_dwordx4 v[100:103], v1, s[12:15], s45 offen offset:1024
  buffer_load_dwordx4 v[104:107], v1, s[12:15], s45 offen offset:2048
  buffer_load_dwordx4 v[108:111], v1, s[12:15], s45 offen offset:3072
  buffer_load_dwordx4 v[112:115], v7, s[12:15], s45 offen offset:0
  buffer_load_dwordx4 v[116:119], v7, s[12:15], s45 offen offset:1024
  buffer_load_dwordx4 v[120:123], v7, s[12:15], s45 offen offset:2048
  buffer_load_dwordx4 v[124:127], v7, s[12:15], s45 offen offset:3072
  s_and_b32 s42, s40, 7
  s_lshl_b32 s42, s42, 2
  s_add_u32 s42, s42, s3
  s_lshl_b32 s42, s42, 9
  s_add_u32 s42, s42, 0x4e00000
  v_lshlrev_b32 v4, 5, v2
  s_mov_b64 exec, 15
  s_mov_b64 exec, 1
  s_mov_b32 s39, 0
  s_cmp_eq_u32 s3, 0
  s_cbranch_scc0 QX0k_43
QX0l_42:
  buffer_load_dword v5, v4, s[12:15], s42 offen sc1
  s_waitcnt vmcnt(0)
  v_cmp_lt_u32 vcc, s41, v5
  s_nop 4
  s_cmp_eq_u32 vcc_lo, 1
  s_cbranch_scc1 QX0k_43
  s_add_u32 s39, s39, 1
  s_cmp_lt_u32 s39, 0x100000
  s_cbranch_scc1 QX0l_42
QX0k_43:
  s_waitcnt vmcnt(0)
  s_barrier
  s_mov_b64 exec, -1
  s_and_b32 s42, s40, 7
  s_lshl_b32 s42, s42, 2
  s_add_u32 s42, s42, s3
  s_lshl_b32 s42, s42, 9
  s_add_u32 s42, s42, 0x4e00000
  v_lshlrev_b32 v4, 5, v2
  s_mov_b64 exec, 15
  s_mov_b32 s39, 0
QXl_44:
  buffer_load_dword v5, v4, s[12:15], s42 offen sc1
  s_waitcnt vmcnt(0)
  v_cmp_lt_u32 vcc, s41, v5
  s_nop 4
  s_cmp_eq_u32 vcc_lo, 15
  s_cbranch_scc1 QXk_45
  s_add_u32 s39, s39, 1
  s_cmp_lt_u32 s39, 0x100000
  s_cbranch_scc1 QXl_44
QXk_45:
  s_mov_b64 exec, -1
  buffer_load_dwordx4 v[128:131], v1, s[12:15], s47 offen offset:0
  buffer_load_dwordx4 v[132:135], v1, s[12:15], s47 offen offset:1024
  buffer_load_dwordx4 v[136:139], v1, s[12:15], s47 offen offset:2048
  buffer_load_dwordx4 v[140:143], v1, s[12:15], s47 offen offset:3072
  buffer_load_dword v144, v2, s[12:15], s48 offen offset:0
  buffer_load_dword v146, v2, s[12:15], s48 offen offset:256
  buffer_load_dword v148, v2, s[12:15], s48 offen offset:512
  buffer_load_dword v150, v2, s[12:15], s48 offen offset:768
  buffer_load_dword v152, v2, s[12:15], s48 offen offset:1024
  buffer_load_dword v154, v2, s[12:15], s48 offen offset:1280
  buffer_load_dword v156, v2, s[12:15], s48 offen offset:1536
  buffer_load_dword v158, v2, s[12:15], s48 offen offset:1792
  v_mov_b32 v145, 0
  v_mov_b32 v147, 0
  v_mov_b32 v149, 0
  v_mov_b32 v151, 0
  v_mov_b32 v153, 0
  v_mov_b32 v155, 0
  v_mov_b32 v157, 0
  v_mov_b32 v159, 0
  v_mov_b32 v27, 0xff800000
  v_mfma_f32_16x16x32_bf16 v[160:163], v[64:67], v[32:35], 0
  s_waitcnt vmcnt(11)
  v_mfma_f32_16x16x32_bf16 v[164:167], v[128:131], v[32:35], 0
  v_mfma_f32_16x16x32_bf16 v[168:171], v[64:67], v[36:39], 0
  v_mfma_f32_16x16x32_bf16 v[172:175], v[68:71], v[36:39], 0
  v_mfma_f32_16x16x32_bf16 v[176:179], v[128:131], v[36:39], 0
  v_mfma_f32_16x16x32_bf16 v[160:163], v[72:75], v[40:43], v[160:163]
  s_waitcnt vmcnt(10)
  v_mfma_f32_16x16x32_bf16 v[164:167], v[132:135], v[40:43], v[164:167]
  v_mfma_f32_16x16x32_bf16 v[168:171], v[72:75], v[44:47], v[168:171]
  v_mfma_f32_16x16x32_bf16 v[172:175], v[76:79], v[44:47], v[172:175]
  v_mfma_f32_16x16x32_bf16 v[176:179], v[132:135], v[44:47], v[176:179]
  v_mfma_f32_16x16x32_bf16 v[160:163], v[80:83], v[48:51], v[160:163]
  s_waitcnt vmcnt(9)
  v_mfma_f32_16x16x32_bf16 v[164:167], v[136:139], v[48:51], v[164:167]
  v_mfma_f32_16x16x32_bf16 v[168:171], v[80:83], v[52:55], v[168:171]
  v_mfma_f32_16x16x32_bf16 v[172:175], v[84:87], v[52:55], v[172:175]
  v_mfma_f32_16x16x32_bf16 v[176:179], v[136:139], v[52:55], v[176:179]
  v_mfma_f32_16x16x32_bf16 v[160:163], v[88:91], v[56:59], v[160:163]
  s_waitcnt vmcnt(8)
  v_mfma_f32_16x16x32_bf16 v[164:167], v[140:143], v[56:59], v[164:167]
  v_mfma_f32_16x16x32_bf16 v[168:171], v[88:91], v[60:63], v[168:171]
  v_mfma_f32_16x16x32_bf16 v[172:175], v[92:95], v[60:63], v[172:175]
  v_mfma_f32_16x16x32_bf16 v[176:179], v[140:143], v[60:63], v[176:179]
  s_nop 2
  v_cvt_pk_bf16_f32 v24, v160, v161
  v_lshlrev_b32 v160, 16, v24
  v_and_b32 v161, 0xffff0000, v24
  v_cvt_pk_bf16_f32 v25, v162, v163
  v_lshlrev_b32 v162, 16, v25
  v_and_b32 v163, 0xffff0000, v25
  v_cvt_pk_bf16_f32 v24, v164, v165
  v_lshlrev_b32 v164, 16, v24
  v_and_b32 v165, 0xffff0000, v24
  v_mul_f32 v160, s68, v160
  v_mul_f32 v161, s68, v161
  v_mul_f32 v162, s68, v162
  v_mul_f32 v163, s68, v163
  v_mul_f32 v164, s68, v164
  v_mul_f32 v165, s68, v165
  v_cvt_pk_bf16_f32 v24, v160, v161
  v_lshlrev_b32 v160, 16, v24
  v_and_b32 v161, 0xffff0000, v24
  v_cvt_pk_bf16_f32 v25, v162, v163
  v_lshlrev_b32 v162, 16, v25
  v_and_b32 v163, 0xffff0000, v25
  v_cvt_pk_bf16_f32 v24, v164, v165
  v_lshlrev_b32 v164, 16, v24
  v_and_b32 v165, 0xffff0000, v24
  v_cndmask_b32 v160, v27, v160, s[60:61]
  v_cndmask_b32 v161, v27, v161, s[62:63]
  v_cndmask_b32 v162, v27, v162, s[64:65]
  v_cndmask_b32 v163, v27, v163, s[66:67]
  v_max_f32 v24, v160, v161
  v_max3_f32 v24, v24, v162, v163
  v_max3_f32 v24, v24, v164, v165
  v_mov_b32 v25, v24
  s_nop 1
  v_permlane32_swap_b32 v24, v25
  v_max_f32 v24, v24, v25
  v_mov_b32 v25, v24
  s_nop 1
  v_permlane16_swap_b32 v24, v25
  v_max_f32 v24, v24, v25
  v_mul_f32 v24, s69, v24
  v_fma_f32 v160, v160, s69, -v24
  v_fma_f32 v161, v161, s69, -v24
  v_fma_f32 v162, v162, s69, -v24
  v_fma_f32 v163, v163, s69, -v24
  v_fma_f32 v164, v164, s69, -v24
  v_fma_f32 v165, v165, s69, -v24
  v_exp_f32 v160, v160
  v_exp_f32 v161, v161
  v_exp_f32 v162, v162
  v_exp_f32 v163, v163
  v_exp_f32 v164, v164
  v_exp_f32 v165, v165
  v_add_f32 v24, v160, v161
  v_add_f32 v24, v24, v162
  v_add_f32 v24, v24, v163
  v_add_f32 v24, v24, v164
  v_add_f32 v24, v24, v165
  v_mov_b32 v25, v24
  s_nop 1
  v_permlane32_swap_b32 v24, v25
  v_add_f32 v24, v24, v25
  v_mov_b32 v25, v24
  s_nop 1
  v_permlane16_swap_b32 v24, v25
  v_add_f32 v24, v24, v25
  v_rcp_f32 v24, v24
  s_nop 0
  v_mul_f32 v160, v160, v24
  v_mul_f32 v161, v161, v24
  v_mul_f32 v162, v162, v24
  v_mul_f32 v163, v163, v24
  v_mul_f32 v164, v164, v24
  v_mul_f32 v165, v165, v24
  v_cvt_pk_bf16_f32 v180, v160, v161
  v_cvt_pk_bf16_f32 v181, v162, v163
  v_mov_b32 v182, 0
  v_mov_b32 v183, 0
  v_cvt_pk_bf16_f32 v184, v164, v165
  v_mov_b32 v185, 0
  v_mfma_f32_16x16x32_bf16 v[192:195], v[96:99], v[180:183], 0
  v_mfma_f32_16x16x32_bf16 v[196:199], v[100:103], v[180:183], 0
  v_mfma_f32_16x16x32_bf16 v[200:203], v[104:107], v[180:183], 0
  v_mfma_f32_16x16x32_bf16 v[204:207], v[108:111], v[180:183], 0
  v_mfma_f32_16x16x32_bf16 v[208:211], v[112:115], v[180:183], 0
  v_mfma_f32_16x16x32_bf16 v[212:215], v[116:119], v[180:183], 0
  v_mfma_f32_16x16x32_bf16 v[216:219], v[120:123], v[180:183], 0
  v_mfma_f32_16x16x32_bf16 v[220:223], v[124:127], v[180:183], 0
  s_waitcnt vmcnt(7)
  v_mfma_f32_16x16x16_bf16 v[192:195], v[144:145], v[184:185], v[192:195]
  s_waitcnt vmcnt(6)
  v_mfma_f32_16x16x16_bf16 v[196:199], v[146:147], v[184:185], v[196:199]
  s_waitcnt vmcnt(5)
  v_mfma_f32_16x16x16_bf16 v[200:203], v[148:149], v[184:185], v[200:203]
  s_waitcnt vmcnt(4)
  v_mfma_f32_16x16x16_bf16 v[204:207], v[150:151], v[184:185], v[204:207]
  s_waitcnt vmcnt(3)
  v_mfma_f32_16x16x16_bf16 v[208:211], v[152:153], v[184:185], v[208:211]
  s_waitcnt vmcnt(2)
  v_mfma_f32_16x16x16_bf16 v[212:215], v[154:155], v[184:185], v[212:215]
  s_waitcnt vmcnt(1)
  v_mfma_f32_16x16x16_bf16 v[216:219], v[156:157], v[184:185], v[216:219]
  s_waitcnt vmcnt(0)
  v_mfma_f32_16x16x16_bf16 v[220:223], v[158:159], v[184:185], v[220:223]
  v_cvt_pk_bf16_f32 v24, v168, v169
  v_lshlrev_b32 v168, 16, v24
  v_and_b32 v169, 0xffff0000, v24
  v_cvt_pk_bf16_f32 v25, v170, v171
  v_lshlrev_b32 v170, 16, v25
  v_and_b32 v171, 0xffff0000, v25
  v_cvt_pk_bf16_f32 v24, v172, v173
  v_lshlrev_b32 v172, 16, v24
  v_and_b32 v173, 0xffff0000, v24
  v_cvt_pk_bf16_f32 v25, v174, v175
  v_lshlrev_b32 v174, 16, v25
  v_and_b32 v175, 0xffff0000, v25
  v_cvt_pk_bf16_f32 v24, v176, v177
  v_lshlrev_b32 v176, 16, v24
  v_and_b32 v177, 0xffff0000, v24
  v_mul_f32 v168, s68, v168
  v_mul_f32 v169, s68, v169
  v_mul_f32 v170, s68, v170
  v_mul_f32 v171, s68, v171
  v_mul_f32 v172, s68, v172
  v_mul_f32 v173, s68, v173
  v_mul_f32 v174, s68, v174
  v_mul_f32 v175, s68, v175
  v_mul_f32 v176, s68, v176
  v_mul_f32 v177, s68, v177
  v_cvt_pk_bf16_f32 v24, v168, v169
  v_lshlrev_b32 v168, 16, v24
  v_and_b32 v169, 0xffff0000, v24
  v_cvt_pk_bf16_f32 v25, v170, v171
  v_lshlrev_b32 v170, 16, v25
  v_and_b32 v171, 0xffff0000, v25
  v_cvt_pk_bf16_f32 v24, v172, v173
  v_lshlrev_b32 v172, 16, v24
  v_and_b32 v173, 0xffff0000, v24
  v_cvt_pk_bf16_f32 v25, v174, v175
  v_lshlrev_b32 v174, 16, v25
  v_and_b32 v175, 0xffff0000, v25
  v_cvt_pk_bf16_f32 v24, v176, v177
  v_lshlrev_b32 v176, 16, v24
  v_and_b32 v177, 0xffff0000, v24
  v_cndmask_b32 v172, v27, v172, s[60:61]
  v_cndmask_b32 v173, v27, v173, s[62:63]
  v_cndmask_b32 v174, v27, v174, s[64:65]
  v_cndmask_b32 v175, v27, v175, s[66:67]
  v_max_f32 v24, v168, v169
  v_max3_f32 v24, v24, v170, v171
  v_max3_f32 v24, v24, v172, v173
  v_max3_f32 v24, v24, v174, v175
  v_max3_f32 v24, v24, v176, v177
  v_mov_b32 v25, v24
  s_nop 1
  v_permlane32_swap_b32 v24, v25
  v_max_f32 v24, v24, v25
  v_mov_b32 v25, v24
  s_nop 1
  v_permlane16_swap_b32 v24, v25
  v_max_f32 v24, v24, v25
  v_mul_f32 v24, s69, v24
  v_fma_f32 v168, v168, s69, -v24
  v_fma_f32 v169, v169, s69, -v24
  v_fma_f32 v170, v170, s69, -v24
  v_fma_f32 v171, v171, s69, -v24
  v_fma_f32 v172, v172, s69, -v24
  v_fma_f32 v173, v173, s69, -v24
  v_fma_f32 v174, v174, s69, -v24
  v_fma_f32 v175, v175, s69, -v24
  v_fma_f32 v176, v176, s69, -v24
  v_fma_f32 v177, v177, s69, -v24
  v_exp_f32 v168, v168
  v_exp_f32 v169, v169
  v_exp_f32 v170, v170
  v_exp_f32 v171, v171
  v_exp_f32 v172, v172
  v_exp_f32 v173, v173
  v_exp_f32 v174, v174
  v_exp_f32 v175, v175
  v_exp_f32 v176, v176
  v_exp_f32 v177, v177
  v_add_f32 v24, v168, v169
  v_add_f32 v24, v24, v170
  v_add_f32 v24, v24, v171
  v_add_f32 v24, v24, v172
  v_add_f32 v24, v24, v173
  v_add_f32 v24, v24, v174
  v_add_f32 v24, v24, v175
  v_add_f32 v24, v24, v176
  v_add_f32 v24, v24, v177
  v_mov_b32 v25, v24
  s_nop 1
  v_permlane32_swap_b32 v24, v25
  v_add_f32 v24, v24, v25
  v_mov_b32 v25, v24
  s_nop 1
  v_permlane16_swap_b32 v24, v25
  v_add_f32 v24, v24, v25
  v_rcp_f32 v24, v24
  s_nop 0
  v_mul_f32 v168, v168, v24
  v_mul_f32 v169, v169, v24
  v_mul_f32 v170, v170, v24
  v_mul_f32 v171, v171, v24
  v_mul_f32 v172, v172, v24
  v_mul_f32 v173, v173, v24
  v_mul_f32 v174, v174, v24
  v_mul_f32 v175, v175, v24
  v_mul_f32 v176, v176, v24
  v_mul_f32 v177, v177, v24
  v_cvt_pk_bf16_f32 v188, v168, v169
  v_cvt_pk_bf16_f32 v189, v170, v171
  v_cvt_pk_bf16_f32 v190, v172, v173
  v_cvt_pk_bf16_f32 v191, v174, v175
  v_cvt_pk_bf16_f32 v186, v176, v177
  v_mov_b32 v187, 0
  v_cvt_pk_bf16_f32 v224, v192, v193
  v_cvt_pk_bf16_f32 v225, v194, v195
  v_cvt_pk_bf16_f32 v226, v196, v197
  v_cvt_pk_bf16_f32 v227, v198, v199
  buffer_store_dwordx4 v[224:227], v1, s[12:15], s49 offen offset:0 sc1
  v_cvt_pk_bf16_f32 v228, v200, v201
  v_cvt_pk_bf16_f32 v229, v202, v203
  v_cvt_pk_bf16_f32 v230, v204, v205
  v_cvt_pk_bf16_f32 v231, v206, v207
  buffer_store_dwordx4 v[228:231], v1, s[12:15], s49 offen offset:2048 sc1
  v_cvt_pk_bf16_f32 v232, v208, v209
  v_cvt_pk_bf16_f32 v233, v210, v211
  v_cvt_pk_bf16_f32 v234, v212, v213
  v_cvt_pk_bf16_f32 v235, v214, v215
  buffer_store_dwordx4 v[232:235], v7, s[12:15], s49 offen offset:0 sc1
  v_cvt_pk_bf16_f32 v236, v216, v217
  v_cvt_pk_bf16_f32 v237, v218, v219
  v_cvt_pk_bf16_f32 v238, v220, v221
  v_cvt_pk_bf16_f32 v239, v222, v223
  buffer_store_dwordx4 v[236:239], v7, s[12:15], s49 offen offset:2048 sc1
  v_mfma_f32_16x16x32_bf16 v[192:195], v[96:99], v[188:191], 0
  v_mfma_f32_16x16x32_bf16 v[196:199], v[100:103], v[188:191], 0
  v_mfma_f32_16x16x32_bf16 v[200:203], v[104:107], v[188:191], 0
  v_mfma_f32_16x16x32_bf16 v[204:207], v[108:111], v[188:191], 0
  v_mfma_f32_16x16x32_bf16 v[208:211], v[112:115], v[188:191], 0
  v_mfma_f32_16x16x32_bf16 v[212:215], v[116:119], v[188:191], 0
  v_mfma_f32_16x16x32_bf16 v[216:219], v[120:123], v[188:191], 0
  v_mfma_f32_16x16x32_bf16 v[220:223], v[124:127], v[188:191], 0
  v_mfma_f32_16x16x16_bf16 v[192:195], v[144:145], v[186:187], v[192:195]
  v_mfma_f32_16x16x16_bf16 v[196:199], v[146:147], v[186:187], v[196:199]
  v_mfma_f32_16x16x16_bf16 v[200:203], v[148:149], v[186:187], v[200:203]
  v_mfma_f32_16x16x16_bf16 v[204:207], v[150:151], v[186:187], v[204:207]
  v_mfma_f32_16x16x16_bf16 v[208:211], v[152:153], v[186:187], v[208:211]
  v_mfma_f32_16x16x16_bf16 v[212:215], v[154:155], v[186:187], v[212:215]
  v_mfma_f32_16x16x16_bf16 v[216:219], v[156:157], v[186:187], v[216:219]
  v_mfma_f32_16x16x16_bf16 v[220:223], v[158:159], v[186:187], v[220:223]
  s_nop 0
  v_cvt_pk_bf16_f32 v240, v192, v193
  v_cvt_pk_bf16_f32 v241, v194, v195
  v_cvt_pk_bf16_f32 v242, v196, v197
  v_cvt_pk_bf16_f32 v243, v198, v199
  buffer_store_dwordx4 v[240:243], v1, s[12:15], s49 offen offset:1024 sc1
  v_cvt_pk_bf16_f32 v244, v200, v201
  v_cvt_pk_bf16_f32 v245, v202, v203
  v_cvt_pk_bf16_f32 v246, v204, v205
  v_cvt_pk_bf16_f32 v247, v206, v207
  buffer_store_dwordx4 v[244:247], v1, s[12:15], s49 offen offset:3072 sc1
  v_cvt_pk_bf16_f32 v248, v208, v209
  v_cvt_pk_bf16_f32 v249, v210, v211
  v_cvt_pk_bf16_f32 v250, v212, v213
  v_cvt_pk_bf16_f32 v251, v214, v215
  buffer_store_dwordx4 v[248:251], v7, s[12:15], s49 offen offset:1024 sc1
  v_cvt_pk_bf16_f32 v252, v216, v217
  v_cvt_pk_bf16_f32 v253, v218, v219
  v_cvt_pk_bf16_f32 v254, v220, v221
  v_cvt_pk_bf16_f32 v255, v222, v223
  buffer_store_dwordx4 v[252:255], v7, s[12:15], s49 offen offset:3072 sc1
  s_waitcnt vmcnt(0)
  s_lshr_b32 s41, s36, 1
  s_lshl_b32 s41, s41, 2
  s_add_u32 s41, s41, 192
  s_and_b32 s42, s36, 1
  s_lshl_b32 s42, s42, 4
  s_lshl_b32 s42, 1, s42
  v_mov_b32 v4, s42
  v_mov_b32 v5, s41
  s_mov_b64 exec, 1
  buffer_atomic_add v4, v5, s[16:19], 0 offen sc1
  s_mov_b64 exec, -1
  s_waitcnt vmcnt(0)
  s_branch Q_TOP
Q_W:
  s_sub_u32 s36, s36, 1
  s_lshr_b32 s41, s36, 1
  s_lshl_b32 s41, s41, 2
  s_add_u32 s41, s41, 192
  v_mov_b32 v4, s41
  s_and_b32 s42, s36, 1
  s_lshl_b32 s42, s42, 4
  s_mov_b32 s39, 0
  s_cmp_eq_u32 s3, 0
  s_cbranch_scc0 QWk_47
QWl_46:
  buffer_load_dword v5, v4, s[16:19], 0 offen sc1
  s_waitcnt vmcnt(0)
  v_readfirstlane_b32 s38, v5
  s_lshr_b32 s38, s38, s42
  s_and_b32 s38, s38, 0xffff
  s_cmp_eq_u32 s38, 64
  s_cbranch_scc1 QWk_47
  s_add_u32 s39, s39, 1
  s_cmp_lt_u32 s39, 0x100000
  s_cbranch_scc1 QWl_46
QWk_47:
  s_waitcnt vmcnt(0)
  s_barrier
  v_mov_b32 v4, 88
  s_mov_b32 s39, 0
  s_nop 0
  s_cmp_eq_u32 s3, 0
  s_cbranch_scc0 QTk_49
QTl_48:
  buffer_load_dword v5, v4, s[16:19], 0 offen sc1
  s_waitcnt vmcnt(0)
  v_readfirstlane_b32 s38, v5
  s_cmp_eq_u32 s38, 128
  s_cbranch_scc1 QTk_49
  s_add_u32 s39, s39, 1
  s_cmp_lt_u32 s39, 0x100000
  s_cbranch_scc1 QTl_48
QTk_49:
  s_waitcnt vmcnt(0)
  s_barrier
  s_mul_i32 s40, s36, 6
  s_add_u32 s40, s40, s37
  s_load_dwordx2 s[4:5], s[0:1], 128
  s_load_dwordx2 s[8:9], s[0:1], 144
  s_waitcnt lgkmcnt(0)
  s_mov_b32 s12, s8
  s_mov_b32 s13, s9
  s_mov_b32 s14, 0x8000000
  s_mov_b32 s15, 0x00020000
  s_mov_b32 s16, s4
  s_mov_b32 s17, s5
  s_mov_b32 s18, 4718592
  s_mov_b32 s19, 0x00020000
  s_mul_i32 s41, s40, 10923
  s_lshr_b32 s41, s41, 16
  s_mul_i32 s42, s41, 6
  s_sub_u32 s42, s40, s42
  v_and_b32 v3, 63, v0
  v_lshlrev_b32 v1, 4, v3
  v_and_b32 v4, 15, v3
  v_lshlrev_b32 v4, 4, v4
  v_lshrrev_b32 v5, 4, v3
  v_and_b32 v5, 1, v5
  v_lshlrev_b32 v5, 10, v5
  v_lshrrev_b32 v6, 5, v3
  v_lshlrev_b32 v6, 8, v6
  v_add_u32 v4, v4, v5
  v_add_u32 v2, v4, v6
  s_lshl_b32 s43, s41, 19
  s_lshl_b32 s44, s3, 16
  s_add_u32 s43, s43, s44
  s_add_u32 s43, s43, 0x3000000
  s_add_u32 s45, s43, 262144
  s_mul_i32 s46, s42, 786432
  s_add_u32 s46, s46, s44
  s_add_u32 s46, s46, 0x5000000
  s_add_u32 s47, s46, 262144
  s_add_u32 s48, s46, 524288
  v_add_u32 v7, 4096, v2
  v_add_u32 v6, 4096, v1
  v_mov_b32 v32, 0
  v_mov_b32 v33, 0
  v_mov_b32 v34, 0
  v_mov_b32 v35, 0
  v_mov_b32 v36, 0
  v_mov_b32 v37, 0
  v_mov_b32 v38, 0
  v_mov_b32 v39, 0
  v_mov_b32 v40, 0
  v_mov_b32 v41, 0
  v_mov_b32 v42, 0
  v_mov_b32 v43, 0
  v_mov_b32 v44, 0
  v_mov_b32 v45, 0
  v_mov_b32 v46, 0
  v_mov_b32 v47, 0
  v_mov_b32 v48, 0
  v_mov_b32 v49, 0
  v_mov_b32 v50, 0
  v_mov_b32 v51, 0
  v_mov_b32 v52, 0
  v_mov_b32 v53, 0
  v_mov_b32 v54, 0
  v_mov_b32 v55, 0
  v_mov_b32 v56, 0
  v_mov_b32 v57, 0
  v_mov_b32 v58, 0
  v_mov_b32 v59, 0
  v_mov_b32 v60, 0
  v_mov_b32 v61, 0
  v_mov_b32 v62, 0
  v_mov_b32 v63, 0
  v_mov_b32 v64, 0
  v_mov_b32 v65, 0
  v_mov_b32 v66, 0
  v_mov_b32 v67, 0
  v_mov_b32 v68, 0
  v_mov_b32 v69, 0
  v_mov_b32 v70, 0
  v_mov_b32 v71, 0
  v_mov_b32 v72, 0
  v_mov_b32 v73, 0
  v_mov_b32 v74, 0
  v_mov_b32 v75, 0
  v_mov_b32 v76, 0
  v_mov_b32 v77, 0
  v_mov_b32 v78, 0
  v_mov_b32 v79, 0
  v_mov_b32 v80, 0
  v_mov_b32 v81, 0
  v_mov_b32 v82, 0
  v_mov_b32 v83, 0
  v_mov_b32 v84, 0
  v_mov_b32 v85, 0
  v_mov_b32 v86, 0
  v_mov_b32 v87, 0
  v_mov_b32 v88, 0
  v_mov_b32 v89, 0
  v_mov_b32 v90, 0
  v_mov_b32 v91, 0
  v_mov_b32 v92, 0
  v_mov_b32 v93, 0
  v_mov_b32 v94, 0
  v_mov_b32 v95, 0
  v_mov_b32 v96, 0
  v_mov_b32 v97, 0
  v_mov_b32 v98, 0
  v_mov_b32 v99, 0
  v_mov_b32 v100, 0
  v_mov_b32 v101, 0
  v_mov_b32 v102, 0
  v_mov_b32 v103, 0
  v_mov_b32 v104, 0
  v_mov_b32 v105, 0
  v_mov_b32 v106, 0
  v_mov_b32 v107, 0
  v_mov_b32 v108, 0
  v_mov_b32 v109, 0
  v_mov_b32 v110, 0
  v_mov_b32 v111, 0
  v_mov_b32 v112, 0
  v_mov_b32 v113, 0
  v_mov_b32 v114, 0
  v_mov_b32 v115, 0
  v_mov_b32 v116, 0
  v_mov_b32 v117, 0
  v_mov_b32 v118, 0
  v_mov_b32 v119, 0
  v_mov_b32 v120, 0
  v_mov_b32 v121, 0
  v_mov_b32 v122, 0
  v_mov_b32 v123, 0
  v_mov_b32 v124, 0
  v_mov_b32 v125, 0
  v_mov_b32 v126, 0
  v_mov_b32 v127, 0
  buffer_load_dwordx4 v[128:131], v2, s[12:15], s43 offen offset:0
  buffer_load_dwordx4 v[132:135], v2, s[12:15], s45 offen offset:0
  buffer_load_dwordx4 v[136:139], v1, s[12:15], s46 offen offset:0
  buffer_load_dwordx4 v[140:143], v1, s[12:15], s47 offen offset:0
  buffer_load_dwordx4 v[144:147], v1, s[12:15], s48 offen offset:0
  buffer_load_dwordx4 v[148:151], v2, s[12:15], s43 offen offset:512
  buffer_load_dwordx4 v[152:155], v2, s[12:15], s45 offen offset:512
  buffer_load_dwordx4 v[156:159], v1, s[12:15], s46 offen offset:1024
  buffer_load_dwordx4 v[160:163], v1, s[12:15], s47 offen offset:1024
  buffer_load_dwordx4 v[164:167], v1, s[12:15], s48 offen offset:1024
  buffer_load_dwordx4 v[168:171], v2, s[12:15], s43 offen offset:2048
  buffer_load_dwordx4 v[172:175], v2, s[12:15], s45 offen offset:2048
  buffer_load_dwordx4 v[176:179], v1, s[12:15], s46 offen offset:2048
  buffer_load_dwordx4 v[180:183], v1, s[12:15], s47 offen offset:2048
  buffer_load_dwordx4 v[184:187], v1, s[12:15], s48 offen offset:2048
  s_mov_b32 s50, 0
W_L_50:
  buffer_load_dwordx4 v[188:191], v2, s[12:15], s43 offen offset:2560
  buffer_load_dwordx4 v[192:195], v2, s[12:15], s45 offen offset:2560
  buffer_load_dwordx4 v[196:199], v1, s[12:15], s46 offen offset:3072
  buffer_load_dwordx4 v[200:203], v1, s[12:15], s47 offen offset:3072
  buffer_load_dwordx4 v[204:207], v1, s[12:15], s48 offen offset:3072
  s_waitcnt vmcnt(17)
  v_mfma_f32_32x32x16_bf16 v[32:47], v[136:139], v[128:131], v[32:47]
  s_waitcnt vmcnt(16)
  v_mfma_f32_32x32x16_bf16 v[48:63], v[140:143], v[128:131], v[48:63]
  s_waitcnt vmcnt(15)
  v_mfma_f32_32x32x16_bf16 v[64:79], v[144:147], v[128:131], v[64:79]
  v_mfma_f32_32x32x16_bf16 v[80:95], v[136:139], v[132:135], v[80:95]
  v_mfma_f32_32x32x16_bf16 v[96:111], v[140:143], v[132:135], v[96:111]
  v_mfma_f32_32x32x16_bf16 v[112:127], v[144:147], v[132:135], v[112:127]
  buffer_load_dwordx4 v[128:131], v7, s[12:15], s43 offen offset:0
  buffer_load_dwordx4 v[132:135], v7, s[12:15], s45 offen offset:0
  buffer_load_dwordx4 v[136:139], v6, s[12:15], s46 offen offset:0
  buffer_load_dwordx4 v[140:143], v6, s[12:15], s47 offen offset:0
  buffer_load_dwordx4 v[144:147], v6, s[12:15], s48 offen offset:0
  s_waitcnt vmcnt(17)
  v_mfma_f32_32x32x16_bf16 v[32:47], v[156:159], v[148:151], v[32:47]
  s_waitcnt vmcnt(16)
  v_mfma_f32_32x32x16_bf16 v[48:63], v[160:163], v[148:151], v[48:63]
  s_waitcnt vmcnt(15)
  v_mfma_f32_32x32x16_bf16 v[64:79], v[164:167], v[148:151], v[64:79]
  v_mfma_f32_32x32x16_bf16 v[80:95], v[156:159], v[152:155], v[80:95]
  v_mfma_f32_32x32x16_bf16 v[96:111], v[160:163], v[152:155], v[96:111]
  v_mfma_f32_32x32x16_bf16 v[112:127], v[164:167], v[152:155], v[112:127]
  buffer_load_dwordx4 v[148:151], v7, s[12:15], s43 offen offset:512
  buffer_load_dwordx4 v[152:155], v7, s[12:15], s45 offen offset:512
  buffer_load_dwordx4 v[156:159], v6, s[12:15], s46 offen offset:1024
  buffer_load_dwordx4 v[160:163], v6, s[12:15], s47 offen offset:1024
  buffer_load_dwordx4 v[164:167], v6, s[12:15], s48 offen offset:1024
  s_waitcnt vmcnt(17)
  v_mfma_f32_32x32x16_bf16 v[32:47], v[176:179], v[168:171], v[32:47]
  s_waitcnt vmcnt(16)
  v_mfma_f32_32x32x16_bf16 v[48:63], v[180:183], v[168:171], v[48:63]
  s_waitcnt vmcnt(15)
  v_mfma_f32_32x32x16_bf16 v[64:79], v[184:187], v[168:171], v[64:79]
  v_mfma_f32_32x32x16_bf16 v[80:95], v[176:179], v[172:175], v[80:95]
  v_mfma_f32_32x32x16_bf16 v[96:111], v[180:183], v[172:175], v[96:111]
  v_mfma_f32_32x32x16_bf16 v[112:127], v[184:187], v[172:175], v[112:127]
  buffer_load_dwordx4 v[168:171], v7, s[12:15], s43 offen offset:2048
  buffer_load_dwordx4 v[172:175], v7, s[12:15], s45 offen offset:2048
  buffer_load_dwordx4 v[176:179], v6, s[12:15], s46 offen offset:2048
  buffer_load_dwordx4 v[180:183], v6, s[12:15], s47 offen offset:2048
  buffer_load_dwordx4 v[184:187], v6, s[12:15], s48 offen offset:2048
  s_waitcnt vmcnt(17)
  v_mfma_f32_32x32x16_bf16 v[32:47], v[196:199], v[188:191], v[32:47]
  s_waitcnt vmcnt(16)
  v_mfma_f32_32x32x16_bf16 v[48:63], v[200:203], v[188:191], v[48:63]
  s_waitcnt vmcnt(15)
  v_mfma_f32_32x32x16_bf16 v[64:79], v[204:207], v[188:191], v[64:79]
  v_mfma_f32_32x32x16_bf16 v[80:95], v[196:199], v[192:195], v[80:95]
  v_mfma_f32_32x32x16_bf16 v[96:111], v[200:203], v[192:195], v[96:111]
  v_mfma_f32_32x32x16_bf16 v[112:127], v[204:207], v[192:195], v[112:127]
  buffer_load_dwordx4 v[188:191], v7, s[12:15], s43 offen offset:2560
  buffer_load_dwordx4 v[192:195], v7, s[12:15], s45 offen offset:2560
  buffer_load_dwordx4 v[196:199], v6, s[12:15], s46 offen offset:3072
  buffer_load_dwordx4 v[200:203], v6, s[12:15], s47 offen offset:3072
  buffer_load_dwordx4 v[204:207], v6, s[12:15], s48 offen offset:3072
  s_waitcnt vmcnt(17)
  v_mfma_f32_32x32x16_bf16 v[32:47], v[136:139], v[128:131], v[32:47]
  s_waitcnt vmcnt(16)
  v_mfma_f32_32x32x16_bf16 v[48:63], v[140:143], v[128:131], v[48:63]
  s_waitcnt vmcnt(15)
  v_mfma_f32_32x32x16_bf16 v[64:79], v[144:147], v[128:131], v[64:79]
  v_mfma_f32_32x32x16_bf16 v[80:95], v[136:139], v[132:135], v[80:95]
  v_mfma_f32_32x32x16_bf16 v[96:111], v[140:143], v[132:135], v[96:111]
  v_mfma_f32_32x32x16_bf16 v[112:127], v[144:147], v[132:135], v[112:127]
  s_cmp_eq_u32 s50, 7
  s_cselect_b32 s51, 0, 8192
  s_add_u32 s43, s43, s51
  s_add_u32 s45, s45, s51
  s_add_u32 s46, s46, s51
  s_add_u32 s47, s47, s51
  s_add_u32 s48, s48, s51
  buffer_load_dwordx4 v[128:131], v2, s[12:15], s43 offen offset:0
  buffer_load_dwordx4 v[132:135], v2, s[12:15], s45 offen offset:0
  buffer_load_dwordx4 v[136:139], v1, s[12:15], s46 offen offset:0
  buffer_load_dwordx4 v[140:143], v1, s[12:15], s47 offen offset:0
  buffer_load_dwordx4 v[144:147], v1, s[12:15], s48 offen offset:0
  s_waitcnt vmcnt(17)
  v_mfma_f32_32x32x16_bf16 v[32:47], v[156:159], v[148:151], v[32:47]
  s_waitcnt vmcnt(16)
  v_mfma_f32_32x32x16_bf16 v[48:63], v[160:163], v[148:151], v[48:63]
  s_waitcnt vmcnt(15)
  v_mfma_f32_32x32x16_bf16 v[64:79], v[164:167], v[148:151], v[64:79]
  v_mfma_f32_32x32x16_bf16 v[80:95], v[156:159], v[152:155], v[80:95]
  v_mfma_f32_32x32x16_bf16 v[96:111], v[160:163], v[152:155], v[96:111]
  v_mfma_f32_32x32x16_bf16 v[112:127], v[164:167], v[152:155], v[112:127]
  buffer_load_dwordx4 v[148:151], v2, s[12:15], s43 offen offset:512
  buffer_load_dwordx4 v[152:155], v2, s[12:15], s45 offen offset:512
  buffer_load_dwordx4 v[156:159], v1, s[12:15], s46 offen offset:1024
  buffer_load_dwordx4 v[160:163], v1, s[12:15], s47 offen offset:1024
  buffer_load_dwordx4 v[164:167], v1, s[12:15], s48 offen offset:1024
  s_waitcnt vmcnt(17)
  v_mfma_f32_32x32x16_bf16 v[32:47], v[176:179], v[168:171], v[32:47]
  s_waitcnt vmcnt(16)
  v_mfma_f32_32x32x16_bf16 v[48:63], v[180:183], v[168:171], v[48:63]
  s_waitcnt vmcnt(15)
  v_mfma_f32_32x32x16_bf16 v[64:79], v[184:187], v[168:171], v[64:79]
  v_mfma_f32_32x32x16_bf16 v[80:95], v[176:179], v[172:175], v[80:95]
  v_mfma_f32_32x32x16_bf16 v[96:111], v[180:183], v[172:175], v[96:111]
  v_mfma_f32_32x32x16_bf16 v[112:127], v[184:187], v[172:175], v[112:127]
  buffer_load_dwordx4 v[168:171], v2, s[12:15], s43 offen offset:2048
  buffer_load_dwordx4 v[172:175], v2, s[12:15], s45 offen offset:2048
  buffer_load_dwordx4 v[176:179], v1, s[12:15], s46 offen offset:2048
  buffer_load_dwordx4 v[180:183], v1, s[12:15], s47 offen offset:2048
  buffer_load_dwordx4 v[184:187], v1, s[12:15], s48 offen offset:2048
  s_waitcnt vmcnt(17)
  v_mfma_f32_32x32x16_bf16 v[32:47], v[196:199], v[188:191], v[32:47]
  s_waitcnt vmcnt(16)
  v_mfma_f32_32x32x16_bf16 v[48:63], v[200:203], v[188:191], v[48:63]
  s_waitcnt vmcnt(15)
  v_mfma_f32_32x32x16_bf16 v[64:79], v[204:207], v[188:191], v[64:79]
  v_mfma_f32_32x32x16_bf16 v[80:95], v[196:199], v[192:195], v[80:95]
  v_mfma_f32_32x32x16_bf16 v[96:111], v[200:203], v[192:195], v[96:111]
  v_mfma_f32_32x32x16_bf16 v[112:127], v[204:207], v[192:195], v[112:127]
  s_add_u32 s50, s50, 1
  s_cmp_lt_u32 s50, 8
  s_nop 9
  s_cbranch_scc1 W_L_50
  s_waitcnt vmcnt(0)
  s_mul_i32 s51, s3, 24576
  v_add_u32 v4, s51, v1
  ds_write_b128 v4, v[32:35] offset:0
  ds_write_b128 v4, v[36:39] offset:1024
  ds_write_b128 v4, v[40:43] offset:2048
  ds_write_b128 v4, v[44:47] offset:3072
  ds_write_b128 v4, v[48:51] offset:4096
  ds_write_b128 v4, v[52:55] offset:5120
  ds_write_b128 v4, v[56:59] offset:6144
  ds_write_b128 v4, v[60:63] offset:7168
  ds_write_b128 v4, v[64:67] offset:8192
  ds_write_b128 v4, v[68:71] offset:9216
  ds_write_b128 v4, v[72:75] offset:10240
  ds_write_b128 v4, v[76:79] offset:11264
  ds_write_b128 v4, v[80:83] offset:12288
  ds_write_b128 v4, v[84:87] offset:13312
  ds_write_b128 v4, v[88:91] offset:14336
  ds_write_b128 v4, v[92:95] offset:15360
  ds_write_b128 v4, v[96:99] offset:16384
  ds_write_b128 v4, v[100:103] offset:17408
  ds_write_b128 v4, v[104:107] offset:18432
  ds_write_b128 v4, v[108:111] offset:19456
  ds_write_b128 v4, v[112:115] offset:20480
  ds_write_b128 v4, v[116:119] offset:21504
  ds_write_b128 v4, v[120:123] offset:22528
  ds_write_b128 v4, v[124:127] offset:23552
  s_waitcnt lgkmcnt(0)
  s_barrier
  s_mul_i32 s51, s3, 6144
  v_add_u32 v4, s51, v1
  v_add_u32 v5, 49152, v4
  v_and_b32 v8, 31, v3
  v_mul_u32_u24 v8, 2304, v8
  v_lshrrev_b32 v9, 5, v3
  v_lshlrev_b32 v9, 3, v9
  v_add_u32 v8, v8, v9
  s_mul_i32 s52, s41, 147456
  s_mul_i32 s53, s42, 192
  s_add_u32 s52, s52, s53
  ds_read_b128 v[160:163], v4 offset:0
  ds_read_b128 v[164:167], v4 offset:24576
  ds_read_b128 v[168:171], v5 offset:0
  ds_read_b128 v[172:175], v5 offset:24576
  s_waitcnt lgkmcnt(2)
  v_add_f32 v160, v160, v164
  s_waitcnt lgkmcnt(0)
  v_add_f32 v168, v168, v172
  v_add_f32 v160, v160, v168
  v_add_f32 v161, v161, v165
  v_add_f32 v169, v169, v173
  v_add_f32 v161, v161, v169
  v_add_f32 v162, v162, v166
  v_add_f32 v170, v170, v174
  v_add_f32 v162, v162, v170
  v_add_f32 v163, v163, v167
  v_add_f32 v171, v171, v175
  v_add_f32 v163, v163, v171
  v_cvt_pk_bf16_f32 v176, v160, v161
  v_cvt_pk_bf16_f32 v177, v162, v163
  s_mul_i32 s54, s3, 6
  s_add_u32 s54, s54, 0
  s_lshr_b32 s55, s54, 2
  s_and_b32 s56, s54, 3
  s_cmp_ge_u32 s55, 3
  s_cselect_b32 s57, 73728, 0
  s_cselect_b32 s58, 3, 0
  s_sub_u32 s55, s55, s58
  s_lshl_b32 s55, s55, 6
  s_lshl_b32 s56, s56, 4
  s_add_u32 s57, s57, s55
  s_add_u32 s57, s57, s56
  s_add_u32 s57, s57, s52
  buffer_store_dwordx2 v[176:177], v8, s[16:19], s57 offen
  ds_read_b128 v[160:163], v4 offset:1024
  ds_read_b128 v[164:167], v4 offset:25600
  ds_read_b128 v[168:171], v5 offset:1024
  ds_read_b128 v[172:175], v5 offset:25600
  s_waitcnt lgkmcnt(2)
  v_add_f32 v160, v160, v164
  s_waitcnt lgkmcnt(0)
  v_add_f32 v168, v168, v172
  v_add_f32 v160, v160, v168
  v_add_f32 v161, v161, v165
  v_add_f32 v169, v169, v173
  v_add_f32 v161, v161, v169
  v_add_f32 v162, v162, v166
  v_add_f32 v170, v170, v174
  v_add_f32 v162, v162, v170
  v_add_f32 v163, v163, v167
  v_add_f32 v171, v171, v175
  v_add_f32 v163, v163, v171
  v_cvt_pk_bf16_f32 v178, v160, v161
  v_cvt_pk_bf16_f32 v179, v162, v163
  s_mul_i32 s54, s3, 6
  s_add_u32 s54, s54, 1
  s_lshr_b32 s55, s54, 2
  s_and_b32 s56, s54, 3
  s_cmp_ge_u32 s55, 3
  s_cselect_b32 s57, 73728, 0
  s_cselect_b32 s58, 3, 0
  s_sub_u32 s55, s55, s58
  s_lshl_b32 s55, s55, 6
  s_lshl_b32 s56, s56, 4
  s_add_u32 s57, s57, s55
  s_add_u32 s57, s57, s56
  s_add_u32 s57, s57, s52
  buffer_store_dwordx2 v[178:179], v8, s[16:19], s57 offen
  ds_read_b128 v[160:163], v4 offset:2048
  ds_read_b128 v[164:167], v4 offset:26624
  ds_read_b128 v[168:171], v5 offset:2048
  ds_read_b128 v[172:175], v5 offset:26624
  s_waitcnt lgkmcnt(2)
  v_add_f32 v160, v160, v164
  s_waitcnt lgkmcnt(0)
  v_add_f32 v168, v168, v172
  v_add_f32 v160, v160, v168
  v_add_f32 v161, v161, v165
  v_add_f32 v169, v169, v173
  v_add_f32 v161, v161, v169
  v_add_f32 v162, v162, v166
  v_add_f32 v170, v170, v174
  v_add_f32 v162, v162, v170
  v_add_f32 v163, v163, v167
  v_add_f32 v171, v171, v175
  v_add_f32 v163, v163, v171
  v_cvt_pk_bf16_f32 v176, v160, v161
  v_cvt_pk_bf16_f32 v177, v162, v163
  s_mul_i32 s54, s3, 6
  s_add_u32 s54, s54, 2
  s_lshr_b32 s55, s54, 2
  s_and_b32 s56, s54, 3
  s_cmp_ge_u32 s55, 3
  s_cselect_b32 s57, 73728, 0
  s_cselect_b32 s58, 3, 0
  s_sub_u32 s55, s55, s58
  s_lshl_b32 s55, s55, 6
  s_lshl_b32 s56, s56, 4
  s_add_u32 s57, s57, s55
  s_add_u32 s57, s57, s56
  s_add_u32 s57, s57, s52
  buffer_store_dwordx2 v[176:177], v8, s[16:19], s57 offen
  ds_read_b128 v[160:163], v4 offset:3072
  ds_read_b128 v[164:167], v4 offset:27648
  ds_read_b128 v[168:171], v5 offset:3072
  ds_read_b128 v[172:175], v5 offset:27648
  s_waitcnt lgkmcnt(2)
  v_add_f32 v160, v160, v164
  s_waitcnt lgkmcnt(0)
  v_add_f32 v168, v168, v172
  v_add_f32 v160, v160, v168
  v_add_f32 v161, v161, v165
  v_add_f32 v169, v169, v173
  v_add_f32 v161, v161, v169
  v_add_f32 v162, v162, v166
  v_add_f32 v170, v170, v174
  v_add_f32 v162, v162, v170
  v_add_f32 v163, v163, v167
  v_add_f32 v171, v171, v175
  v_add_f32 v163, v163, v171
  v_cvt_pk_bf16_f32 v178, v160, v161
  v_cvt_pk_bf16_f32 v179, v162, v163
  s_mul_i32 s54, s3, 6
  s_add_u32 s54, s54, 3
  s_lshr_b32 s55, s54, 2
  s_and_b32 s56, s54, 3
  s_cmp_ge_u32 s55, 3
  s_cselect_b32 s57, 73728, 0
  s_cselect_b32 s58, 3, 0
  s_sub_u32 s55, s55, s58
  s_lshl_b32 s55, s55, 6
  s_lshl_b32 s56, s56, 4
  s_add_u32 s57, s57, s55
  s_add_u32 s57, s57, s56
  s_add_u32 s57, s57, s52
  buffer_store_dwordx2 v[178:179], v8, s[16:19], s57 offen
  ds_read_b128 v[160:163], v4 offset:4096
  ds_read_b128 v[164:167], v4 offset:28672
  ds_read_b128 v[168:171], v5 offset:4096
  ds_read_b128 v[172:175], v5 offset:28672
  s_waitcnt lgkmcnt(2)
  v_add_f32 v160, v160, v164
  s_waitcnt lgkmcnt(0)
  v_add_f32 v168, v168, v172
  v_add_f32 v160, v160, v168
  v_add_f32 v161, v161, v165
  v_add_f32 v169, v169, v173
  v_add_f32 v161, v161, v169
  v_add_f32 v162, v162, v166
  v_add_f32 v170, v170, v174
  v_add_f32 v162, v162, v170
  v_add_f32 v163, v163, v167
  v_add_f32 v171, v171, v175
  v_add_f32 v163, v163, v171
  v_cvt_pk_bf16_f32 v176, v160, v161
  v_cvt_pk_bf16_f32 v177, v162, v163
  s_mul_i32 s54, s3, 6
  s_add_u32 s54, s54, 4
  s_lshr_b32 s55, s54, 2
  s_and_b32 s56, s54, 3
  s_cmp_ge_u32 s55, 3
  s_cselect_b32 s57, 73728, 0
  s_cselect_b32 s58, 3, 0
  s_sub_u32 s55, s55, s58
  s_lshl_b32 s55, s55, 6
  s_lshl_b32 s56, s56, 4
  s_add_u32 s57, s57, s55
  s_add_u32 s57, s57, s56
  s_add_u32 s57, s57, s52
  buffer_store_dwordx2 v[176:177], v8, s[16:19], s57 offen
  ds_read_b128 v[160:163], v4 offset:5120
  ds_read_b128 v[164:167], v4 offset:29696
  ds_read_b128 v[168:171], v5 offset:5120
  ds_read_b128 v[172:175], v5 offset:29696
  s_waitcnt lgkmcnt(2)
  v_add_f32 v160, v160, v164
  s_waitcnt lgkmcnt(0)
  v_add_f32 v168, v168, v172
  v_add_f32 v160, v160, v168
  v_add_f32 v161, v161, v165
  v_add_f32 v169, v169, v173
  v_add_f32 v161, v161, v169
  v_add_f32 v162, v162, v166
  v_add_f32 v170, v170, v174
  v_add_f32 v162, v162, v170
  v_add_f32 v163, v163, v167
  v_add_f32 v171, v171, v175
  v_add_f32 v163, v163, v171
  v_cvt_pk_bf16_f32 v178, v160, v161
  v_cvt_pk_bf16_f32 v179, v162, v163
  s_mul_i32 s54, s3, 6
  s_add_u32 s54, s54, 5
  s_lshr_b32 s55, s54, 2
  s_and_b32 s56, s54, 3
  s_cmp_ge_u32 s55, 3
  s_cselect_b32 s57, 73728, 0
  s_cselect_b32 s58, 3, 0
  s_sub_u32 s55, s55, s58
  s_lshl_b32 s55, s55, 6
  s_lshl_b32 s56, s56, 4
  s_add_u32 s57, s57, s55
  s_add_u32 s57, s57, s56
  s_add_u32 s57, s57, s52
  buffer_store_dwordx2 v[178:179], v8, s[16:19], s57 offen
  s_waitcnt vmcnt(0)
  s_barrier
  s_branch Q_TOP
Q_WS:
  s_sub_u32 s36, s36, 1
  v_mov_b32 v4, 88
  s_mov_b32 s39, 0
  s_nop 0
  s_cmp_eq_u32 s3, 0
  s_cbranch_scc0 QT2k_52
QT2l_51:
  buffer_load_dword v5, v4, s[16:19], 0 offen sc1
  s_waitcnt vmcnt(0)
  v_readfirstlane_b32 s38, v5
  s_cmp_eq_u32 s38, 128
  s_cbranch_scc1 QT2k_52
  s_add_u32 s39, s39, 1
  s_cmp_lt_u32 s39, 0x100000
  s_cbranch_scc1 QT2l_51
QT2k_52:
  s_waitcnt vmcnt(0)
  s_barrier
  s_load_dwordx2 s[4:5], s[0:1], 128
  s_load_dwordx2 s[8:9], s[0:1], 144
  s_waitcnt lgkmcnt(0)
  s_mov_b32 s12, s8
  s_mov_b32 s13, s9
  s_mov_b32 s14, 0x8000000
  s_mov_b32 s15, 0x00020000
  s_mov_b32 s20, s4
  s_mov_b32 s21, s5
  s_mov_b32 s22, 4718592
  s_mov_b32 s23, 0x00020000
  s_cmp_ge_u32 s37, 18
  s_cselect_b32 s41, 1, 0
  s_cselect_b32 s42, 18, 0
  s_sub_u32 s42, s37, s42
  v_and_b32 v3, 63, v0
  v_lshlrev_b32 v1, 4, v3
  v_and_b32 v4, 15, v3
  v_lshlrev_b32 v4, 4, v4
  v_lshrrev_b32 v5, 4, v3
  v_and_b32 v5, 1, v5
  v_lshlrev_b32 v5, 10, v5
  v_lshrrev_b32 v6, 5, v3
  v_lshlrev_b32 v6, 8, v6
  v_add_u32 v4, v4, v5
  v_add_u32 v2, v4, v6
  s_lshl_b32 s44, s3, 16
  s_lshl_b32 s46, s42, 18
  s_add_u32 s46, s46, s44
  s_add_u32 s46, s46, 0x5000000
  s_lshl_b32 s43, s36, 1
  s_add_u32 s43, s43, s41
  s_lshl_b32 s47, s43, 18
  s_add_u32 s47, s47, s44
  s_add_u32 s47, s47, 0x3000000
  s_add_u32 s48, s46, 0
  buffer_load_dwordx4 a[0:3], v1, s[12:15], s48 offen offset:0
  buffer_load_dwordx4 a[4:7], v1, s[12:15], s48 offen offset:1024
  buffer_load_dwordx4 a[8:11], v1, s[12:15], s48 offen offset:2048
  buffer_load_dwordx4 a[12:15], v1, s[12:15], s48 offen offset:3072
  s_add_u32 s48, s46, 4096
  buffer_load_dwordx4 a[16:19], v1, s[12:15], s48 offen offset:0
  buffer_load_dwordx4 a[20:23], v1, s[12:15], s48 offen offset:1024
  buffer_load_dwordx4 a[24:27], v1, s[12:15], s48 offen offset:2048
  buffer_load_dwordx4 a[28:31], v1, s[12:15], s48 offen offset:3072
  s_add_u32 s48, s46, 8192
  buffer_load_dwordx4 a[32:35], v1, s[12:15], s48 offen offset:0
  buffer_load_dwordx4 a[36:39], v1, s[12:15], s48 offen offset:1024
  buffer_load_dwordx4 a[40:43], v1, s[12:15], s48 offen offset:2048
  buffer_load_dwordx4 a[44:47], v1, s[12:15], s48 offen offset:3072
  s_add_u32 s48, s46, 12288
  buffer_load_dwordx4 a[48:51], v1, s[12:15], s48 offen offset:0
  buffer_load_dwordx4 a[52:55], v1, s[12:15], s48 offen offset:1024
  buffer_load_dwordx4 a[56:59], v1, s[12:15], s48 offen offset:2048
  buffer_load_dwordx4 a[60:63], v1, s[12:15], s48 offen offset:3072
  s_add_u32 s48, s46, 16384
  buffer_load_dwordx4 a[64:67], v1, s[12:15], s48 offen offset:0
  buffer_load_dwordx4 a[68:71], v1, s[12:15], s48 offen offset:1024
  buffer_load_dwordx4 a[72:75], v1, s[12:15], s48 offen offset:2048
  buffer_load_dwordx4 a[76:79], v1, s[12:15], s48 offen offset:3072
  s_add_u32 s48, s46, 20480
  buffer_load_dwordx4 a[80:83], v1, s[12:15], s48 offen offset:0
  buffer_load_dwordx4 a[84:87], v1, s[12:15], s48 offen offset:1024
  buffer_load_dwordx4 a[88:91], v1, s[12:15], s48 offen offset:2048
  buffer_load_dwordx4 a[92:95], v1, s[12:15], s48 offen offset:3072
  s_add_u32 s48, s46, 24576
  buffer_load_dwordx4 a[96:99], v1, s[12:15], s48 offen offset:0
  buffer_load_dwordx4 a[100:103], v1, s[12:15], s48 offen offset:1024
  buffer_load_dwordx4 a[104:107], v1, s[12:15], s48 offen offset:2048
  buffer_load_dwordx4 a[108:111], v1, s[12:15], s48 offen offset:3072
  s_add_u32 s48, s46, 28672
  buffer_load_dwordx4 a[112:115], v1, s[12:15], s48 offen offset:0
  buffer_load_dwordx4 a[116:119], v1, s[12:15], s48 offen offset:1024
  buffer_load_dwordx4 a[120:123], v1, s[12:15], s48 offen offset:2048
  buffer_load_dwordx4 a[124:127], v1, s[12:15], s48 offen offset:3072
  s_add_u32 s48, s46, 32768
  buffer_load_dwordx4 a[128:131], v1, s[12:15], s48 offen offset:0
  buffer_load_dwordx4 a[132:135], v1, s[12:15], s48 offen offset:1024
  buffer_load_dwordx4 a[136:139], v1, s[12:15], s48 offen offset:2048
  buffer_load_dwordx4 a[140:143], v1, s[12:15], s48 offen offset:3072
  s_add_u32 s48, s46, 36864
  buffer_load_dwordx4 a[144:147], v1, s[12:15], s48 offen offset:0
  buffer_load_dwordx4 a[148:151], v1, s[12:15], s48 offen offset:1024
  buffer_load_dwordx4 a[152:155], v1, s[12:15], s48 offen offset:2048
  buffer_load_dwordx4 a[156:159], v1, s[12:15], s48 offen offset:3072
  s_add_u32 s48, s46, 40960
  buffer_load_dwordx4 a[160:163], v1, s[12:15], s48 offen offset:0
  buffer_load_dwordx4 a[164:167], v1, s[12:15], s48 offen offset:1024
  buffer_load_dwordx4 a[168:171], v1, s[12:15], s48 offen offset:2048
  buffer_load_dwordx4 a[172:175], v1, s[12:15], s48 offen offset:3072
  s_add_u32 s48, s46, 45056
  buffer_load_dwordx4 a[176:179], v1, s[12:15], s48 offen offset:0
  buffer_load_dwordx4 a[180:183], v1, s[12:15], s48 offen offset:1024
  buffer_load_dwordx4 a[184:187], v1, s[12:15], s48 offen offset:2048
  buffer_load_dwordx4 a[188:191], v1, s[12:15], s48 offen offset:3072
  s_add_u32 s48, s46, 49152
  s_waitcnt vmcnt(16)
  buffer_load_dwordx4 a[192:195], v1, s[12:15], s48 offen offset:0
  buffer_load_dwordx4 a[196:199], v1, s[12:15], s48 offen offset:1024
  buffer_load_dwordx4 a[200:203], v1, s[12:15], s48 offen offset:2048
  buffer_load_dwordx4 a[204:207], v1, s[12:15], s48 offen offset:3072
  s_add_u32 s48, s46, 53248
  buffer_load_dwordx4 a[208:211], v1, s[12:15], s48 offen offset:0
  buffer_load_dwordx4 a[212:215], v1, s[12:15], s48 offen offset:1024
  buffer_load_dwordx4 a[216:219], v1, s[12:15], s48 offen offset:2048
  buffer_load_dwordx4 a[220:223], v1, s[12:15], s48 offen offset:3072
  s_add_u32 s48, s46, 57344
  buffer_load_dwordx4 a[224:227], v1, s[12:15], s48 offen offset:0
  buffer_load_dwordx4 a[228:231], v1, s[12:15], s48 offen offset:1024
  buffer_load_dwordx4 a[232:235], v1, s[12:15], s48 offen offset:2048
  buffer_load_dwordx4 a[236:239], v1, s[12:15], s48 offen offset:3072
  s_add_u32 s48, s46, 61440
  buffer_load_dwordx4 a[240:243], v1, s[12:15], s48 offen offset:0
  buffer_load_dwordx4 a[244:247], v1, s[12:15], s48 offen offset:1024
  buffer_load_dwordx4 a[248:251], v1, s[12:15], s48 offen offset:2048
  buffer_load_dwordx4 a[252:255], v1, s[12:15], s48 offen offset:3072
  s_lshr_b32 s49, s36, 1
  s_lshl_b32 s49, s49, 2
  s_add_u32 s49, s49, 192
  v_mov_b32 v4, s49
  s_and_b32 s50, s36, 1
  s_lshl_b32 s50, s50, 4
  s_mov_b32 s39, 0
  s_cmp_eq_u32 s3, 0
  s_cbranch_scc0 QW2k_54
QW2l_53:
  buffer_load_dword v5, v4, s[16:19], 0 offen sc1
  s_waitcnt vmcnt(0)
  v_readfirstlane_b32 s38, v5
  s_lshr_b32 s38, s38, s50
  s_and_b32 s38, s38, 0xffff
  s_cmp_eq_u32 s38, 64
  s_cbranch_scc1 QW2k_54
  s_add_u32 s39, s39, 1
  s_cmp_lt_u32 s39, 0x100000
  s_cbranch_scc1 QW2l_53
QW2k_54:
  s_waitcnt vmcnt(0)
  s_barrier
  s_waitcnt vmcnt(0)
  s_add_u32 s48, s47, 0
  buffer_load_dwordx4 v[32:35], v2, s[12:15], s48 offen offset:0
  buffer_load_dwordx4 v[36:39], v2, s[12:15], s48 offen offset:512
  buffer_load_dwordx4 v[40:43], v2, s[12:15], s48 offen offset:2048
  buffer_load_dwordx4 v[44:47], v2, s[12:15], s48 offen offset:2560
  s_add_u32 s48, s47, 4096
  buffer_load_dwordx4 v[48:51], v2, s[12:15], s48 offen offset:0
  buffer_load_dwordx4 v[52:55], v2, s[12:15], s48 offen offset:512
  buffer_load_dwordx4 v[56:59], v2, s[12:15], s48 offen offset:2048
  buffer_load_dwordx4 v[60:63], v2, s[12:15], s48 offen offset:2560
  s_add_u32 s48, s47, 8192
  buffer_load_dwordx4 v[64:67], v2, s[12:15], s48 offen offset:0
  buffer_load_dwordx4 v[68:71], v2, s[12:15], s48 offen offset:512
  buffer_load_dwordx4 v[72:75], v2, s[12:15], s48 offen offset:2048
  buffer_load_dwordx4 v[76:79], v2, s[12:15], s48 offen offset:2560
  s_add_u32 s48, s47, 12288
  buffer_load_dwordx4 v[80:83], v2, s[12:15], s48 offen offset:0
  buffer_load_dwordx4 v[84:87], v2, s[12:15], s48 offen offset:512
  buffer_load_dwordx4 v[88:91], v2, s[12:15], s48 offen offset:2048
  buffer_load_dwordx4 v[92:95], v2, s[12:15], s48 offen offset:2560
  s_add_u32 s48, s47, 16384
  buffer_load_dwordx4 v[96:99], v2, s[12:15], s48 offen offset:0
  buffer_load_dwordx4 v[100:103], v2, s[12:15], s48 offen offset:512
  buffer_load_dwordx4 v[104:107], v2, s[12:15], s48 offen offset:2048
  buffer_load_dwordx4 v[108:111], v2, s[12:15], s48 offen offset:2560
  s_add_u32 s48, s47, 20480
  buffer_load_dwordx4 v[112:115], v2, s[12:15], s48 offen offset:0
  buffer_load_dwordx4 v[116:119], v2, s[12:15], s48 offen offset:512
  buffer_load_dwordx4 v[120:123], v2, s[12:15], s48 offen offset:2048
  buffer_load_dwordx4 v[124:127], v2, s[12:15], s48 offen offset:2560
  s_add_u32 s48, s47, 24576
  buffer_load_dwordx4 v[128:131], v2, s[12:15], s48 offen offset:0
  buffer_load_dwordx4 v[132:135], v2, s[12:15], s48 offen offset:512
  buffer_load_dwordx4 v[136:139], v2, s[12:15], s48 offen offset:2048
  buffer_load_dwordx4 v[140:143], v2, s[12:15], s48 offen offset:2560
  s_add_u32 s48, s47, 28672
  buffer_load_dwordx4 v[144:147], v2, s[12:15], s48 offen offset:0
  buffer_load_dwordx4 v[148:151], v2, s[12:15], s48 offen offset:512
  buffer_load_dwordx4 v[152:155], v2, s[12:15], s48 offen offset:2048
  buffer_load_dwordx4 v[156:159], v2, s[12:15], s48 offen offset:2560
  s_add_u32 s48, s47, 32768
  buffer_load_dwordx4 v[160:163], v2, s[12:15], s48 offen offset:0
  buffer_load_dwordx4 v[164:167], v2, s[12:15], s48 offen offset:512
  buffer_load_dwordx4 v[168:171], v2, s[12:15], s48 offen offset:2048
  buffer_load_dwordx4 v[172:175], v2, s[12:15], s48 offen offset:2560
  s_add_u32 s48, s47, 36864
  buffer_load_dwordx4 v[176:179], v2, s[12:15], s48 offen offset:0
  buffer_load_dwordx4 v[180:183], v2, s[12:15], s48 offen offset:512
  buffer_load_dwordx4 v[184:187], v2, s[12:15], s48 offen offset:2048
  buffer_load_dwordx4 v[188:191], v2, s[12:15], s48 offen offset:2560
  s_add_u32 s48, s47, 40960
  buffer_load_dwordx4 v[192:195], v2, s[12:15], s48 offen offset:0
  buffer_load_dwordx4 v[196:199], v2, s[12:15], s48 offen offset:512
  buffer_load_dwordx4 v[200:203], v2, s[12:15], s48 offen offset:2048
  buffer_load_dwordx4 v[204:207], v2, s[12:15], s48 offen offset:2560
  s_add_u32 s48, s47, 45056
  buffer_load_dwordx4 v[208:211], v2, s[12:15], s48 offen offset:0
  buffer_load_dwordx4 v[212:215], v2, s[12:15], s48 offen offset:512
  buffer_load_dwordx4 v[216:219], v2, s[12:15], s48 offen offset:2048
  buffer_load_dwordx4 v[220:223], v2, s[12:15], s48 offen offset:2560
  s_add_u32 s48, s47, 49152
  buffer_load_dwordx4 v[224:227], v2, s[12:15], s48 offen offset:0
  buffer_load_dwordx4 v[228:231], v2, s[12:15], s48 offen offset:512
  buffer_load_dwordx4 v[232:235], v2, s[12:15], s48 offen offset:2048
  buffer_load_dwordx4 v[236:239], v2, s[12:15], s48 offen offset:2560
  s_add_u32 s48, s47, 53248
  buffer_load_dwordx4 v[240:243], v2, s[12:15], s48 offen offset:0
  buffer_load_dwordx4 v[244:247], v2, s[12:15], s48 offen offset:512
  buffer_load_dwordx4 v[248:251], v2, s[12:15], s48 offen offset:2048
  buffer_load_dwordx4 v[252:255], v2, s[12:15], s48 offen offset:2560
  s_waitcnt vmcnt(55)
  v_mfma_f32_32x32x16_bf16 v[16:31], a[0:3], v[32:35], 0
  s_add_u32 s48, s47, 57344
  buffer_load_dwordx4 v[32:35], v2, s[12:15], s48 offen offset:0
  s_waitcnt vmcnt(55)
  v_mfma_f32_32x32x16_bf16 v[16:31], a[4:7], v[36:39], v[16:31]
  buffer_load_dwordx4 v[36:39], v2, s[12:15], s48 offen offset:512
  s_waitcnt vmcnt(55)
  v_mfma_f32_32x32x16_bf16 v[16:31], a[8:11], v[40:43], v[16:31]
  buffer_load_dwordx4 v[40:43], v2, s[12:15], s48 offen offset:2048
  s_waitcnt vmcnt(55)
  v_mfma_f32_32x32x16_bf16 v[16:31], a[12:15], v[44:47], v[16:31]
  buffer_load_dwordx4 v[44:47], v2, s[12:15], s48 offen offset:2560
  s_waitcnt vmcnt(55)
  v_mfma_f32_32x32x16_bf16 v[16:31], a[16:19], v[48:51], v[16:31]
  s_add_u32 s48, s47, 61440
  buffer_load_dwordx4 v[48:51], v2, s[12:15], s48 offen offset:0
  s_waitcnt vmcnt(55)
  v_mfma_f32_32x32x16_bf16 v[16:31], a[20:23], v[52:55], v[16:31]
  buffer_load_dwordx4 v[52:55], v2, s[12:15], s48 offen offset:512
  s_waitcnt vmcnt(55)
  v_mfma_f32_32x32x16_bf16 v[16:31], a[24:27], v[56:59], v[16:31]
  buffer_load_dwordx4 v[56:59], v2, s[12:15], s48 offen offset:2048
  s_waitcnt vmcnt(55)
  v_mfma_f32_32x32x16_bf16 v[16:31], a[28:31], v[60:63], v[16:31]
  buffer_load_dwordx4 v[60:63], v2, s[12:15], s48 offen offset:2560
  s_waitcnt vmcnt(55)
  v_mfma_f32_32x32x16_bf16 v[16:31], a[32:35], v[64:67], v[16:31]
  s_waitcnt vmcnt(54)
  v_mfma_f32_32x32x16_bf16 v[16:31], a[36:39], v[68:71], v[16:31]
  s_waitcnt vmcnt(53)
  v_mfma_f32_32x32x16_bf16 v[16:31], a[40:43], v[72:75], v[16:31]
  s_waitcnt vmcnt(52)
  v_mfma_f32_32x32x16_bf16 v[16:31], a[44:47], v[76:79], v[16:31]
  s_waitcnt vmcnt(51)
  v_mfma_f32_32x32x16_bf16 v[16:31], a[48:51], v[80:83], v[16:31]
  s_waitcnt vmcnt(50)
  v_mfma_f32_32x32x16_bf16 v[16:31], a[52:55], v[84:87], v[16:31]
  s_waitcnt vmcnt(49)
  v_mfma_f32_32x32x16_bf16 v[16:31], a[56:59], v[88:91], v[16:31]
  s_waitcnt vmcnt(48)
  v_mfma_f32_32x32x16_bf16 v[16:31], a[60:63], v[92:95], v[16:31]
  s_waitcnt vmcnt(47)
  v_mfma_f32_32x32x16_bf16 v[16:31], a[64:67], v[96:99], v[16:31]
  s_waitcnt vmcnt(46)
  v_mfma_f32_32x32x16_bf16 v[16:31], a[68:71], v[100:103], v[16:31]
  s_waitcnt vmcnt(45)
  v_mfma_f32_32x32x16_bf16 v[16:31], a[72:75], v[104:107], v[16:31]
  s_waitcnt vmcnt(44)
  v_mfma_f32_32x32x16_bf16 v[16:31], a[76:79], v[108:111], v[16:31]
  s_waitcnt vmcnt(43)
  v_mfma_f32_32x32x16_bf16 v[16:31], a[80:83], v[112:115], v[16:31]
  s_waitcnt vmcnt(42)
  v_mfma_f32_32x32x16_bf16 v[16:31], a[84:87], v[116:119], v[16:31]
  s_waitcnt vmcnt(41)
  v_mfma_f32_32x32x16_bf16 v[16:31], a[88:91], v[120:123], v[16:31]
  s_waitcnt vmcnt(40)
  v_mfma_f32_32x32x16_bf16 v[16:31], a[92:95], v[124:127], v[16:31]
  s_waitcnt vmcnt(39)
  v_mfma_f32_32x32x16_bf16 v[16:31], a[96:99], v[128:131], v[16:31]
  s_waitcnt vmcnt(38)
  v_mfma_f32_32x32x16_bf16 v[16:31], a[100:103], v[132:135], v[16:31]
  s_waitcnt vmcnt(37)
  v_mfma_f32_32x32x16_bf16 v[16:31], a[104:107], v[136:139], v[16:31]
  s_waitcnt vmcnt(36)
  v_mfma_f32_32x32x16_bf16 v[16:31], a[108:111], v[140:143], v[16:31]
  s_waitcnt vmcnt(35)
  v_mfma_f32_32x32x16_bf16 v[16:31], a[112:115], v[144:147], v[16:31]
  s_waitcnt vmcnt(34)
  v_mfma_f32_32x32x16_bf16 v[16:31], a[116:119], v[148:151], v[16:31]
  s_waitcnt vmcnt(33)
  v_mfma_f32_32x32x16_bf16 v[16:31], a[120:123], v[152:155], v[16:31]
  s_waitcnt vmcnt(32)
  v_mfma_f32_32x32x16_bf16 v[16:31], a[124:127], v[156:159], v[16:31]
  s_waitcnt vmcnt(31)
  v_mfma_f32_32x32x16_bf16 v[16:31], a[128:131], v[160:163], v[16:31]
  s_waitcnt vmcnt(30)
  v_mfma_f32_32x32x16_bf16 v[16:31], a[132:135], v[164:167], v[16:31]
  s_waitcnt vmcnt(29)
  v_mfma_f32_32x32x16_bf16 v[16:31], a[136:139], v[168:171], v[16:31]
  s_waitcnt vmcnt(28)
  v_mfma_f32_32x32x16_bf16 v[16:31], a[140:143], v[172:175], v[16:31]
  s_waitcnt vmcnt(27)
  v_mfma_f32_32x32x16_bf16 v[16:31], a[144:147], v[176:179], v[16:31]
  s_waitcnt vmcnt(26)
  v_mfma_f32_32x32x16_bf16 v[16:31], a[148:151], v[180:183], v[16:31]
  s_waitcnt vmcnt(25)
  v_mfma_f32_32x32x16_bf16 v[16:31], a[152:155], v[184:187], v[16:31]
  s_waitcnt vmcnt(24)
  v_mfma_f32_32x32x16_bf16 v[16:31], a[156:159], v[188:191], v[16:31]
  s_waitcnt vmcnt(23)
  v_mfma_f32_32x32x16_bf16 v[16:31], a[160:163], v[192:195], v[16:31]
  s_waitcnt vmcnt(22)
  v_mfma_f32_32x32x16_bf16 v[16:31], a[164:167], v[196:199], v[16:31]
  s_waitcnt vmcnt(21)
  v_mfma_f32_32x32x16_bf16 v[16:31], a[168:171], v[200:203], v[16:31]
  s_waitcnt vmcnt(20)
  v_mfma_f32_32x32x16_bf16 v[16:31], a[172:175], v[204:207], v[16:31]
  s_waitcnt vmcnt(19)
  v_mfma_f32_32x32x16_bf16 v[16:31], a[176:179], v[208:211], v[16:31]
  s_waitcnt vmcnt(18)
  v_mfma_f32_32x32x16_bf16 v[16:31], a[180:183], v[212:215], v[16:31]
  s_waitcnt vmcnt(17)
  v_mfma_f32_32x32x16_bf16 v[16:31], a[184:187], v[216:219], v[16:31]
  s_waitcnt vmcnt(16)
  v_mfma_f32_32x32x16_bf16 v[16:31], a[188:191], v[220:223], v[16:31]
  s_waitcnt vmcnt(15)
  v_mfma_f32_32x32x16_bf16 v[16:31], a[192:195], v[224:227], v[16:31]
  s_waitcnt vmcnt(14)
  v_mfma_f32_32x32x16_bf16 v[16:31], a[196:199], v[228:231], v[16:31]
  s_waitcnt vmcnt(13)
  v_mfma_f32_32x32x16_bf16 v[16:31], a[200:203], v[232:235], v[16:31]
  s_waitcnt vmcnt(12)
  v_mfma_f32_32x32x16_bf16 v[16:31], a[204:207], v[236:239], v[16:31]
  s_waitcnt vmcnt(11)
  v_mfma_f32_32x32x16_bf16 v[16:31], a[208:211], v[240:243], v[16:31]
  s_waitcnt vmcnt(10)
  v_mfma_f32_32x32x16_bf16 v[16:31], a[212:215], v[244:247], v[16:31]
  s_waitcnt vmcnt(9)
  v_mfma_f32_32x32x16_bf16 v[16:31], a[216:219], v[248:251], v[16:31]
  s_waitcnt vmcnt(8)
  v_mfma_f32_32x32x16_bf16 v[16:31], a[220:223], v[252:255], v[16:31]
  s_waitcnt vmcnt(7)
  v_mfma_f32_32x32x16_bf16 v[16:31], a[224:227], v[32:35], v[16:31]
  s_waitcnt vmcnt(6)
  v_mfma_f32_32x32x16_bf16 v[16:31], a[228:231], v[36:39], v[16:31]
  s_waitcnt vmcnt(5)
  v_mfma_f32_32x32x16_bf16 v[16:31], a[232:235], v[40:43], v[16:31]
  s_waitcnt vmcnt(4)
  v_mfma_f32_32x32x16_bf16 v[16:31], a[236:239], v[44:47], v[16:31]
  s_waitcnt vmcnt(3)
  v_mfma_f32_32x32x16_bf16 v[16:31], a[240:243], v[48:51], v[16:31]
  s_waitcnt vmcnt(2)
  v_mfma_f32_32x32x16_bf16 v[16:31], a[244:247], v[52:55], v[16:31]
  s_waitcnt vmcnt(1)
  v_mfma_f32_32x32x16_bf16 v[16:31], a[248:251], v[56:59], v[16:31]
  s_waitcnt vmcnt(0)
  v_mfma_f32_32x32x16_bf16 v[16:31], a[252:255], v[60:63], v[16:31]
  s_lshl_b32 s51, s3, 12
  v_add_u32 v4, s51, v1
  s_nop 9
  ds_write_b128 v4, v[16:19] offset:0
  ds_write_b128 v4, v[20:23] offset:1024
  ds_write_b128 v4, v[24:27] offset:2048
  ds_write_b128 v4, v[28:31] offset:3072
  s_waitcnt lgkmcnt(0)
  s_barrier
  s_lshl_b32 s51, s3, 10
  v_add_u32 v4, s51, v1
  ds_read_b128 v[32:35], v4 offset:0
  ds_read_b128 v[36:39], v4 offset:4096
  ds_read_b128 v[40:43], v4 offset:8192
  ds_read_b128 v[44:47], v4 offset:12288
  s_waitcnt lgkmcnt(2)
  v_add_f32 v32, v32, v36
  s_waitcnt lgkmcnt(0)
  v_add_f32 v40, v40, v44
  v_add_f32 v32, v32, v40
  v_add_f32 v33, v33, v37
  v_add_f32 v41, v41, v45
  v_add_f32 v33, v33, v41
  v_add_f32 v34, v34, v38
  v_add_f32 v42, v42, v46
  v_add_f32 v34, v34, v42
  v_add_f32 v35, v35, v39
  v_add_f32 v43, v43, v47
  v_add_f32 v35, v35, v43
  v_cvt_pk_bf16_f32 v48, v32, v33
  v_cvt_pk_bf16_f32 v49, v34, v35
  v_and_b32 v8, 31, v3
  v_mul_u32_u24 v8, 2304, v8
  v_lshrrev_b32 v9, 5, v3
  v_lshlrev_b32 v9, 3, v9
  v_add_u32 v8, v8, v9
  s_mul_i32 s52, s43, 73728
  s_lshl_b32 s53, s42, 6
  s_add_u32 s52, s52, s53
  s_lshl_b32 s53, s3, 4
  s_add_u32 s52, s52, s53
  buffer_store_dwordx2 v[48:49], v8, s[20:23], s52 offen
  s_waitcnt vmcnt(0)
  s_barrier
  s_branch Q_TOP
Q_END:
C_FIN:
C_EXIT:
  s_endpgm
.section .rodata,"a"
.p2align 6
.amdhsa_kernel c_kernel
  .amdhsa_next_free_vgpr 512
  .amdhsa_next_free_sgpr 102
  .amdhsa_accum_offset 256
  .amdhsa_group_segment_fixed_size 0
  .amdhsa_kernarg_size 152
  .amdhsa_user_sgpr_count 2
  .amdhsa_user_sgpr_kernarg_segment_ptr 1
  .amdhsa_system_sgpr_workgroup_id_x 1
.end_amdhsa_kernel
```
